```python
import torch

def _softmax(x, axis=-1):
    return torch.softmax(x, dim=axis)
def _gelu(x):
    return torch.nn.functional.gelu(x, approximate="tanh")
def _silu(x):
    return torch.nn.functional.silu(x)
def _sigmoid(x):
    return torch.sigmoid(x)
def _layernorm(x, axis=-1, eps=1e-5):
    m = x.mean(dim=axis, keepdim=True)
    v = x.var(dim=axis, keepdim=True, unbiased=False)
    return (x - m) / torch.sqrt(v + eps)
def _scatter_add(tgt, idx, src, axis=0):
    return tgt.clone().index_add_(axis, idx, src)
def _segment_sum(src, seg, n):
    out = torch.zeros((n,) + src.shape[1:], dtype=src.dtype)
    return out.index_add_(0, seg, src)
def _pad(x, pw):
    flat = tuple(v for pair in reversed(pw) for v in pair)
    return torch.nn.functional.pad(x, flat)

kernel_name = 'interleave_layers__ssm_conv_s4d__dense_activation_silu__prompt'

def setup_inputs():

    _w = (lambda a: (lambda t: t.to(torch.bfloat16) if t.is_floating_point() else t)(torch.as_tensor(a)))
    def _A_setup():
        Bsz, L, D, N = 1, 2048, 512, 128
        return {
            "u": _w((lambda *s: torch.randn(*s, dtype=torch.bfloat16) * 0.05)(Bsz, L, D)),
            "log_A_real": _w((lambda *s: torch.randn(*s, dtype=torch.bfloat16) * 3.2)(D, N) * 0.5),
            "A_imag": _w((lambda *s: torch.randn(*s, dtype=torch.bfloat16) * 0.05)(D, N) * 3.14),
            "C_real": _w((lambda *s: torch.randn(*s, dtype=torch.bfloat16) * 0.05)(D, N) / N ** 0.5),
            "C_imag": _w((lambda *s: torch.randn(*s, dtype=torch.bfloat16) * 0.05)(D, N) / N ** 0.5),
            "log_dt": _w((lambda *s: torch.randn(*s, dtype=torch.bfloat16) * 0.05)(D) * 0.5 - 4.0),
            "D_skip": _w((lambda *s: torch.randn(*s, dtype=torch.bfloat16) * 0.05)(D)),
        }
    _A_in = _A_setup()

    def _B_setup():
        B, S, D, F = 1, 2048, 512, 1792
        return {
            "x": _w((lambda *s: torch.randn(*s, dtype=torch.bfloat16) * 0.05)(B, S, D)),
            "w1": _w((lambda *s: torch.randn(*s, dtype=torch.bfloat16) * 0.8)(D, F) * (D ** -0.5)),
            "w2": _w((lambda *s: torch.randn(*s, dtype=torch.bfloat16) * 0.2)(F, D) * (F ** -0.5)),
        }
    _B_in = _B_setup()

    return {
        "A_u": _A_in["u"],
        "A_log_A_real": _A_in["log_A_real"],
        "A_A_imag": _A_in["A_imag"],
        "A_C_real": _A_in["C_real"],
        "A_C_imag": _A_in["C_imag"],
        "A_log_dt": _A_in["log_dt"],
        "A_D_skip": _A_in["D_skip"],
        "B_x": _B_in["x"],
        "B_w1": _B_in["w1"],
        "B_w2": _B_in["w2"],
    }

def reference(A_u, A_log_A_real, A_A_imag, A_C_real, A_C_imag, A_log_dt, A_D_skip, B_x, B_w1, B_w2):
    def _A_ref(u, log_A_real, A_imag, C_real, C_imag, log_dt, D_skip):
        L = u.shape[1]
        dt = torch.exp(log_dt)
        A = -torch.exp(log_A_real) + 1j * A_imag
        C = (C_real + 1j * C_imag) * dt[:, None]
        pos = (lambda x, dt: x.to(dt))(torch.arange(L), log_dt.dtype)
        P = torch.exp((A * dt[:, None])[:, :, None] * pos[None, None, :])
        K = 2.0 * torch.einsum("dn,dnl->dl", C, P).real
        L2 = 2 * L
        u_t = (lambda x, *d: x.permute(*d))(u, 0, 2, 1)
        Kf = (lambda x, *a, **k: torch.fft.rfft(x.float(), *a, **k))(K, L2)
        Uf = (lambda x, *a, **k: torch.fft.rfft(x.float(), *a, **k))(u_t, L2)
        y = (lambda x, *a, **k: torch.fft.irfft(x, *a, **k).to(torch.bfloat16))(Uf * Kf[None, :, :], L2)[:, :, :L]
        y = (lambda x, *d: x.permute(*d))(y, 0, 2, 1)
        return y + u * D_skip[None, None, :]

    def _B_ref(x, w1, w2):
        h = torch.einsum("bsd,df->bsf", x, w1)
        h = _silu(h)
        out = torch.einsum("bsf,fd->bsd", h, w2)
        return out

    x = A_u
    x = x + _A_ref(_layernorm(x, axis=-1), A_log_A_real, A_A_imag, A_C_real, A_C_imag, A_log_dt, A_D_skip)
    x = x + _B_ref(_layernorm(x, axis=-1), B_w1, B_w2)
    x = x + _A_ref(_layernorm(x, axis=-1), A_log_A_real, A_A_imag, A_C_real, A_C_imag, A_log_dt, A_D_skip)
    x = x + _B_ref(_layernorm(x, axis=-1), B_w1, B_w2)
    return x
```

```asm
; @launch grid=(256,1,1) block=(256,1,1) lds=163840
.amdgcn_target "amdgcn-amd-amdhsa--gfx950"
.text
.globl interleave_layers__ssm_conv_s4d__dense_activation_silu__prompt_kernel
.p2align 8
.type interleave_layers__ssm_conv_s4d__dense_activation_silu__prompt_kernel,@function
interleave_layers__ssm_conv_s4d__dense_activation_silu__prompt_kernel:
.Lkstart:
    s_cmp_ge_u32 s2, 256
    s_cbranch_scc1 .Ldone
    s_load_dwordx16 s[16:31], s[0:1], 0
    s_load_dwordx8 s[32:39], s[0:1], 64
    s_load_dwordx2 s[40:41], s[0:1], 96
    s_memrealtime s[14:15]
    s_getpc_b64 s[42:43]
.Lpc:
    v_and_b32 v1, 63, v0
    v_lshlrev_b32 v2, 4, v1
    v_lshrrev_b32 v3, 6, v0
    s_nop 0
    v_readfirstlane_b32 s60, v3
    s_and_b32 s3, s2, 7
    s_lshr_b32 s4, s2, 3
    s_lshl_b32 s5, s4, 2
    s_add_u32 s5, s5, s60
    s_min_u32 s5, s5, ((.Lkend-.Lkstart-128)>>10)-1
    s_lshl_b32 s5, s5, 10
    v_add_u32 v5, s5, v2
    s_mov_b32 s90, s5
    global_load_dwordx4 v[200:203], v5, s[42:43]
    s_lshl_b32 s61, s3, 5
    s_add_u32 s61, s61, s4
    s_lshl_b32 s5, s2, 13
    s_lshl_b32 s6, s60, 11
    s_add_u32 s5, s5, s6
    v_add_u32 v62, s5, v2
    s_lshl_b32 s5, s61, 9
    v_lshlrev_b32 v63, 1, v0
    v_add_u32 v63, s5, v63
    s_lshr_b32 s5, s2, 2
    s_lshl_b32 s5, s5, 15
    s_and_b32 s6, s2, 3
    s_lshl_b32 s6, s6, 8
    s_add_u32 s5, s5, s6
    s_lshl_b32 s6, s60, 6
    s_add_u32 s5, s5, s6
    v_and_b32 v5, 7, v1
    v_lshlrev_b32 v64, 12, v5
    v_lshrrev_b32 v6, 3, v1
    v_lshl_add_u32 v64, v6, 3, v64
    v_add_u32 v64, s5, v64
    s_waitcnt lgkmcnt(0)
    s_or_b32 s5, s4, s60
    s_cmp_lg_u32 s5, 0
    s_cbranch_scc1 .n0_1
    s_or_b32 s14, s14, 1
    v_mov_b32 v8, s14
    v_mov_b32 v9, 0
    s_mov_b64 exec, 1
    global_atomic_cmpswap v9, v[8:9], s[38:39] sc1
    s_mov_b64 exec, -1
.n0_1:
    global_load_dwordx2 v[216:217], v64, s[16:17] offset:0
    global_load_dwordx2 v[220:221], v64, s[16:17] offset:1024
    global_load_dwordx2 v[218:219], v64, s[16:17] offset:2048
    global_load_dwordx2 v[222:223], v64, s[16:17] offset:3072
    global_load_dwordx4 v[32:35], v62, s[16:17]
    global_load_dwordx4 v[36:39], v62, s[16:17] offset:1024
    global_load_ushort v48, v63, s[18:19]
    global_load_ushort v49, v63, s[20:21]
    global_load_ushort v50, v63, s[22:23]
    global_load_ushort v51, v63, s[24:25]
    s_and_b32 s63, s4, 15
    s_lshl_b32 s62, s3, 1
    s_lshr_b32 s5, s4, 4
    s_add_u32 s62, s62, s5
    s_lshl_b32 s64, s62, 1
    s_bfe_u32 s5, s4, 0x10003
    s_add_u32 s64, s64, s5
    s_and_b32 s65, s4, 7
    s_lshl_b32 s67, s62, 10
    s_add_u32 s67, s67, 196608
    s_lshl_b32 s5, s60, 8
    s_add_u32 s82, s67, s5
    s_mov_b32 s70, 0x3f803f80
    s_mov_b32 s71, 0xffff0000
    s_mov_b32 s72, 0x3b000000
    s_mov_b32 s73, 0x3b000000
    s_mov_b32 s74, 0x3727c5ac
    s_mov_b32 s75, 0xbfb8aa3b
    s_lshl_b32 s5, s60, 1
    s_lshl_b32 s76, 3, s5
    s_mov_b32 s77, 0
    s_lshl_b32 s5, s60, 2
    s_lshl_b32 s92, 0x000f000f, s5
    s_mov_b32 s93, s92
    v_and_b32 v5, 7, v1
    v_lshrrev_b32 v6, 3, v1
    v_lshrrev_b32 v65, 2, v1
    v_lshlrev_b32 v65, 10, v65
    v_and_b32 v66, 3, v1
    v_lshl_add_u32 v65, v66, 4, v65
    v_lshlrev_b32 v207, 9, v6
    v_lshl_add_u32 v207, v5, 4, v207
    s_lshl_b32 s94, s2, 2
    s_add_u32 s94, s94, s60
    s_min_u32 s94, s94, 895
    s_mul_i32 s95, s94, 2341
    s_lshr_b32 s95, s95, 16
    s_mul_i32 s5, s95, 28
    s_sub_u32 s96, s94, s5
    s_and_b32 s5, s95, 3
    s_mul_i32 s5, s5, 448
    s_lshr_b32 s6, s96, 1
    s_lshl_b32 s6, s6, 5
    s_add_u32 s5, s5, s6
    s_lshl_b32 s7, s5, 10
    s_lshr_b32 s5, s95, 2
    s_lshl_b32 s5, s5, 7
    s_add_u32 s7, s7, s5
    s_lshr_b32 s5, s95, 1
    s_xor_b32 s5, s5, s96
    s_and_b32 s5, s5, 1
    s_lshl_b32 s5, s5, 6
    s_add_u32 s7, s7, s5
    s_lshl_b32 s9, s60, 12
    s_add_u32 s9, s9, 114688
    s_mov_b32 s46, 0x2000000
    s_mov_b32 s47, 0x20000
    s_mov_b32 s44, s40
    s_mov_b32 s45, s41
    s_cmp_ge_u32 s2, 128
    s_cbranch_scc1 .n1_2
    s_lshl_b32 s5, s2, 2
    s_add_u32 s5, s5, s60
    s_lshl_b32 s6, s5, 9
    s_lshl_b32 s5, s5, 5
    s_add_u32 s5, s5, 540672
    v_mov_b32 v4, 0
    v_mov_b32 v5, 0
    v_lshlrev_b32 v6, 3, v1
    v_lshlrev_b32 v8, 2, v1
    buffer_store_dwordx2 v[4:5], v6, s[44:47], s6 offen sc1
    s_mov_b64 exec, 0xff
    buffer_store_dword v5, v8, s[44:47], s5 offen sc1
    s_mov_b64 exec, -1
.n1_2:
    s_mov_b32 s48, s32
    s_mov_b32 s49, s33
    s_mov_b32 s50, 0x1c0000
    s_mov_b32 s51, 0x20000
    s_mov_b32 s52, s34
    s_mov_b32 s53, s35
    s_mov_b32 s54, 0x1c0000
    s_mov_b32 s55, 0x20000
    s_mov_b32 s56, s36
    s_mov_b32 s57, s37
    s_mov_b32 s58, 0x200000
    s_mov_b32 s59, 0x20000
    s_mov_b32 m0, s9
    s_add_u32 s5, s7, 16384
    buffer_load_dwordx4 v65, s[52:55], s7 offen lds
    s_add_u32 m0, s9, 1024
    s_nop 0
    buffer_load_dwordx4 v65, s[52:55], s5 offen lds
    s_lshl_b32 s5, s61, 2
    s_load_dword s12, s[26:27], s5
    s_load_dword s13, s[28:29], s5
    v_and_b32 v60, 15, v1
    v_lshrrev_b32 v61, 4, v1
    s_mul_i32 s88, s60, 458752
    s_mul_i32 s5, s63, 224
    s_add_u32 s88, s88, s5
    s_mul_i32 s89, s60, 28672
    s_lshr_b32 s5, s63, 2
    s_lshl_b32 s5, s5, 1
    s_and_b32 s6, s60, 1
    s_add_u32 s5, s5, s6
    s_lshl_b32 s5, s5, 7
    s_add_u32 s82, s67, s5
    s_lshl_b32 s5, s60, 1
    s_and_b32 s6, s64, 1
    s_add_u32 s5, s5, s6
    s_lshl_b32 s5, s5, 7
    s_add_u32 s91, s67, s5
    s_cmp_ge_u32 s61, 128
    s_cselect_b64 s[100:101], -1, 0
    s_cmp_ge_u32 s65, 4
    s_cselect_b64 s[86:87], -1, 0
    v_lshlrev_b32 v5, 3, v61
    v_bfe_u32 v6, v1, 2, 2
    v_add_u32 v5, v5, v6
    v_lshlrev_b32 v5, 6, v5
    v_and_b32 v62, 3, v1
    v_lshl_add_u32 v5, v62, 3, v5
    s_and_b32 s5, s95, 1
    s_lshl_b32 s5, s5, 5
    s_add_u32 s5, s5, s9
    v_add_u32 v209, s5, v5
    v_xor_b32 v210, 32, v209
    s_lshl_b32 s99, s94, 11
    s_add_u32 s99, s99, 1048576
    s_lshl_b32 s11, s4, 16
    s_bfe_u32 s6, s2, 0x10002
    s_lshl_b32 s6, s6, 7
    s_add_u32 s11, s11, s6
    s_and_b32 s6, s2, 3
    s_lshl_b32 s6, s6, 14
    s_add_u32 s11, s11, s6
    s_lshl_b32 s6, s60, 12
    s_add_u32 s11, s11, s6
    s_add_u32 s11, s11, 24117248
    s_and_b32 s7, s63, 1
    s_lshl_b32 s8, s7, 5
    s_mul_i32 s7, s7, 192
    s_sub_u32 s7, 192, s7
    v_and_b32 v64, 3, v1
    v_lshlrev_b32 v64, 4, v64
    v_add_u32 v65, s8, v64
    v_xor_b32 v66, 32, v64
    v_add_u32 v66, s8, v66
    v_add_u32 v66, 3392, v66
    v_and_b32 v67, 16, v64
    v_add_u32 v67, s7, v67
    v_lshrrev_b32 v64, 5, v64
    v_mul_u32_u24 v64, 3584, v64
    v_add_u32 v67, v67, v64
    v_subrev_u32 v67, 384, v67
    v_lshrrev_b32 v64, 2, v1
    v_add_u32 v5, 0, v64
    v_mul_u32_u24 v6, 9363, v5
    v_lshrrev_b32 v6, 16, v6
    v_mul_u32_u24 v62, 7, v6
    v_sub_u32 v5, v5, v62
    v_cmp_lt_u32 vcc, 2, v5
    v_mul_u32_u24 v6, 7168, v6
    v_lshl_add_u32 v6, v5, 6, v6
    v_cndmask_b32 v62, v65, v66, vcc
    v_cmp_eq_u32 vcc, 6, v5
    s_nop 1
    v_cndmask_b32 v62, v62, v67, vcc
    v_add_u32 v24, v6, v62
    v_add_u32 v5, 16, v64
    v_mul_u32_u24 v6, 9363, v5
    v_lshrrev_b32 v6, 16, v6
    v_mul_u32_u24 v62, 7, v6
    v_sub_u32 v5, v5, v62
    v_cmp_lt_u32 vcc, 2, v5
    v_mul_u32_u24 v6, 7168, v6
    v_lshl_add_u32 v6, v5, 6, v6
    v_cndmask_b32 v62, v65, v66, vcc
    v_cmp_eq_u32 vcc, 6, v5
    s_nop 1
    v_cndmask_b32 v62, v62, v67, vcc
    v_add_u32 v25, v6, v62
    v_add_u32 v5, 32, v64
    v_mul_u32_u24 v6, 9363, v5
    v_lshrrev_b32 v6, 16, v6
    v_mul_u32_u24 v62, 7, v6
    v_sub_u32 v5, v5, v62
    v_cmp_lt_u32 vcc, 2, v5
    v_mul_u32_u24 v6, 7168, v6
    v_lshl_add_u32 v6, v5, 6, v6
    v_cndmask_b32 v62, v65, v66, vcc
    v_cmp_eq_u32 vcc, 6, v5
    s_nop 1
    v_cndmask_b32 v62, v62, v67, vcc
    v_add_u32 v26, v6, v62
    v_add_u32 v5, 48, v64
    v_mul_u32_u24 v6, 9363, v5
    v_lshrrev_b32 v6, 16, v6
    v_mul_u32_u24 v62, 7, v6
    v_sub_u32 v5, v5, v62
    v_cmp_lt_u32 vcc, 2, v5
    v_mul_u32_u24 v6, 7168, v6
    v_lshl_add_u32 v6, v5, 6, v6
    v_cndmask_b32 v62, v65, v66, vcc
    v_cmp_eq_u32 vcc, 6, v5
    s_nop 1
    v_cndmask_b32 v62, v62, v67, vcc
    v_add_u32 v27, v6, v62
    v_add_u32 v5, 64, v64
    v_mul_u32_u24 v6, 9363, v5
    v_lshrrev_b32 v6, 16, v6
    v_mul_u32_u24 v62, 7, v6
    v_sub_u32 v5, v5, v62
    v_cmp_lt_u32 vcc, 2, v5
    v_mul_u32_u24 v6, 7168, v6
    v_lshl_add_u32 v6, v5, 6, v6
    v_cndmask_b32 v62, v65, v66, vcc
    v_cmp_eq_u32 vcc, 6, v5
    s_nop 1
    v_cndmask_b32 v62, v62, v67, vcc
    v_add_u32 v28, v6, v62
    v_add_u32 v5, 80, v64
    v_mul_u32_u24 v6, 9363, v5
    v_lshrrev_b32 v6, 16, v6
    v_mul_u32_u24 v62, 7, v6
    v_sub_u32 v5, v5, v62
    v_cmp_lt_u32 vcc, 2, v5
    v_mul_u32_u24 v6, 7168, v6
    v_lshl_add_u32 v6, v5, 6, v6
    v_cndmask_b32 v62, v65, v66, vcc
    v_cmp_eq_u32 vcc, 6, v5
    s_nop 1
    v_cndmask_b32 v62, v62, v67, vcc
    v_add_u32 v29, v6, v62
    v_add_u32 v5, 96, v64
    v_mul_u32_u24 v6, 9363, v5
    v_lshrrev_b32 v6, 16, v6
    v_mul_u32_u24 v62, 7, v6
    v_sub_u32 v5, v5, v62
    v_cmp_lt_u32 vcc, 2, v5
    v_mul_u32_u24 v6, 7168, v6
    v_lshl_add_u32 v6, v5, 6, v6
    v_cndmask_b32 v62, v65, v66, vcc
    v_cmp_eq_u32 vcc, 6, v5
    s_nop 1
    v_cndmask_b32 v62, v62, v67, vcc
    v_add_u32 v30, v6, v62
    s_and_b32 s5, s60, 1
    s_lshr_b32 s6, s60, 1
    v_bfe_u32 v8, v1, 2, 2
    v_lshlrev_b32 v8, 16, v8
    v_and_b32 v5, 3, v1
    v_lshl_add_u32 v8, v5, 6, v8
    v_lshl_add_u32 v8, v61, 4, v8
    s_lshl_b32 s7, s60, 18
    s_lshl_b32 s8, s61, 8
    s_add_u32 s7, s7, s8
    v_add_u32 v8, s7, v8
    v_lshlrev_b32 v9, 7, v60
    v_lshl_add_u32 v9, v61, 5, v9
    s_lshl_b32 s7, s60, 11
    v_add_u32 v9, s7, v9
    v_lshlrev_b32 v5, 5, v60
    v_lshl_add_u32 v10, v61, 3, v5
    s_lshl_b32 s7, s60, 9
    s_add_u32 s7, s7, 132224
    v_add_u32 v10, s7, v10
    v_lshl_add_u32 v11, v61, 4, v5
    s_mul_i32 s7, s6, 4608
    s_lshl_b32 s8, s5, 8
    s_sub_u32 s7, s7, s8
    s_add_u32 s7, s7, 131712
    v_add_u32 v11, s7, v11
    v_lshlrev_b32 v5, 3, v61
    v_sub_u32 v5, v60, v5
    v_lshlrev_b32 v5, 2, v5
    s_mul_i32 s7, s6, 8256
    s_lshl_b32 s8, s5, 9
    s_add_u32 s7, s7, s8
    s_add_u32 s7, s7, 114792
    v_add_u32 v12, s7, v5
    s_lshl_b32 s7, s60, 10
    s_add_u32 s7, s7, 140928
    v_add_u32 v13, s7, v2
    s_lshl_b32 s7, s60, 12
    s_add_u32 s7, s7, 140928
    v_add_u32 v14, s7, v2
    v_and_b32 v204, 7, v1
    v_lshlrev_b32 v204, 8, v204
    s_and_b32 s7, s3, 7
    s_lshl_b32 s7, s7, 12
    v_add_u32 v204, s7, v204
    v_lshlrev_b32 v205, 12, v1
    s_and_b32 s7, s63, 7
    s_lshl_b32 s7, s7, 8
    v_add_u32 v205, s7, v205
    v_mov_b32 v4, 1
    v_lshlrev_b32 v5, 3, v0
    v_add_u32 v5, -1, v5
    v_max_i32 v5, 0, v5
    v_cvt_f32_u32 v5, v5
    v_cvt_pk_bf16_f32 v5, 0, v5
    v_cvt_u32_f32 v6, v5
    v_lshrrev_b32 v5, 23, v5
    v_subrev_u32 v5, 134, v5
    v_med3_i32 v5, v5, 0, 3
    v_lshrrev_b32 v62, 7, v6
    v_and_b32 v63, 7, v6
    v_lshl_or_b32 v62, v62, 3, v63
    v_lshrrev_b32 v62, v5, v62
    v_lshl_add_u32 v62, v5, 3, v62
    v_bfe_u32 v6, v6, 3, 4
    v_lshlrev_b32 v6, 2, v6
    v_lshl_add_u32 v6, v62, 6, v6
    v_add_u32 v100, 140928, v6
    v_lshlrev_b32 v5, 3, v0
    v_add_u32 v5, 0, v5
    v_cvt_f32_u32 v5, v5
    v_cvt_pk_bf16_f32 v5, 0, v5
    v_cvt_u32_f32 v6, v5
    v_lshrrev_b32 v5, 23, v5
    v_subrev_u32 v5, 134, v5
    v_med3_i32 v5, v5, 0, 3
    v_lshrrev_b32 v62, 7, v6
    v_and_b32 v63, 7, v6
    v_lshl_or_b32 v62, v62, 3, v63
    v_lshrrev_b32 v62, v5, v62
    v_lshl_add_u32 v62, v5, 3, v62
    v_bfe_u32 v6, v6, 3, 4
    v_lshlrev_b32 v6, 2, v6
    v_lshl_add_u32 v6, v62, 6, v6
    v_add_u32 v101, 140928, v6
    v_lshlrev_b32 v5, 3, v0
    v_add_u32 v5, 1, v5
    v_cvt_f32_u32 v5, v5
    v_cvt_pk_bf16_f32 v5, 0, v5
    v_cvt_u32_f32 v6, v5
    v_lshrrev_b32 v5, 23, v5
    v_subrev_u32 v5, 134, v5
    v_med3_i32 v5, v5, 0, 3
    v_lshrrev_b32 v62, 7, v6
    v_and_b32 v63, 7, v6
    v_lshl_or_b32 v62, v62, 3, v63
    v_lshrrev_b32 v62, v5, v62
    v_lshl_add_u32 v62, v5, 3, v62
    v_bfe_u32 v6, v6, 3, 4
    v_lshlrev_b32 v6, 2, v6
    v_lshl_add_u32 v6, v62, 6, v6
    v_add_u32 v102, 140928, v6
    v_lshlrev_b32 v5, 3, v0
    v_add_u32 v5, 2, v5
    v_cvt_f32_u32 v5, v5
    v_cvt_pk_bf16_f32 v5, 0, v5
    v_cvt_u32_f32 v6, v5
    v_lshrrev_b32 v5, 23, v5
    v_subrev_u32 v5, 134, v5
    v_med3_i32 v5, v5, 0, 3
    v_lshrrev_b32 v62, 7, v6
    v_and_b32 v63, 7, v6
    v_lshl_or_b32 v62, v62, 3, v63
    v_lshrrev_b32 v62, v5, v62
    v_lshl_add_u32 v62, v5, 3, v62
    v_bfe_u32 v6, v6, 3, 4
    v_lshlrev_b32 v6, 2, v6
    v_lshl_add_u32 v6, v62, 6, v6
    v_add_u32 v103, 140928, v6
    v_lshlrev_b32 v5, 3, v0
    v_add_u32 v5, 3, v5
    v_cvt_f32_u32 v5, v5
    v_cvt_pk_bf16_f32 v5, 0, v5
    v_cvt_u32_f32 v6, v5
    v_lshrrev_b32 v5, 23, v5
    v_subrev_u32 v5, 134, v5
    v_med3_i32 v5, v5, 0, 3
    v_lshrrev_b32 v62, 7, v6
    v_and_b32 v63, 7, v6
    v_lshl_or_b32 v62, v62, 3, v63
    v_lshrrev_b32 v62, v5, v62
    v_lshl_add_u32 v62, v5, 3, v62
    v_bfe_u32 v6, v6, 3, 4
    v_lshlrev_b32 v6, 2, v6
    v_lshl_add_u32 v6, v62, 6, v6
    v_add_u32 v104, 140928, v6
    v_lshlrev_b32 v5, 3, v0
    v_add_u32 v5, 4, v5
    v_cvt_f32_u32 v5, v5
    v_cvt_pk_bf16_f32 v5, 0, v5
    v_cvt_u32_f32 v6, v5
    v_lshrrev_b32 v5, 23, v5
    v_subrev_u32 v5, 134, v5
    v_med3_i32 v5, v5, 0, 3
    v_lshrrev_b32 v62, 7, v6
    v_and_b32 v63, 7, v6
    v_lshl_or_b32 v62, v62, 3, v63
    v_lshrrev_b32 v62, v5, v62
    v_lshl_add_u32 v62, v5, 3, v62
    v_bfe_u32 v6, v6, 3, 4
    v_lshlrev_b32 v6, 2, v6
    v_lshl_add_u32 v6, v62, 6, v6
    v_add_u32 v105, 140928, v6
    v_lshlrev_b32 v5, 3, v0
    v_add_u32 v5, 5, v5
    v_cvt_f32_u32 v5, v5
    v_cvt_pk_bf16_f32 v5, 0, v5
    v_cvt_u32_f32 v6, v5
    v_lshrrev_b32 v5, 23, v5
    v_subrev_u32 v5, 134, v5
    v_med3_i32 v5, v5, 0, 3
    v_lshrrev_b32 v62, 7, v6
    v_and_b32 v63, 7, v6
    v_lshl_or_b32 v62, v62, 3, v63
    v_lshrrev_b32 v62, v5, v62
    v_lshl_add_u32 v62, v5, 3, v62
    v_bfe_u32 v6, v6, 3, 4
    v_lshlrev_b32 v6, 2, v6
    v_lshl_add_u32 v6, v62, 6, v6
    v_add_u32 v106, 140928, v6
    v_lshlrev_b32 v5, 3, v0
    v_add_u32 v5, 6, v5
    v_cvt_f32_u32 v5, v5
    v_cvt_pk_bf16_f32 v5, 0, v5
    v_cvt_u32_f32 v6, v5
    v_lshrrev_b32 v5, 23, v5
    v_subrev_u32 v5, 134, v5
    v_med3_i32 v5, v5, 0, 3
    v_lshrrev_b32 v62, 7, v6
    v_and_b32 v63, 7, v6
    v_lshl_or_b32 v62, v62, 3, v63
    v_lshrrev_b32 v62, v5, v62
    v_lshl_add_u32 v62, v5, 3, v62
    v_bfe_u32 v6, v6, 3, 4
    v_lshlrev_b32 v6, 2, v6
    v_lshl_add_u32 v6, v62, 6, v6
    v_add_u32 v107, 140928, v6
    v_lshlrev_b32 v5, 3, v0
    v_add_u32 v5, 7, v5
    v_cvt_f32_u32 v5, v5
    v_cvt_pk_bf16_f32 v5, 0, v5
    v_cvt_u32_f32 v6, v5
    v_lshrrev_b32 v5, 23, v5
    v_subrev_u32 v5, 134, v5
    v_med3_i32 v5, v5, 0, 3
    v_lshrrev_b32 v62, 7, v6
    v_and_b32 v63, 7, v6
    v_lshl_or_b32 v62, v62, 3, v63
    v_lshrrev_b32 v62, v5, v62
    v_lshl_add_u32 v62, v5, 3, v62
    v_bfe_u32 v6, v6, 3, 4
    v_lshlrev_b32 v6, 2, v6
    v_lshl_add_u32 v6, v62, 6, v6
    v_add_u32 v108, 140928, v6
    s_waitcnt vmcnt(6)
    v_swap_b32 v217, v220
    v_swap_b32 v219, v222
    buffer_store_dwordx4 v[216:219], v207, s[44:47], s11 offen sc1
    buffer_store_dwordx4 v[220:223], v207, s[44:47], s11 offen offset:256 sc1
    v_mov_b32 v52, 0
    v_mov_b32 v53, 0
    v_mov_b32 v54, 0
    v_mov_b32 v55, 0
    v_dot2c_f32_bf16 v52, s70, v32
    v_dot2c_f32_bf16 v53, v32, v32
    v_dot2c_f32_bf16 v54, s70, v36
    v_dot2c_f32_bf16 v55, v36, v36
    v_dot2c_f32_bf16 v52, s70, v33
    v_dot2c_f32_bf16 v53, v33, v33
    v_dot2c_f32_bf16 v54, s70, v37
    v_dot2c_f32_bf16 v55, v37, v37
    v_dot2c_f32_bf16 v52, s70, v34
    v_dot2c_f32_bf16 v53, v34, v34
    v_dot2c_f32_bf16 v54, s70, v38
    v_dot2c_f32_bf16 v55, v38, v38
    v_dot2c_f32_bf16 v52, s70, v35
    v_dot2c_f32_bf16 v53, v35, v35
    v_dot2c_f32_bf16 v54, s70, v39
    v_dot2c_f32_bf16 v55, v39, v39
    v_add_f32_dpp v52, v52, v52 quad_perm:[1,0,3,2] row_mask:0xf bank_mask:0xf
    v_add_f32_dpp v53, v53, v53 quad_perm:[1,0,3,2] row_mask:0xf bank_mask:0xf
    v_add_f32_dpp v54, v54, v54 quad_perm:[1,0,3,2] row_mask:0xf bank_mask:0xf
    v_add_f32_dpp v55, v55, v55 quad_perm:[1,0,3,2] row_mask:0xf bank_mask:0xf
    v_add_f32_dpp v52, v52, v52 quad_perm:[2,3,0,1] row_mask:0xf bank_mask:0xf
    v_add_f32_dpp v53, v53, v53 quad_perm:[2,3,0,1] row_mask:0xf bank_mask:0xf
    v_add_f32_dpp v54, v54, v54 quad_perm:[2,3,0,1] row_mask:0xf bank_mask:0xf
    v_add_f32_dpp v55, v55, v55 quad_perm:[2,3,0,1] row_mask:0xf bank_mask:0xf
    v_add_f32_dpp v52, v52, v52 row_half_mirror row_mask:0xf bank_mask:0xf
    v_add_f32_dpp v53, v53, v53 row_half_mirror row_mask:0xf bank_mask:0xf
    v_add_f32_dpp v54, v54, v54 row_half_mirror row_mask:0xf bank_mask:0xf
    v_add_f32_dpp v55, v55, v55 row_half_mirror row_mask:0xf bank_mask:0xf
    v_add_f32_dpp v52, v52, v52 row_mirror row_mask:0xf bank_mask:0xf
    v_add_f32_dpp v53, v53, v53 row_mirror row_mask:0xf bank_mask:0xf
    v_add_f32_dpp v54, v54, v54 row_mirror row_mask:0xf bank_mask:0xf
    v_add_f32_dpp v55, v55, v55 row_mirror row_mask:0xf bank_mask:0xf
    v_mov_b32 v56, v52
    v_mov_b32 v57, v53
    v_mov_b32 v58, v54
    v_mov_b32 v59, v55
    v_permlane16_swap_b32 v52, v56
    v_permlane16_swap_b32 v53, v57
    v_permlane16_swap_b32 v54, v58
    v_permlane16_swap_b32 v55, v59
    v_add_f32 v52, v52, v56
    v_add_f32 v53, v53, v57
    v_add_f32 v54, v54, v58
    v_add_f32 v55, v55, v59
    v_mov_b32 v56, v52
    v_mov_b32 v57, v53
    v_mov_b32 v58, v54
    v_mov_b32 v59, v55
    v_permlane32_swap_b32 v52, v56
    v_permlane32_swap_b32 v53, v57
    v_permlane32_swap_b32 v54, v58
    v_permlane32_swap_b32 v55, v59
    v_add_f32 v52, v52, v56
    v_add_f32 v53, v53, v57
    v_add_f32 v54, v54, v58
    v_add_f32 v55, v55, v59
    v_pk_mul_f32 v[52:53], v[52:53], s[72:73]
    v_pk_mul_f32 v[54:55], v[54:55], s[72:73]
    v_fma_f32 v53, -v52, v52, v53
    v_fma_f32 v55, -v54, v54, v55
    v_cvt_pk_bf16_f32 v53, 0, v53
    v_cvt_pk_bf16_f32 v55, 0, v55
    v_add_f32 v53, s74, v53
    v_add_f32 v55, s74, v55
    v_cvt_pk_bf16_f32 v53, 0, v53
    v_cvt_pk_bf16_f32 v55, 0, v55
    v_sqrt_f32 v53, abs(v53)
    v_sqrt_f32 v55, abs(v55)
    v_cvt_pk_bf16_f32 v52, v52, v53
    v_cvt_pk_bf16_f32 v54, v54, v55
    s_lshl_b32 s5, s2, 6
    s_lshl_b32 s6, s60, 4
    s_add_u32 s5, s5, s6
    s_add_u32 s15, s5, 524288
    s_waitcnt lgkmcnt(0)
    s_load_dword s66, s[38:39], 0
    v_mov_b32 v212, v52
    v_mov_b32 v214, v54
    s_waitcnt vmcnt(4)
    s_lshl_b32 s68, s13, 16
    s_and_b32 s69, s13, s71
    s_lshl_b32 s5, s12, 16
    s_and_b32 s6, s12, s71
    s_cmp_ge_u32 s60, 2
    s_cselect_b32 s5, s6, s5
    s_add_u32 m0, s89, 17408
    s_add_u32 s79, s88, 229376
    buffer_load_dwordx4 v27, s[48:51], s79 offen lds
    v_mov_b32 v5, s5
    v_mul_f32 v5, 0x3fb8aa3b, v5
    v_exp_f32 v5, v5
    v_lshlrev_b32 v48, 16, v48
    v_lshlrev_b32 v49, 16, v49
    v_lshlrev_b32 v50, 16, v50
    v_lshlrev_b32 v51, 16, v51
    v_mul_f32 v48, 0x3fb8aa3b, v48
    v_exp_f32 v48, v48
    s_mul_i32 s5, s60, 28672
    v_lshlrev_b32 v98, 2, v1
    v_add_u32 v98, s5, v98
    v_cvt_pk_bf16_f32 v5, 0, v5
    v_cvt_pk_bf16_f32 v48, 0, v48
    v_mul_f32 v49, v49, v5
    v_mul_f32 v48, v48, v5
    v_mul_f32 v49, 0.15915494, v49
    v_mul_f32 v48, s75, v48
    v_add_f32 v5, v5, v5
    v_mul_f32 v110, v50, v5
    v_mul_f32 v111, v51, v5
    v_mul_f32 v52, 0x3f800000, v48
    v_mul_f32 v56, 0x3f800000, v49
    v_mul_f32 v53, 0x41000000, v48
    v_mul_f32 v57, 0x41000000, v49
    v_mul_f32 v54, 0x43000000, v48
    v_mul_f32 v58, 0x43000000, v49
    v_mul_f32 v55, 0x44800000, v48
    v_mul_f32 v59, 0x44800000, v49
    v_exp_f32 v52, v52
    v_fract_f32 v56, v56
    s_add_u32 m0, s89, 18432
    s_add_u32 s79, s88, 229376
    buffer_load_dwordx4 v28, s[48:51], s79 offen lds
    v_exp_f32 v53, v53
    v_fract_f32 v57, v57
    v_exp_f32 v54, v54
    v_fract_f32 v58, v58
    v_exp_f32 v55, v55
    v_fract_f32 v59, v59
    v_cos_f32 v144, v56
    v_sin_f32 v145, v56
    v_cos_f32 v34, v57
    v_sin_f32 v35, v57
    v_cos_f32 v158, v58
    v_sin_f32 v159, v58
    v_cos_f32 v68, v59
    v_sin_f32 v69, v59
    v_mul_u32_u24 v99, 272, v60
    v_lshl_add_u32 v99, v61, 4, v99
    v_add_u32 v99, s5, v99
    v_mov_b32 v142, 1.0
    v_mov_b32 v143, 0
    v_mul_f32 v144, v144, v52
    v_mul_f32 v145, v145, v52
    v_mul_f32 v34, v34, v53
    v_mul_f32 v35, v35, v53
    v_mul_f32 v158, v158, v54
    v_mul_f32 v159, v159, v54
    v_mul_f32 v68, v68, v55
    v_mul_f32 v69, v69, v55
    v_cvt_pk_bf16_f32 v86, v110, -v111
    v_pk_mul_f32 v[112:113], v[110:111], v[34:35] op_sel_hi:[1,0]
    v_pk_mul_f32 v[146:147], v[144:145], v[144:145] op_sel_hi:[1,0]
    v_cvt_pk_bf16_f32 v87, v142, v143
    s_add_u32 m0, s89, 19456
    s_add_u32 s79, s88, 229376
    buffer_load_dwordx4 v29, s[48:51], s79 offen lds
    ds_write_b32 v98, v86 offset:0
    v_pk_mul_f32 v[174:175], v[158:159], v[158:159] op_sel_hi:[1,0]
    v_pk_mul_f32 v[36:37], v[34:35], v[34:35] op_sel_hi:[1,0]
    v_pk_mul_f32 v[84:85], v[68:69], v[68:69] op_sel_hi:[1,0]
    v_cvt_pk_bf16_f32 v88, v144, v145
    ds_write_b32 v98, v87 offset:4352
    v_pk_mul_f32 v[160:161], v[144:145], v[158:159] op_sel_hi:[1,0]
    v_pk_mul_f32 v[70:71], v[68:69], v[158:159] op_sel_hi:[1,0]
    v_cvt_pk_bf16_f32 v89, v158, v159
    ds_write_b32 v98, v88 offset:4624
    v_pk_fma_f32 v[112:113], v[110:111], v[34:35], v[112:113] op_sel:[1,1,0] op_sel_hi:[0,1,1] neg_lo:[1,0,0]
    v_pk_fma_f32 v[146:147], v[144:145], v[144:145], v[146:147] op_sel:[1,1,0] op_sel_hi:[0,1,1] neg_lo:[1,0,0]
    v_pk_fma_f32 v[174:175], v[158:159], v[158:159], v[174:175] op_sel:[1,1,0] op_sel_hi:[0,1,1] neg_lo:[1,0,0]
    v_cvt_pk_bf16_f32 v90, v68, v69
    ds_write_b32 v98, v89 offset:6528
    v_pk_fma_f32 v[36:37], v[34:35], v[34:35], v[36:37] op_sel:[1,1,0] op_sel_hi:[0,1,1] neg_lo:[1,0,0]
    v_pk_fma_f32 v[84:85], v[68:69], v[68:69], v[84:85] op_sel:[1,1,0] op_sel_hi:[0,1,1] neg_lo:[1,0,0]
    ds_write_b32 v98, v90 offset:13056
    v_pk_fma_f32 v[160:161], v[144:145], v[158:159], v[160:161] op_sel:[1,1,0] op_sel_hi:[0,1,1] neg_lo:[1,0,0]
    v_pk_fma_f32 v[70:71], v[68:69], v[158:159], v[70:71] op_sel:[1,1,0] op_sel_hi:[0,1,1] neg_lo:[1,0,0]
    v_cvt_pk_bf16_f32 v91, v112, -v113
    v_pk_mul_f32 v[38:39], v[36:37], v[36:37] op_sel_hi:[1,0]
    v_pk_mul_f32 v[150:151], v[146:147], v[146:147] op_sel_hi:[1,0]
    v_pk_mul_f32 v[190:191], v[174:175], v[174:175] op_sel_hi:[1,0]
    v_cvt_pk_bf16_f32 v92, v146, v147
    ds_write_b32 v98, v91 offset:272
    v_pk_mul_f32 v[114:115], v[110:111], v[36:37] op_sel_hi:[1,0]
    v_pk_mul_f32 v[116:117], v[112:113], v[36:37] op_sel_hi:[1,0]
    v_pk_mul_f32 v[148:149], v[146:147], v[144:145] op_sel_hi:[1,0]
    v_cvt_pk_bf16_f32 v93, v174, v175
    ds_write_b32 v98, v92 offset:4896
    s_add_u32 m0, s89, 20480
    s_add_u32 s79, s88, 229376
    buffer_load_dwordx4 v30, s[48:51], s79 offen lds
    v_pk_mul_f32 v[182:183], v[174:175], v[158:159] op_sel_hi:[1,0]
    v_pk_mul_f32 v[162:163], v[146:147], v[158:159] op_sel_hi:[1,0]
    v_pk_mul_f32 v[72:73], v[68:69], v[174:175] op_sel_hi:[1,0]
    v_cvt_pk_bf16_f32 v94, v84, v85
    ds_write_b32 v98, v93 offset:8704
    v_pk_mul_f32 v[176:177], v[174:175], v[146:147] op_sel_hi:[1,0]
    v_pk_fma_f32 v[38:39], v[36:37], v[36:37], v[38:39] op_sel:[1,1,0] op_sel_hi:[0,1,1] neg_lo:[1,0,0]
    v_pk_fma_f32 v[150:151], v[146:147], v[146:147], v[150:151] op_sel:[1,1,0] op_sel_hi:[0,1,1] neg_lo:[1,0,0]
    v_cvt_pk_bf16_f32 v95, v160, v161
    s_waitcnt lgkmcnt(0)
    s_cmp_eq_u32 s66, 0
    s_cbranch_scc1 .nn_3
.nb_5:
    v_mov_b32 v213, s66
    v_mov_b32 v215, s66
    s_waitcnt vmcnt(4)
    s_barrier
    s_mov_b64 exec, 1
    buffer_store_dwordx4 v[212:215], off, s[44:47], s15 sc1
    s_mov_b64 exec, -1
    ds_read_b64_tr_b16 v[224:225], v209 offset:0
    ds_read_b64_tr_b16 v[226:227], v209 offset:256
    ds_read_b64_tr_b16 v[228:229], v210 offset:0
    ds_read_b64_tr_b16 v[230:231], v210 offset:256
    s_waitcnt lgkmcnt(0)
    s_cmp_ge_u32 s2, 224
    s_cbranch_scc1 .n3_6
    buffer_store_dwordx4 v[224:227], v2, s[44:47], s99 offen sc1
    buffer_store_dwordx4 v[228:231], v2, s[44:47], s99 offen offset:1024 sc1
.n3_6:
    ds_write_b32 v98, v94 offset:15232
    v_pk_fma_f32 v[190:191], v[174:175], v[174:175], v[190:191] op_sel:[1,1,0] op_sel_hi:[0,1,1] neg_lo:[1,0,0]
    v_pk_fma_f32 v[114:115], v[110:111], v[36:37], v[114:115] op_sel:[1,1,0] op_sel_hi:[0,1,1] neg_lo:[1,0,0]
    v_pk_fma_f32 v[116:117], v[112:113], v[36:37], v[116:117] op_sel:[1,1,0] op_sel_hi:[0,1,1] neg_lo:[1,0,0]
    v_cvt_pk_bf16_f32 v96, v70, v71
    ds_write_b32 v98, v95 offset:6800
    v_pk_fma_f32 v[148:149], v[146:147], v[144:145], v[148:149] op_sel:[1,1,0] op_sel_hi:[0,1,1] neg_lo:[1,0,0]
    v_pk_fma_f32 v[182:183], v[174:175], v[158:159], v[182:183] op_sel:[1,1,0] op_sel_hi:[0,1,1] neg_lo:[1,0,0]
    v_pk_fma_f32 v[162:163], v[146:147], v[158:159], v[162:163] op_sel:[1,1,0] op_sel_hi:[0,1,1] neg_lo:[1,0,0]
    ds_write_b32 v98, v96 offset:13328
    v_pk_fma_f32 v[72:73], v[68:69], v[174:175], v[72:73] op_sel:[1,1,0] op_sel_hi:[0,1,1] neg_lo:[1,0,0]
    v_pk_fma_f32 v[176:177], v[174:175], v[146:147], v[176:177] op_sel:[1,1,0] op_sel_hi:[0,1,1] neg_lo:[1,0,0]
    s_add_u32 m0, s89, 21504
    s_add_u32 s79, s88, 344064
    buffer_load_dwordx4 v24, s[48:51], s79 offen lds
    v_cvt_pk_bf16_f32 v97, v150, v151
    v_pk_mul_f32 v[32:33], v[38:39], v[38:39] op_sel_hi:[1,0]
    v_pk_mul_f32 v[118:119], v[110:111], v[38:39] op_sel_hi:[1,0]
    v_pk_mul_f32 v[120:121], v[112:113], v[38:39] op_sel_hi:[1,0]
    v_cvt_pk_bf16_f32 v86, v190, v191
    ds_write_b32 v98, v97 offset:5440
    v_pk_mul_f32 v[122:123], v[114:115], v[38:39] op_sel_hi:[1,0]
    v_pk_mul_f32 v[124:125], v[116:117], v[38:39] op_sel_hi:[1,0]
    v_pk_mul_f32 v[152:153], v[150:151], v[144:145] op_sel_hi:[1,0]
    v_pk_mul_f32 v[154:155], v[150:151], v[146:147] op_sel_hi:[1,0]
    v_cvt_pk_bf16_f32 v87, v114, -v115
    ds_write_b32 v98, v86 offset:10880
    v_pk_mul_f32 v[156:157], v[150:151], v[148:149] op_sel_hi:[1,0]
    v_pk_mul_f32 v[194:195], v[190:191], v[158:159] op_sel_hi:[1,0]
    v_pk_mul_f32 v[198:199], v[190:191], v[174:175] op_sel_hi:[1,0]
    v_pk_mul_f32 v[64:65], v[190:191], v[182:183] op_sel_hi:[1,0]
    v_cvt_pk_bf16_f32 v88, v116, -v117
    ds_write_b32 v98, v87 offset:544
    v_pk_mul_f32 v[164:165], v[148:149], v[158:159] op_sel_hi:[1,0]
    v_pk_mul_f32 v[166:167], v[150:151], v[158:159] op_sel_hi:[1,0]
    v_pk_mul_f32 v[74:75], v[68:69], v[182:183] op_sel_hi:[1,0]
    v_pk_mul_f32 v[76:77], v[68:69], v[190:191] op_sel_hi:[1,0]
    v_cvt_pk_bf16_f32 v89, v148, v149
    ds_write_b32 v98, v88 offset:816
    v_pk_mul_f32 v[178:179], v[174:175], v[150:151] op_sel_hi:[1,0]
    v_pk_mul_f32 v[184:185], v[182:183], v[146:147] op_sel_hi:[1,0]
    v_pk_mul_f32 v[186:187], v[182:183], v[150:151] op_sel_hi:[1,0]
    v_pk_mul_f32 v[192:193], v[190:191], v[150:151] op_sel_hi:[1,0]
    v_cvt_pk_bf16_f32 v90, v182, v183
    ds_write_b32 v98, v89 offset:5168
    v_pk_fma_f32 v[32:33], v[38:39], v[38:39], v[32:33] op_sel:[1,1,0] op_sel_hi:[0,1,1] neg_lo:[1,0,0]
    s_add_u32 m0, s89, 22528
    s_add_u32 s79, s88, 344064
    buffer_load_dwordx4 v25, s[48:51], s79 offen lds
    v_pk_fma_f32 v[118:119], v[110:111], v[38:39], v[118:119] op_sel:[1,1,0] op_sel_hi:[0,1,1] neg_lo:[1,0,0]
    v_pk_fma_f32 v[120:121], v[112:113], v[38:39], v[120:121] op_sel:[1,1,0] op_sel_hi:[0,1,1] neg_lo:[1,0,0]
    v_pk_fma_f32 v[122:123], v[114:115], v[38:39], v[122:123] op_sel:[1,1,0] op_sel_hi:[0,1,1] neg_lo:[1,0,0]
    v_cvt_pk_bf16_f32 v91, v162, v163
    ds_write_b32 v98, v90 offset:9792
    v_pk_fma_f32 v[124:125], v[116:117], v[38:39], v[124:125] op_sel:[1,1,0] op_sel_hi:[0,1,1] neg_lo:[1,0,0]
    v_pk_fma_f32 v[152:153], v[150:151], v[144:145], v[152:153] op_sel:[1,1,0] op_sel_hi:[0,1,1] neg_lo:[1,0,0]
    v_pk_fma_f32 v[154:155], v[150:151], v[146:147], v[154:155] op_sel:[1,1,0] op_sel_hi:[0,1,1] neg_lo:[1,0,0]
    v_pk_fma_f32 v[156:157], v[150:151], v[148:149], v[156:157] op_sel:[1,1,0] op_sel_hi:[0,1,1] neg_lo:[1,0,0]
    v_cvt_pk_bf16_f32 v92, v72, v73
    ds_write_b32 v98, v91 offset:7072
    v_pk_fma_f32 v[194:195], v[190:191], v[158:159], v[194:195] op_sel:[1,1,0] op_sel_hi:[0,1,1] neg_lo:[1,0,0]
    v_pk_fma_f32 v[198:199], v[190:191], v[174:175], v[198:199] op_sel:[1,1,0] op_sel_hi:[0,1,1] neg_lo:[1,0,0]
    v_pk_fma_f32 v[64:65], v[190:191], v[182:183], v[64:65] op_sel:[1,1,0] op_sel_hi:[0,1,1] neg_lo:[1,0,0]
    v_pk_fma_f32 v[164:165], v[148:149], v[158:159], v[164:165] op_sel:[1,1,0] op_sel_hi:[0,1,1] neg_lo:[1,0,0]
    v_cvt_pk_bf16_f32 v93, v176, v177
    ds_write_b32 v98, v92 offset:13600
    v_pk_fma_f32 v[166:167], v[150:151], v[158:159], v[166:167] op_sel:[1,1,0] op_sel_hi:[0,1,1] neg_lo:[1,0,0]
    v_pk_fma_f32 v[74:75], v[68:69], v[182:183], v[74:75] op_sel:[1,1,0] op_sel_hi:[0,1,1] neg_lo:[1,0,0]
    v_pk_fma_f32 v[76:77], v[68:69], v[190:191], v[76:77] op_sel:[1,1,0] op_sel_hi:[0,1,1] neg_lo:[1,0,0]
    v_pk_fma_f32 v[178:179], v[174:175], v[150:151], v[178:179] op_sel:[1,1,0] op_sel_hi:[0,1,1] neg_lo:[1,0,0]
    ds_write_b32 v98, v93 offset:8976
    v_pk_fma_f32 v[184:185], v[182:183], v[146:147], v[184:185] op_sel:[1,1,0] op_sel_hi:[0,1,1] neg_lo:[1,0,0]
    v_pk_fma_f32 v[186:187], v[182:183], v[150:151], v[186:187] op_sel:[1,1,0] op_sel_hi:[0,1,1] neg_lo:[1,0,0]
    v_pk_fma_f32 v[192:193], v[190:191], v[150:151], v[192:193] op_sel:[1,1,0] op_sel_hi:[0,1,1] neg_lo:[1,0,0]
    v_cvt_pk_bf16_f32 v94, v118, -v119
    v_pk_mul_f32 v[126:127], v[110:111], v[32:33] op_sel_hi:[1,0]
    v_pk_mul_f32 v[128:129], v[112:113], v[32:33] op_sel_hi:[1,0]
    v_cvt_pk_bf16_f32 v95, v120, -v121
    ds_write_b32 v98, v94 offset:1088
    v_pk_mul_f32 v[130:131], v[114:115], v[32:33] op_sel_hi:[1,0]
    s_add_u32 m0, s89, 23552
    s_add_u32 s79, s88, 344064
    buffer_load_dwordx4 v26, s[48:51], s79 offen lds
    v_pk_mul_f32 v[132:133], v[116:117], v[32:33] op_sel_hi:[1,0]
    v_cvt_pk_bf16_f32 v96, v122, -v123
    ds_write_b32 v98, v95 offset:1360
    v_pk_mul_f32 v[134:135], v[118:119], v[32:33] op_sel_hi:[1,0]
    v_pk_mul_f32 v[136:137], v[120:121], v[32:33] op_sel_hi:[1,0]
    v_cvt_pk_bf16_f32 v97, v124, -v125
    ds_write_b32 v98, v96 offset:1632
    v_pk_mul_f32 v[138:139], v[122:123], v[32:33] op_sel_hi:[1,0]
    v_pk_mul_f32 v[140:141], v[124:125], v[32:33] op_sel_hi:[1,0]
    v_cvt_pk_bf16_f32 v86, v152, v153
    ds_write_b32 v98, v97 offset:1904
    v_pk_mul_f32 v[168:169], v[152:153], v[158:159] op_sel_hi:[1,0]
    v_pk_mul_f32 v[170:171], v[154:155], v[158:159] op_sel_hi:[1,0]
    v_cvt_pk_bf16_f32 v87, v154, v155
    ds_write_b32 v98, v86 offset:5712
    v_pk_mul_f32 v[172:173], v[156:157], v[158:159] op_sel_hi:[1,0]
    v_pk_mul_f32 v[180:181], v[174:175], v[154:155] op_sel_hi:[1,0]
    v_cvt_pk_bf16_f32 v88, v156, v157
    ds_write_b32 v98, v87 offset:5984
    v_pk_mul_f32 v[188:189], v[182:183], v[154:155] op_sel_hi:[1,0]
    v_pk_mul_f32 v[196:197], v[194:195], v[150:151] op_sel_hi:[1,0]
    v_cvt_pk_bf16_f32 v89, v194, v195
    ds_write_b32 v98, v88 offset:6256
    v_pk_mul_f32 v[62:63], v[198:199], v[150:151] op_sel_hi:[1,0]
    v_pk_mul_f32 v[66:67], v[64:65], v[150:151] op_sel_hi:[1,0]
    v_cvt_pk_bf16_f32 v90, v198, v199
    ds_write_b32 v98, v89 offset:11424
    v_pk_mul_f32 v[78:79], v[68:69], v[194:195] op_sel_hi:[1,0]
    v_pk_mul_f32 v[80:81], v[68:69], v[198:199] op_sel_hi:[1,0]
    v_cvt_pk_bf16_f32 v91, v64, v65
    ds_write_b32 v98, v90 offset:11968
    s_add_u32 m0, s89, 24576
    s_add_u32 s79, s88, 344064
    buffer_load_dwordx4 v27, s[48:51], s79 offen lds
    v_pk_mul_f32 v[82:83], v[68:69], v[64:65] op_sel_hi:[1,0]
    v_pk_fma_f32 v[126:127], v[110:111], v[32:33], v[126:127] op_sel:[1,1,0] op_sel_hi:[0,1,1] neg_lo:[1,0,0]
    v_cvt_pk_bf16_f32 v92, v164, v165
    ds_write_b32 v98, v91 offset:12512
    v_pk_fma_f32 v[128:129], v[112:113], v[32:33], v[128:129] op_sel:[1,1,0] op_sel_hi:[0,1,1] neg_lo:[1,0,0]
    v_pk_fma_f32 v[130:131], v[114:115], v[32:33], v[130:131] op_sel:[1,1,0] op_sel_hi:[0,1,1] neg_lo:[1,0,0]
    v_cvt_pk_bf16_f32 v93, v166, v167
    ds_write_b32 v98, v92 offset:7344
    v_pk_fma_f32 v[132:133], v[116:117], v[32:33], v[132:133] op_sel:[1,1,0] op_sel_hi:[0,1,1] neg_lo:[1,0,0]
    v_pk_fma_f32 v[134:135], v[118:119], v[32:33], v[134:135] op_sel:[1,1,0] op_sel_hi:[0,1,1] neg_lo:[1,0,0]
    v_cvt_pk_bf16_f32 v94, v74, v75
    ds_write_b32 v98, v93 offset:7616
    v_pk_fma_f32 v[136:137], v[120:121], v[32:33], v[136:137] op_sel:[1,1,0] op_sel_hi:[0,1,1] neg_lo:[1,0,0]
    v_pk_fma_f32 v[138:139], v[122:123], v[32:33], v[138:139] op_sel:[1,1,0] op_sel_hi:[0,1,1] neg_lo:[1,0,0]
    v_cvt_pk_bf16_f32 v95, v76, v77
    ds_write_b32 v98, v94 offset:13872
    v_pk_fma_f32 v[140:141], v[124:125], v[32:33], v[140:141] op_sel:[1,1,0] op_sel_hi:[0,1,1] neg_lo:[1,0,0]
    v_pk_fma_f32 v[168:169], v[152:153], v[158:159], v[168:169] op_sel:[1,1,0] op_sel_hi:[0,1,1] neg_lo:[1,0,0]
    v_cvt_pk_bf16_f32 v96, v178, v179
    ds_write_b32 v98, v95 offset:14144
    v_pk_fma_f32 v[170:171], v[154:155], v[158:159], v[170:171] op_sel:[1,1,0] op_sel_hi:[0,1,1] neg_lo:[1,0,0]
    v_pk_fma_f32 v[172:173], v[156:157], v[158:159], v[172:173] op_sel:[1,1,0] op_sel_hi:[0,1,1] neg_lo:[1,0,0]
    v_cvt_pk_bf16_f32 v97, v184, v185
    ds_write_b32 v98, v96 offset:9248
    v_pk_fma_f32 v[180:181], v[174:175], v[154:155], v[180:181] op_sel:[1,1,0] op_sel_hi:[0,1,1] neg_lo:[1,0,0]
    v_pk_fma_f32 v[188:189], v[182:183], v[154:155], v[188:189] op_sel:[1,1,0] op_sel_hi:[0,1,1] neg_lo:[1,0,0]
    v_cvt_pk_bf16_f32 v86, v186, v187
    ds_write_b32 v98, v97 offset:10064
    v_pk_fma_f32 v[196:197], v[194:195], v[150:151], v[196:197] op_sel:[1,1,0] op_sel_hi:[0,1,1] neg_lo:[1,0,0]
    v_pk_fma_f32 v[62:63], v[198:199], v[150:151], v[62:63] op_sel:[1,1,0] op_sel_hi:[0,1,1] neg_lo:[1,0,0]
    v_cvt_pk_bf16_f32 v87, v192, v193
    s_add_u32 m0, s89, 25600
    s_add_u32 s79, s88, 344064
    buffer_load_dwordx4 v28, s[48:51], s79 offen lds
    ds_write_b32 v98, v86 offset:10336
    v_pk_fma_f32 v[66:67], v[64:65], v[150:151], v[66:67] op_sel:[1,1,0] op_sel_hi:[0,1,1] neg_lo:[1,0,0]
    v_pk_fma_f32 v[78:79], v[68:69], v[194:195], v[78:79] op_sel:[1,1,0] op_sel_hi:[0,1,1] neg_lo:[1,0,0]
    ds_write_b32 v98, v87 offset:11152
    v_pk_fma_f32 v[80:81], v[68:69], v[198:199], v[80:81] op_sel:[1,1,0] op_sel_hi:[0,1,1] neg_lo:[1,0,0]
    v_pk_fma_f32 v[82:83], v[68:69], v[64:65], v[82:83] op_sel:[1,1,0] op_sel_hi:[0,1,1] neg_lo:[1,0,0]
    v_cvt_pk_bf16_f32 v88, v126, -v127
    v_cvt_pk_bf16_f32 v89, v128, -v129
    ds_write_b32 v98, v88 offset:2176
    v_cvt_pk_bf16_f32 v90, v130, -v131
    ds_write_b32 v98, v89 offset:2448
    v_cvt_pk_bf16_f32 v91, v132, -v133
    ds_write_b32 v98, v90 offset:2720
    v_cvt_pk_bf16_f32 v92, v134, -v135
    ds_write_b32 v98, v91 offset:2992
    v_cvt_pk_bf16_f32 v93, v136, -v137
    ds_write_b32 v98, v92 offset:3264
    v_cvt_pk_bf16_f32 v94, v138, -v139
    ds_write_b32 v98, v93 offset:3536
    v_cvt_pk_bf16_f32 v95, v140, -v141
    ds_write_b32 v98, v94 offset:3808
    v_cvt_pk_bf16_f32 v96, v168, v169
    ds_write_b32 v98, v95 offset:4080
    v_cvt_pk_bf16_f32 v97, v170, v171
    ds_write_b32 v98, v96 offset:7888
    v_cvt_pk_bf16_f32 v86, v172, v173
    ds_write_b32 v98, v97 offset:8160
    v_cvt_pk_bf16_f32 v87, v180, v181
    ds_write_b32 v98, v86 offset:8432
    v_cvt_pk_bf16_f32 v88, v188, v189
    ds_write_b32 v98, v87 offset:9520
    s_add_u32 m0, s89, 26624
    s_add_u32 s79, s88, 344064
    buffer_load_dwordx4 v29, s[48:51], s79 offen lds
    v_cvt_pk_bf16_f32 v89, v196, v197
    ds_write_b32 v98, v88 offset:10608
    v_cvt_pk_bf16_f32 v90, v62, v63
    ds_write_b32 v98, v89 offset:11696
    v_cvt_pk_bf16_f32 v91, v66, v67
    ds_write_b32 v98, v90 offset:12240
    v_cvt_pk_bf16_f32 v92, v78, v79
    ds_write_b32 v98, v91 offset:12784
    v_cvt_pk_bf16_f32 v93, v80, v81
    ds_write_b32 v98, v92 offset:14416
    v_cvt_pk_bf16_f32 v94, v82, v83
    ds_write_b32 v98, v93 offset:14688
    ds_write_b32 v98, v94 offset:14960
    s_waitcnt lgkmcnt(0)
    ds_read_b128 v[110:113], v99 offset:0
    ds_read_b128 v[126:129], v99 offset:4352
    ds_read_b128 v[142:145], v99 offset:8704
    ds_read_b128 v[158:161], v99 offset:13056
    ds_read_b128 v[114:117], v99 offset:64
    ds_read_b128 v[130:133], v99 offset:4416
    ds_read_b128 v[146:149], v99 offset:8768
    ds_read_b128 v[162:165], v99 offset:13120
    ds_read_b128 v[118:121], v99 offset:128
    ds_read_b128 v[134:137], v99 offset:4480
    ds_read_b128 v[150:153], v99 offset:8832
    ds_read_b128 v[166:169], v99 offset:13184
    ds_read_b128 v[122:125], v99 offset:192
    ds_read_b128 v[138:141], v99 offset:4544
    ds_read_b128 v[154:157], v99 offset:8896
    ds_read_b128 v[170:173], v99 offset:13248
    s_mul_i32 s5, s60, 3072
    s_add_u32 m0, s89, 27648
    s_add_u32 s79, s88, 344064
    buffer_load_dwordx4 v30, s[48:51], s79 offen lds
    s_add_u32 s5, s5, 140928
    v_lshlrev_b32 v5, 2, v60
    v_lshl_add_u32 v5, v61, 8, v5
    v_add_u32 v5, s5, v5
    s_waitcnt lgkmcnt(12)
    v_mfma_f32_16x16x32_bf16 v[62:65], v[126:129], v[110:113], 0
    v_mfma_f32_16x16x32_bf16 v[66:69], v[142:145], v[110:113], 0
    v_mfma_f32_16x16x32_bf16 v[70:73], v[158:161], v[110:113], 0
    s_waitcnt lgkmcnt(8)
    v_mfma_f32_16x16x32_bf16 v[62:65], v[130:133], v[114:117], v[62:65]
    v_mfma_f32_16x16x32_bf16 v[66:69], v[146:149], v[114:117], v[66:69]
    v_mfma_f32_16x16x32_bf16 v[70:73], v[162:165], v[114:117], v[70:73]
    s_waitcnt lgkmcnt(4)
    v_mfma_f32_16x16x32_bf16 v[62:65], v[134:137], v[118:121], v[62:65]
    v_mfma_f32_16x16x32_bf16 v[66:69], v[150:153], v[118:121], v[66:69]
    v_mfma_f32_16x16x32_bf16 v[70:73], v[166:169], v[118:121], v[70:73]
    s_waitcnt lgkmcnt(0)
    v_mfma_f32_16x16x32_bf16 v[62:65], v[138:141], v[122:125], v[62:65]
    v_mfma_f32_16x16x32_bf16 v[66:69], v[154:157], v[122:125], v[66:69]
    v_mfma_f32_16x16x32_bf16 v[70:73], v[170:173], v[122:125], v[70:73]
    s_nop 5
    ds_write2_b32 v5, v62, v63 offset0:0 offset1:16
    ds_write2_b32 v5, v64, v65 offset0:32 offset1:48
    ds_write_b32 v5, v66 offset:1024
    ds_write_b32 v5, v67 offset:1088
    ds_write_b32 v5, v68 offset:1152
    ds_write_b32 v5, v69 offset:1216
    ds_write_b32 v5, v70 offset:2048
    ds_write_b32 v5, v71 offset:2112
    ds_write_b32 v5, v72 offset:2176
    ds_write_b32 v5, v73 offset:2240
    s_mov_b32 s80, 524288
    buffer_load_dwordx4 v[232:235], v9, s[44:47], s80 offen sc1
    buffer_load_dwordx4 v[236:239], v9, s[44:47], s80 offen offset:16 sc1
    s_mov_b32 s80, 532480
    buffer_load_dwordx4 v[240:243], v9, s[44:47], s80 offen sc1
    buffer_load_dwordx4 v[244:247], v9, s[44:47], s80 offen offset:16 sc1
    s_waitcnt lgkmcnt(0)
    s_barrier
    ds_read2st64_b32 v[110:111], v100 offset0:0 offset1:12
    ds_read2st64_b32 v[112:113], v101 offset0:0 offset1:12
    ds_read2st64_b32 v[114:115], v102 offset0:0 offset1:12
    ds_read2st64_b32 v[116:117], v103 offset0:0 offset1:12
    ds_read2st64_b32 v[118:119], v104 offset0:0 offset1:12
    ds_read2st64_b32 v[120:121], v105 offset0:0 offset1:12
    ds_read2st64_b32 v[122:123], v106 offset0:0 offset1:12
    ds_read2st64_b32 v[124:125], v107 offset0:0 offset1:12
    ds_read2st64_b32 v[126:127], v108 offset0:0 offset1:12
    ds_read2st64_b32 v[128:129], v100 offset0:24 offset1:36
    ds_read2st64_b32 v[130:131], v101 offset0:24 offset1:36
    ds_read2st64_b32 v[132:133], v102 offset0:24 offset1:36
    ds_read2st64_b32 v[134:135], v103 offset0:24 offset1:36
    ds_read2st64_b32 v[136:137], v104 offset0:24 offset1:36
    ds_read2st64_b32 v[138:139], v105 offset0:24 offset1:36
    ds_read2st64_b32 v[140:141], v106 offset0:24 offset1:36
    ds_read2st64_b32 v[142:143], v107 offset0:24 offset1:36
    ds_read2st64_b32 v[144:145], v108 offset0:24 offset1:36
    v_bfe_u32 v5, v0, 4, 1
    v_mul_u32_u24 v5, 8256, v5
    v_lshl_add_u32 v5, v60, 2, v5
    v_add_u32 v5, 114688, v5
    v_mov_b32 v6, 0
    ds_write_b32 v5, v6
    v_lshlrev_b32 v5, 5, v0
    v_add_u32 v5, 114752, v5
    v_cmp_eq_u32 vcc, 0, v0
    s_waitcnt lgkmcnt(10)
    v_add_f32 v110, v110, v111
    v_add_f32 v112, v112, v113
    v_add_f32 v114, v114, v115
    v_add_f32 v116, v116, v117
    v_add_f32 v118, v118, v119
    v_add_f32 v120, v120, v121
    v_add_f32 v122, v122, v123
    v_add_f32 v124, v124, v125
    v_add_f32 v126, v126, v127
    v_cndmask_b32 v110, v110, v6, vcc
    v_cvt_pk_bf16_f32 v72, v112, v110
    v_cvt_pk_bf16_f32 v73, v114, v112
    v_cvt_pk_bf16_f32 v74, v116, v114
    v_cvt_pk_bf16_f32 v75, v118, v116
    v_cvt_pk_bf16_f32 v76, v120, v118
    v_cvt_pk_bf16_f32 v77, v122, v120
    v_cvt_pk_bf16_f32 v78, v124, v122
    v_cvt_pk_bf16_f32 v79, v126, v124
    ds_write_b128 v5, v[72:75] offset:0
    ds_write_b128 v5, v[76:79] offset:16
    s_waitcnt lgkmcnt(3)
    v_add_f32 v128, v128, v129
    v_add_f32 v130, v130, v131
    v_add_f32 v132, v132, v133
    v_add_f32 v134, v134, v135
    v_add_f32 v136, v136, v137
    v_add_f32 v138, v138, v139
    v_add_f32 v140, v140, v141
    v_add_f32 v142, v142, v143
    v_add_f32 v144, v144, v145
    v_cndmask_b32 v128, v128, v6, vcc
    v_cvt_pk_bf16_f32 v80, v130, v128
    v_cvt_pk_bf16_f32 v81, v132, v130
    v_cvt_pk_bf16_f32 v82, v134, v132
    v_cvt_pk_bf16_f32 v83, v136, v134
    v_cvt_pk_bf16_f32 v84, v138, v136
    v_cvt_pk_bf16_f32 v85, v140, v138
    v_cvt_pk_bf16_f32 v86, v142, v140
    v_cvt_pk_bf16_f32 v87, v144, v142
    ds_write_b128 v5, v[80:83] offset:8256
    ds_write_b128 v5, v[84:87] offset:8272
    s_waitcnt vmcnt(0)
    v_xor_b32 v160, s66, v233
    v_xor_b32 v161, s66, v235
    v_xor_b32 v162, s66, v237
    v_xor_b32 v163, s66, v239
    v_xor_b32 v164, s66, v241
    v_xor_b32 v165, s66, v243
    v_xor_b32 v166, s66, v245
    v_xor_b32 v167, s66, v247
    v_or3_b32 v160, v160, v161, v162
    v_or3_b32 v163, v163, v164, v165
    v_or3_b32 v160, v160, v166, v167
    v_or_b32 v160, v160, v163
    v_cmp_ne_u32 vcc, 0, v160
    s_cbranch_vccnz .gs_7
.gb_8:
    v_mov_b32 v252, v240
    v_mov_b32 v253, v242
    v_mov_b32 v254, v244
    v_mov_b32 v255, v246
    s_mov_b32 s80, 24117248
    buffer_load_dwordx4 v[248:251], v8, s[44:47], s80 offen sc1
    v_mov_b32 v1, v204
    v_mov_b32 v2, v205
    s_waitcnt lgkmcnt(0)
    s_barrier
    s_add_u32 m0, s89, 0
    s_add_u32 s79, s88, 0
    buffer_load_dwordx4 v24, s[48:51], s79 offen lds
    ds_read2_b32 v[32:33], v12 offset0:6 offset1:4
    ds_read2_b32 v[34:35], v12 offset0:2 offset1:0
    ds_read2_b32 v[36:37], v12 offset0:38 offset1:36
    ds_read2_b32 v[38:39], v12 offset0:34 offset1:32
    ds_read2_b32 v[40:41], v12 offset0:70 offset1:68
    ds_read2_b32 v[42:43], v12 offset0:66 offset1:64
    s_add_u32 m0, s89, 1024
    s_add_u32 s79, s88, 0
    buffer_load_dwordx4 v25, s[48:51], s79 offen lds
    ds_read2_b32 v[44:45], v12 offset0:102 offset1:100
    ds_read2_b32 v[46:47], v12 offset0:98 offset1:96
    v_add_u32 v5, 1024, v12
    ds_read2_b32 v[48:49], v5 offset0:6 offset1:4
    ds_read2_b32 v[50:51], v5 offset0:2 offset1:0
    ds_read2_b32 v[52:53], v5 offset0:38 offset1:36
    s_add_u32 m0, s89, 2048
    s_add_u32 s79, s88, 0
    buffer_load_dwordx4 v26, s[48:51], s79 offen lds
    ds_read2_b32 v[54:55], v5 offset0:34 offset1:32
    ds_read2_b32 v[56:57], v5 offset0:70 offset1:68
    ds_read2_b32 v[58:59], v5 offset0:66 offset1:64
    ds_read2_b32 v[60:61], v5 offset0:102 offset1:100
    ds_read2_b32 v[62:63], v5 offset0:98 offset1:96
    v_add_u32 v5, 2048, v12
    s_add_u32 m0, s89, 3072
    s_add_u32 s79, s88, 0
    buffer_load_dwordx4 v27, s[48:51], s79 offen lds
    ds_read2_b32 v[64:65], v5 offset0:6 offset1:4
    ds_read2_b32 v[66:67], v5 offset0:2 offset1:0
    ds_read2_b32 v[68:69], v5 offset0:38 offset1:36
    ds_read2_b32 v[70:71], v5 offset0:34 offset1:32
    ds_read2_b32 v[72:73], v5 offset0:70 offset1:68
    ds_read2_b32 v[74:75], v5 offset0:66 offset1:64
    s_add_u32 m0, s89, 4096
    s_add_u32 s79, s88, 0
    buffer_load_dwordx4 v28, s[48:51], s79 offen lds
    ds_read2_b32 v[76:77], v5 offset0:102 offset1:100
    ds_read2_b32 v[78:79], v5 offset0:98 offset1:96
    v_add_u32 v5, 3072, v12
    ds_read2_b32 v[80:81], v5 offset0:6 offset1:4
    ds_read2_b32 v[82:83], v5 offset0:2 offset1:0
    ds_read2_b32 v[84:85], v5 offset0:38 offset1:36
    s_add_u32 m0, s89, 5120
    s_add_u32 s79, s88, 0
    buffer_load_dwordx4 v29, s[48:51], s79 offen lds
    ds_read2_b32 v[86:87], v5 offset0:34 offset1:32
    ds_read2_b32 v[88:89], v5 offset0:70 offset1:68
    ds_read2_b32 v[90:91], v5 offset0:66 offset1:64
    ds_read2_b32 v[92:93], v5 offset0:102 offset1:100
    ds_read2_b32 v[94:95], v5 offset0:98 offset1:96
    v_subrev_u32 v5, 140928, v13
    v_and_b32 v5, 0x3f0, v5
    v_lshrrev_b32 v5, 1, v5
    v_add_u32 v5, 131712, v5
    v_mov_b32 v240, 0
    v_mov_b32 v241, 0
    ds_write_b64 v5, v[240:241]
    ds_write_b64 v5, v[240:241] offset:4608
    s_waitcnt vmcnt(6)
    v_and_b32 v196, s71, v232
    v_and_b32 v197, s71, v234
    v_and_b32 v198, s71, v236
    v_and_b32 v199, s71, v238
    v_rcp_f32 v196, v196
    v_rcp_f32 v197, v197
    v_rcp_f32 v198, v198
    v_rcp_f32 v199, v199
    v_lshlrev_b32 v192, 16, v232
    v_lshlrev_b32 v193, 16, v234
    v_lshlrev_b32 v194, 16, v236
    v_lshlrev_b32 v195, 16, v238
    v_lshlrev_b32 v224, 16, v248
    v_and_b32 v228, s71, v248
    v_lshlrev_b32 v225, 16, v249
    v_and_b32 v229, s71, v249
    v_lshlrev_b32 v226, 16, v250
    v_and_b32 v230, s71, v250
    v_lshlrev_b32 v227, 16, v251
    v_and_b32 v231, s71, v251
    v_pk_add_f32 v[176:177], v[224:225], v[192:193] neg_lo:[0,1] neg_hi:[0,1]
    v_pk_add_f32 v[178:179], v[226:227], v[194:195] neg_lo:[0,1] neg_hi:[0,1]
    v_pk_add_f32 v[180:181], v[228:229], v[192:193] neg_lo:[0,1] neg_hi:[0,1]
    v_pk_add_f32 v[182:183], v[230:231], v[194:195] neg_lo:[0,1] neg_hi:[0,1]
    v_cvt_pk_bf16_f32 v176, 0, v176
    v_cvt_pk_bf16_f32 v177, 0, v177
    v_cvt_pk_bf16_f32 v178, 0, v178
    v_cvt_pk_bf16_f32 v179, 0, v179
    v_cvt_pk_bf16_f32 v180, 0, v180
    v_cvt_pk_bf16_f32 v181, 0, v181
    v_cvt_pk_bf16_f32 v182, 0, v182
    v_cvt_pk_bf16_f32 v183, 0, v183
    v_pk_mul_f32 v[176:177], v[176:177], v[196:197]
    v_pk_mul_f32 v[178:179], v[178:179], v[198:199]
    v_pk_mul_f32 v[180:181], v[180:181], v[196:197]
    v_pk_mul_f32 v[182:183], v[182:183], v[198:199]
    v_cvt_pk_bf16_f32 v240, v176, v177
    v_cvt_pk_bf16_f32 v241, v178, v179
    v_cvt_pk_bf16_f32 v242, v180, v181
    v_cvt_pk_bf16_f32 v243, v182, v183
    ds_write_b64 v10, v[240:241] offset:0
    ds_write_b64 v10, v[242:243] offset:4608
    s_waitcnt lgkmcnt(0)
    s_barrier
    ds_read_b128 v[160:163], v11 offset:480
    ds_read_b128 v[164:167], v11 offset:416
    ds_read_b128 v[168:171], v11 offset:352
    ds_read_b128 v[172:175], v11 offset:288
    ds_read_b128 v[176:179], v11 offset:992
    ds_read_b128 v[180:183], v11 offset:928
    s_waitcnt lgkmcnt(5)
    v_mfma_f32_16x16x32_bf16 a[224:227], v[32:35], v[160:163], 0
    v_add_u32 v5, 4096, v12
    ds_read2_b32 v[96:97], v5 offset0:6 offset1:4
    ds_read2_b32 v[98:99], v5 offset0:2 offset1:0
    s_add_u32 m0, s89, 6144
    s_add_u32 s79, s88, 0
    buffer_load_dwordx4 v30, s[48:51], s79 offen lds
    ds_read_b128 v[184:187], v11 offset:864
    v_mfma_f32_16x16x32_bf16 a[228:231], v[48:51], v[160:163], 0
    ds_read_b128 v[188:191], v11 offset:800
    v_mfma_f32_16x16x32_bf16 a[232:235], v[64:67], v[160:163], 0
    ds_read_b128 v[192:195], v11 offset:1504
    ds_read2_b32 v[100:101], v5 offset0:38 offset1:36
    ds_read2_b32 v[102:103], v5 offset0:34 offset1:32
    v_mfma_f32_16x16x32_bf16 a[236:239], v[80:83], v[160:163], 0
    ds_read_b128 v[196:199], v11 offset:1440
    s_waitcnt lgkmcnt(12)
    v_mfma_f32_16x16x32_bf16 a[224:227], v[36:39], v[164:167], a[224:227]
    ds_read_b128 v[200:203], v11 offset:1376
    ds_read2_b32 v[104:105], v5 offset0:70 offset1:68
    ds_read2_b32 v[106:107], v5 offset0:66 offset1:64
    s_add_u32 m0, s89, 7168
    s_add_u32 s79, s88, 114688
    buffer_load_dwordx4 v24, s[48:51], s79 offen lds
    v_mfma_f32_16x16x32_bf16 a[228:231], v[52:55], v[164:167], a[228:231]
    ds_read_b128 v[204:207], v11 offset:1312
    v_mfma_f32_16x16x32_bf16 a[232:235], v[68:71], v[164:167], a[232:235]
    ds_read_b128 v[208:211], v11 offset:2016
    v_mfma_f32_16x16x32_bf16 a[236:239], v[84:87], v[164:167], a[236:239]
    ds_read2_b32 v[108:109], v5 offset0:102 offset1:100
    ds_read2_b32 v[110:111], v5 offset0:98 offset1:96
    ds_read_b128 v[212:215], v11 offset:1952
    s_waitcnt lgkmcnt(15)
    v_mfma_f32_16x16x32_bf16 a[224:227], v[40:43], v[168:171], a[224:227]
    ds_read_b128 v[216:219], v11 offset:1888
    v_mfma_f32_16x16x32_bf16 a[228:231], v[56:59], v[168:171], a[228:231]
    ds_read_b128 v[220:223], v11 offset:1824
    v_add_u32 v5, 5120, v12
    ds_read2_b32 v[112:113], v5 offset0:6 offset1:4
    ds_read2_b32 v[114:115], v5 offset0:2 offset1:0
    s_add_u32 m0, s89, 8192
    s_add_u32 s79, s88, 114688
    buffer_load_dwordx4 v25, s[48:51], s79 offen lds
    v_mfma_f32_16x16x32_bf16 a[232:235], v[72:75], v[168:171], a[232:235]
    v_lshlrev_b32 v232, 16, v240
    v_mfma_f32_16x16x32_bf16 a[236:239], v[88:91], v[168:171], a[236:239]
    v_and_b32 v233, s71, v240
    ds_read2_b32 v[116:117], v5 offset0:38 offset1:36
    ds_read2_b32 v[118:119], v5 offset0:34 offset1:32
    v_mfma_f32_16x16x32_bf16 a[224:227], v[44:47], v[172:175], a[224:227]
    v_lshlrev_b32 v234, 16, v241
    v_mfma_f32_16x16x32_bf16 a[228:231], v[60:63], v[172:175], a[228:231]
    v_and_b32 v235, s71, v241
    v_mfma_f32_16x16x32_bf16 a[232:235], v[76:79], v[172:175], a[232:235]
    ds_read2_b32 v[120:121], v5 offset0:70 offset1:68
    ds_read2_b32 v[122:123], v5 offset0:66 offset1:64
    s_add_u32 m0, s89, 9216
    s_add_u32 s79, s88, 114688
    buffer_load_dwordx4 v26, s[48:51], s79 offen lds
    v_lshlrev_b32 v236, 16, v242
    v_mfma_f32_16x16x32_bf16 a[236:239], v[92:95], v[172:175], a[236:239]
    v_and_b32 v237, s71, v242
    v_mfma_f32_16x16x32_bf16 a[228:231], v[32:35], v[176:179], a[228:231]
    ds_read2_b32 v[124:125], v5 offset0:102 offset1:100
    ds_read2_b32 v[126:127], v5 offset0:98 offset1:96
    v_lshlrev_b32 v238, 16, v243
    v_mfma_f32_16x16x32_bf16 a[232:235], v[48:51], v[176:179], a[232:235]
    v_and_b32 v239, s71, v243
    ds_write_b128 v13, a[224:227] offset:0
    v_mfma_f32_16x16x32_bf16 a[236:239], v[64:67], v[176:179], a[236:239]
    v_fmac_f32 v224, s68, v232
    v_add_u32 v5, 6144, v12
    ds_read2_b32 v[128:129], v5 offset0:6 offset1:4
    ds_read2_b32 v[130:131], v5 offset0:2 offset1:0
    s_add_u32 m0, s89, 10240
    s_add_u32 s79, s88, 114688
    buffer_load_dwordx4 v27, s[48:51], s79 offen lds
    v_mfma_f32_16x16x32_bf16 a[228:231], v[36:39], v[180:183], a[228:231]
    v_fmac_f32 v225, s68, v233
    v_mfma_f32_16x16x32_bf16 a[232:235], v[52:55], v[180:183], a[232:235]
    v_fmac_f32 v226, s68, v234
    ds_read2_b32 v[132:133], v5 offset0:38 offset1:36
    ds_read2_b32 v[134:135], v5 offset0:34 offset1:32
    v_mfma_f32_16x16x32_bf16 a[236:239], v[68:71], v[180:183], a[236:239]
    v_fmac_f32 v227, s68, v235
    s_waitcnt lgkmcnt(15)
    v_mfma_f32_16x16x32_bf16 a[228:231], v[40:43], v[184:187], a[228:231]
    v_fmac_f32 v228, s69, v236
    ds_read2_b32 v[136:137], v5 offset0:70 offset1:68
    ds_read2_b32 v[138:139], v5 offset0:66 offset1:64
    s_add_u32 m0, s89, 11264
    s_add_u32 s79, s88, 114688
    buffer_load_dwordx4 v28, s[48:51], s79 offen lds
    v_mfma_f32_16x16x32_bf16 a[232:235], v[56:59], v[184:187], a[232:235]
    v_fmac_f32 v229, s69, v237
    v_mfma_f32_16x16x32_bf16 a[236:239], v[72:75], v[184:187], a[236:239]
    v_fmac_f32 v230, s69, v238
    ds_read2_b32 v[140:141], v5 offset0:102 offset1:100
    ds_read2_b32 v[142:143], v5 offset0:98 offset1:96
    v_mfma_f32_16x16x32_bf16 a[228:231], v[44:47], v[188:191], a[228:231]
    v_fmac_f32 v231, s69, v239
    v_mfma_f32_16x16x32_bf16 a[232:235], v[60:63], v[188:191], a[232:235]
    v_mfma_f32_16x16x32_bf16 a[236:239], v[76:79], v[188:191], a[236:239]
    v_mfma_f32_16x16x32_bf16 a[232:235], v[32:35], v[192:195], a[232:235]
    v_add_u32 v5, 7168, v12
    ds_read2_b32 v[144:145], v5 offset0:6 offset1:4
    ds_read2_b32 v[146:147], v5 offset0:2 offset1:0
    v_mfma_f32_16x16x32_bf16 a[236:239], v[48:51], v[192:195], a[236:239]
    v_mfma_f32_16x16x32_bf16 a[232:235], v[36:39], v[196:199], a[232:235]
    ds_write_b128 v13, a[228:231] offset:4096
    v_mfma_f32_16x16x32_bf16 a[236:239], v[52:55], v[196:199], a[236:239]
    ds_read2_b32 v[148:149], v5 offset0:38 offset1:36
    ds_read2_b32 v[150:151], v5 offset0:34 offset1:32
    v_mfma_f32_16x16x32_bf16 a[232:235], v[40:43], v[200:203], a[232:235]
    v_mfma_f32_16x16x32_bf16 a[236:239], v[56:59], v[200:203], a[236:239]
    v_mfma_f32_16x16x32_bf16 a[232:235], v[44:47], v[204:207], a[232:235]
    ds_read2_b32 v[152:153], v5 offset0:70 offset1:68
    ds_read2_b32 v[154:155], v5 offset0:66 offset1:64
    v_mfma_f32_16x16x32_bf16 a[236:239], v[60:63], v[204:207], a[236:239]
    v_mfma_f32_16x16x32_bf16 a[236:239], v[32:35], v[208:211], a[236:239]
    v_mfma_f32_16x16x32_bf16 a[236:239], v[36:39], v[212:215], a[236:239]
    ds_read2_b32 v[156:157], v5 offset0:102 offset1:100
    ds_read2_b32 v[158:159], v5 offset0:98 offset1:96
    s_waitcnt lgkmcnt(15)
    v_mfma_f32_16x16x32_bf16 a[236:239], v[40:43], v[216:219], a[236:239]
    v_mfma_f32_16x16x32_bf16 a[236:239], v[44:47], v[220:223], a[236:239]
    ds_write_b128 v13, a[232:235] offset:8192
    s_nop 6
    ds_write_b128 v13, a[236:239] offset:12288
    v_mfma_f32_16x16x32_bf16 a[240:243], v[80:83], v[176:179], 0
    v_mfma_f32_16x16x32_bf16 a[240:243], v[64:67], v[192:195], a[240:243]
    v_mfma_f32_16x16x32_bf16 a[240:243], v[48:51], v[208:211], a[240:243]
    v_mfma_f32_16x16x32_bf16 a[244:247], v[80:83], v[192:195], 0
    v_mfma_f32_16x16x32_bf16 a[244:247], v[64:67], v[208:211], a[244:247]
    s_waitcnt lgkmcnt(0)
    s_barrier
    ds_read_b128 v[232:235], v14 offset:0
    ds_read_b128 v[236:239], v14 offset:1024
    ds_read_b128 v[240:243], v14 offset:2048
    ds_read_b128 v[244:247], v14 offset:3072
    v_mfma_f32_16x16x32_bf16 a[248:251], v[80:83], v[208:211], 0
    v_mfma_f32_16x16x32_bf16 a[240:243], v[84:87], v[180:183], a[240:243]
    v_mfma_f32_16x16x32_bf16 a[240:243], v[68:71], v[196:199], a[240:243]
    v_mfma_f32_16x16x32_bf16 a[240:243], v[52:55], v[212:215], a[240:243]
    v_mfma_f32_16x16x32_bf16 a[244:247], v[84:87], v[196:199], a[244:247]
    v_mfma_f32_16x16x32_bf16 a[244:247], v[68:71], v[212:215], a[244:247]
    v_mfma_f32_16x16x32_bf16 a[248:251], v[84:87], v[212:215], a[248:251]
    s_mov_b32 s80, 3145728
    s_waitcnt lgkmcnt(2)
    v_pk_add_f32 v[232:233], v[232:233], v[236:237]
    v_pk_add_f32 v[234:235], v[234:235], v[238:239]
    v_pk_add_f32 v[224:225], v[224:225], v[232:233]
    v_pk_add_f32 v[226:227], v[226:227], v[234:235]
    s_waitcnt lgkmcnt(0)
    v_pk_add_f32 v[240:241], v[240:241], v[244:245]
    v_pk_add_f32 v[242:243], v[242:243], v[246:247]
    v_pk_add_f32 v[228:229], v[228:229], v[240:241]
    v_pk_add_f32 v[230:231], v[230:231], v[242:243]
    v_cvt_pk_bf16_f32 v244, v224, v228
    v_cvt_pk_bf16_f32 v245, v225, v229
    v_cvt_pk_bf16_f32 v246, v226, v230
    v_cvt_pk_bf16_f32 v247, v227, v231
    s_mov_b64 exec, s[100:101]
    v_swap_b32 v244, v245
    v_swap_b32 v246, v247
    s_mov_b64 exec, -1
    buffer_store_dwordx4 v[244:247], v8, s[44:47], s80 offen sc1
    s_mov_b32 s80, 25165824
    buffer_load_dwordx4 v[248:251], v8, s[44:47], s80 offen sc1
    s_add_u32 m0, s89, 12288
    s_add_u32 s79, s88, 114688
    buffer_load_dwordx4 v29, s[48:51], s79 offen lds
    v_mfma_f32_16x16x32_bf16 a[240:243], v[88:91], v[184:187], a[240:243]
    v_mbcnt_lo_u32_b32 v246, -1, 0
    v_mbcnt_hi_u32_b32 v246, -1, v246
    v_mfma_f32_16x16x32_bf16 a[240:243], v[72:75], v[200:203], a[240:243]
    v_and_b32 v244, 15, v246
    v_lshrrev_b32 v245, 4, v246
    v_mfma_f32_16x16x32_bf16 a[240:243], v[56:59], v[216:219], a[240:243]
    v_mfma_f32_16x16x32_bf16 a[244:247], v[88:91], v[200:203], a[244:247]
    v_lshlrev_b32 v247, 4, v246
    s_and_b32 s5, s60, 1
    v_mfma_f32_16x16x32_bf16 a[244:247], v[72:75], v[216:219], a[244:247]
    v_mfma_f32_16x16x32_bf16 a[248:251], v[88:91], v[216:219], a[248:251]
    s_lshr_b32 s6, s60, 1
    v_lshlrev_b32 v15, 9, v245
    v_mfma_f32_16x16x32_bf16 a[240:243], v[92:95], v[188:191], a[240:243]
    v_lshl_add_u32 v15, v244, 3, v15
    s_lshl_b32 s7, s62, 16
    v_mfma_f32_16x16x32_bf16 a[240:243], v[76:79], v[204:207], a[240:243]
    v_mfma_f32_16x16x32_bf16 a[240:243], v[60:63], v[220:223], a[240:243]
    s_lshl_b32 s8, s5, 7
    s_add_u32 s7, s7, s8
    v_mfma_f32_16x16x32_bf16 a[244:247], v[92:95], v[204:207], a[244:247]
    v_mfma_f32_16x16x32_bf16 a[244:247], v[76:79], v[220:223], a[244:247]
    s_add_u32 m0, s89, 13312
    s_add_u32 s79, s88, 114688
    buffer_load_dwordx4 v30, s[48:51], s79 offen lds
    s_lshl_b32 s8, s6, 15
    s_add_u32 s7, s7, s8
    v_mfma_f32_16x16x32_bf16 a[248:251], v[92:95], v[220:223], a[248:251]
    v_mfma_f32_16x16x32_bf16 a[240:243], v[96:99], v[160:163], a[240:243]
    v_add_u32 v15, s7, v15
    v_lshlrev_b32 v240, 2, v245
    v_mfma_f32_16x16x32_bf16 a[244:247], v[112:115], v[160:163], a[244:247]
    v_bfe_u32 v241, v246, 2, 2
    v_add_u32 v240, v240, v241
    v_mfma_f32_16x16x32_bf16 a[244:247], v[96:99], v[176:179], a[244:247]
    v_mfma_f32_16x16x32_bf16 a[248:251], v[128:131], v[160:163], a[248:251]
    v_mul_u32_u24 v240, 224, v240
    v_and_b32 v241, 3, v246
    v_mfma_f32_16x16x32_bf16 a[248:251], v[112:115], v[176:179], a[248:251]
    v_mfma_f32_16x16x32_bf16 a[248:251], v[96:99], v[192:195], a[248:251]
    v_lshl_add_u32 v240, v241, 3, v240
    s_mul_i32 s7, s6, 57344
    v_mfma_f32_16x16x32_bf16 a[252:255], v[144:147], v[160:163], 0
    v_mfma_f32_16x16x32_bf16 a[252:255], v[128:131], v[176:179], a[252:255]
    v_add_u32 v16, s7, v240
    s_mul_i32 s7, s60, 7680
    v_mfma_f32_16x16x32_bf16 a[252:255], v[112:115], v[192:195], a[252:255]
    s_add_u32 s7, s7, 131712
    s_add_u32 m0, s89, 14336
    s_add_u32 s79, s88, 229376
    buffer_load_dwordx4 v24, s[48:51], s79 offen lds
    v_add_u32 v17, s7, v247
    v_mfma_f32_16x16x32_bf16 a[252:255], v[96:99], v[208:211], a[252:255]
    v_mfma_f32_16x16x32_bf16 a[240:243], v[100:103], v[164:167], a[240:243]
    v_lshrrev_b32 v240, 5, v246
    v_xor_b32 v240, s6, v240
    v_mfma_f32_16x16x32_bf16 a[244:247], v[116:119], v[164:167], a[244:247]
    v_mfma_f32_16x16x32_bf16 a[244:247], v[100:103], v[180:183], a[244:247]
    v_lshlrev_b32 v240, 8, v240
    v_lshl_add_u32 v240, v246, 2, v240
    v_mfma_f32_16x16x32_bf16 a[248:251], v[132:135], v[164:167], a[248:251]
    v_mfma_f32_16x16x32_bf16 a[248:251], v[116:119], v[180:183], a[248:251]
    s_lshl_b32 s7, s5, 9
    s_add_u32 s7, s7, 162432
    v_mfma_f32_16x16x32_bf16 a[248:251], v[100:103], v[196:199], a[248:251]
    v_add_u32 v19, s7, v240
    s_lshl_b32 s8, s6, 8
    v_mfma_f32_16x16x32_bf16 a[252:255], v[148:151], v[164:167], a[252:255]
    s_waitcnt vmcnt(4)
    s_add_u32 s7, s7, s8
    v_lshlrev_b32 v240, 2, v244
    s_barrier
    s_mov_b32 s80, 0
    s_mov_b64 exec, s[76:77]
    v_mov_b32 v5, 1
    buffer_atomic_add v5, v2, s[44:47], s80 offen sc1
    s_mov_b64 exec, -1
    v_mfma_f32_16x16x32_bf16 a[252:255], v[132:135], v[180:183], a[252:255]
    v_add_u32 v20, s7, v240
    s_xor_b32 s7, s60, 2
    s_add_u32 m0, s89, 15360
    s_add_u32 s79, s88, 229376
    buffer_load_dwordx4 v25, s[48:51], s79 offen lds
    v_mfma_f32_16x16x32_bf16 a[252:255], v[116:119], v[196:199], a[252:255]
    v_mfma_f32_16x16x32_bf16 a[252:255], v[100:103], v[212:215], a[252:255]
    s_mul_i32 s7, s7, 7680
    s_add_u32 s7, s7, 131712
    v_mfma_f32_16x16x32_bf16 a[240:243], v[104:107], v[168:171], a[240:243]
    v_add_u32 v18, s7, v247
    v_lshlrev_b32 v21, 4, v245
    v_mfma_f32_16x16x32_bf16 a[244:247], v[120:123], v[168:171], a[244:247]
    v_mfma_f32_16x16x32_bf16 a[244:247], v[104:107], v[184:187], a[244:247]
    v_add_u32 v21, 131200, v21
    s_lshl_b32 s7, s62, 1
    v_mfma_f32_16x16x32_bf16 a[248:251], v[136:139], v[168:171], a[248:251]
    v_mfma_f32_16x16x32_bf16 a[248:251], v[120:123], v[184:187], a[248:251]
    s_add_u32 s7, s7, s5
    s_mul_i32 s7, s7, 114688
    v_mfma_f32_16x16x32_bf16 a[248:251], v[104:107], v[200:203], a[248:251]
    v_mfma_f32_16x16x32_bf16 a[252:255], v[152:155], v[168:171], a[252:255]
    s_mul_i32 s8, s63, 7168
    s_add_u32 s7, s7, s8
    v_mfma_f32_16x16x32_bf16 a[252:255], v[136:139], v[184:187], a[252:255]
    s_lshl_b32 s8, s6, 8
    s_add_u32 s7, s7, s8
    v_mfma_f32_16x16x32_bf16 a[252:255], v[120:123], v[200:203], a[252:255]
    s_add_u32 m0, s89, 16384
    s_add_u32 s79, s88, 229376
    buffer_load_dwordx4 v26, s[48:51], s79 offen lds
    v_mfma_f32_16x16x32_bf16 a[252:255], v[104:107], v[216:219], a[252:255]
    v_and_b32 v240, 1, v245
    v_lshrrev_b32 v241, 1, v245
    v_mfma_f32_16x16x32_bf16 a[240:243], v[108:111], v[172:175], a[240:243]
    v_mfma_f32_16x16x32_bf16 a[244:247], v[124:127], v[172:175], a[244:247]
    v_lshlrev_b32 v23, 9, v241
    v_lshl_add_u32 v23, v244, 4, v23
    v_mfma_f32_16x16x32_bf16 a[244:247], v[108:111], v[188:191], a[244:247]
    v_mfma_f32_16x16x32_bf16 a[248:251], v[140:143], v[172:175], a[248:251]
    v_add_u32 v23, s7, v23
    v_lshl_add_u32 v22, v240, 10, v23
    v_mfma_f32_16x16x32_bf16 a[248:251], v[124:127], v[188:191], a[248:251]
    v_lshl_add_u32 v23, v240, 3, v23
    s_and_b32 s7, s63, 1
    v_mfma_f32_16x16x32_bf16 a[248:251], v[108:111], v[204:207], a[248:251]
    v_mfma_f32_16x16x32_bf16 a[252:255], v[156:159], v[172:175], a[252:255]
    s_lshl_b32 s8, s7, 10
    v_add_u32 v22, s8, v22
    v_mfma_f32_16x16x32_bf16 a[252:255], v[140:143], v[188:191], a[252:255]
    v_mfma_f32_16x16x32_bf16 a[252:255], v[124:127], v[204:207], a[252:255]
    s_mul_i32 s8, s7, 6144
    v_subrev_u32 v23, s8, v23
    v_mfma_f32_16x16x32_bf16 a[252:255], v[108:111], v[220:223], a[252:255]
    s_waitcnt vmcnt(6)
    v_and_b32 v196, s71, v252
    v_and_b32 v197, s71, v253
    v_and_b32 v198, s71, v254
    v_and_b32 v199, s71, v255
    v_rcp_f32 v196, v196
    v_rcp_f32 v197, v197
    v_rcp_f32 v198, v198
    v_rcp_f32 v199, v199
    v_lshlrev_b32 v192, 16, v252
    v_lshlrev_b32 v193, 16, v253
    v_lshlrev_b32 v194, 16, v254
    v_lshlrev_b32 v195, 16, v255
    v_lshlrev_b32 v224, 16, v248
    v_and_b32 v228, s71, v248
    v_lshlrev_b32 v225, 16, v249
    v_and_b32 v229, s71, v249
    v_lshlrev_b32 v226, 16, v250
    v_and_b32 v230, s71, v250
    v_lshlrev_b32 v227, 16, v251
    v_and_b32 v231, s71, v251
    v_pk_add_f32 v[176:177], v[224:225], v[192:193] neg_lo:[0,1] neg_hi:[0,1]
    v_pk_add_f32 v[178:179], v[226:227], v[194:195] neg_lo:[0,1] neg_hi:[0,1]
    v_pk_add_f32 v[180:181], v[228:229], v[192:193] neg_lo:[0,1] neg_hi:[0,1]
    v_pk_add_f32 v[182:183], v[230:231], v[194:195] neg_lo:[0,1] neg_hi:[0,1]
    v_cvt_pk_bf16_f32 v176, 0, v176
    v_cvt_pk_bf16_f32 v177, 0, v177
    v_cvt_pk_bf16_f32 v178, 0, v178
    v_cvt_pk_bf16_f32 v179, 0, v179
    v_cvt_pk_bf16_f32 v180, 0, v180
    v_cvt_pk_bf16_f32 v181, 0, v181
    v_cvt_pk_bf16_f32 v182, 0, v182
    v_cvt_pk_bf16_f32 v183, 0, v183
    v_pk_mul_f32 v[176:177], v[176:177], v[196:197]
    v_pk_mul_f32 v[178:179], v[178:179], v[198:199]
    v_pk_mul_f32 v[180:181], v[180:181], v[196:197]
    v_pk_mul_f32 v[182:183], v[182:183], v[198:199]
    v_cvt_pk_bf16_f32 v240, v176, v177
    v_cvt_pk_bf16_f32 v241, v178, v179
    v_cvt_pk_bf16_f32 v242, v180, v181
    v_cvt_pk_bf16_f32 v243, v182, v183
    ds_write_b64 v10, v[240:241] offset:2048
    ds_write_b64 v10, v[242:243] offset:6656
    s_waitcnt lgkmcnt(0)
    s_barrier
    ds_read_b128 v[160:163], v11 offset:2528
    ds_read_b128 v[164:167], v11 offset:2464
    ds_read_b128 v[168:171], v11 offset:2400
    ds_read_b128 v[172:175], v11 offset:2336
    ds_read_b128 v[176:179], v11 offset:3040
    ds_read_b128 v[180:183], v11 offset:2976
    s_waitcnt lgkmcnt(5)
    v_mfma_f32_16x16x32_bf16 a[240:243], v[32:35], v[160:163], a[240:243]
    v_mbcnt_lo_u32_b32 v248, -1, 0
    v_mbcnt_hi_u32_b32 v248, -1, v248
    ds_read_b128 v[184:187], v11 offset:2912
    v_mfma_f32_16x16x32_bf16 a[244:247], v[48:51], v[160:163], a[244:247]
    ds_read_b128 v[188:191], v11 offset:2848
    v_lshlrev_b32 v6, 4, v248
    s_lshl_b32 s5, s65, 2
    v_mfma_f32_16x16x32_bf16 a[248:251], v[64:67], v[160:163], a[248:251]
    ds_read_b128 v[192:195], v11 offset:3552
    v_mfma_f32_16x16x32_bf16 a[252:255], v[80:83], v[160:163], a[252:255]
    s_add_u32 s5, s5, s60
    s_mul_i32 s5, s5, 57344
    ds_read_b128 v[196:199], v11 offset:3488
    s_waitcnt lgkmcnt(8)
    v_mfma_f32_16x16x32_bf16 a[240:243], v[36:39], v[164:167], a[240:243]
    s_add_u32 s81, s5, 1048576
    v_and_b32 v249, 15, v248
    ds_read_b128 v[200:203], v11 offset:3424
    v_mfma_f32_16x16x32_bf16 a[244:247], v[52:55], v[164:167], a[244:247]
    ds_read_b128 v[204:207], v11 offset:3360
    v_lshrrev_b32 v250, 4, v248
    s_mul_i32 s7, s64, 114688
    v_mfma_f32_16x16x32_bf16 a[248:251], v[68:71], v[164:167], a[248:251]
    ds_read_b128 v[208:211], v11 offset:4064
    v_mfma_f32_16x16x32_bf16 a[252:255], v[84:87], v[164:167], a[252:255]
    s_mul_i32 s8, s60, 28672
    s_add_u32 s7, s7, s8
    ds_read_b128 v[212:215], v11 offset:4000
    s_waitcnt lgkmcnt(11)
    v_mfma_f32_16x16x32_bf16 a[240:243], v[40:43], v[168:171], a[240:243]
    v_lshlrev_b32 v5, 9, v250
    v_lshl_add_u32 v24, v249, 4, v5
    ds_read_b128 v[216:219], v11 offset:3936
    v_mfma_f32_16x16x32_bf16 a[244:247], v[56:59], v[168:171], a[244:247]
    ds_read_b128 v[220:223], v11 offset:3872
    v_add_u32 v24, s7, v24
    s_lshr_b32 s7, s64, 1
    v_mfma_f32_16x16x32_bf16 a[248:251], v[72:75], v[168:171], a[248:251]
    v_lshlrev_b32 v232, 16, v240
    v_mfma_f32_16x16x32_bf16 a[252:255], v[88:91], v[168:171], a[252:255]
    s_lshl_b32 s7, s7, 16
    s_and_b32 s8, s64, 1
    v_and_b32 v233, s71, v240
    s_waitcnt lgkmcnt(12)
    v_mfma_f32_16x16x32_bf16 a[240:243], v[44:47], v[172:175], a[240:243]
    s_lshl_b32 s8, s8, 7
    s_add_u32 s7, s7, s8
    v_lshlrev_b32 v234, 16, v241
    v_mfma_f32_16x16x32_bf16 a[244:247], v[60:63], v[172:175], a[244:247]
    v_and_b32 v235, s71, v241
    s_lshl_b32 s8, s65, 13
    s_add_u32 s7, s7, s8
    v_mfma_f32_16x16x32_bf16 a[248:251], v[76:79], v[172:175], a[248:251]
    v_lshlrev_b32 v236, 16, v242
    v_mfma_f32_16x16x32_bf16 a[252:255], v[92:95], v[172:175], a[252:255]
    s_lshl_b32 s8, s60, 11
    s_add_u32 s7, s7, s8
    v_and_b32 v237, s71, v242
    s_waitcnt lgkmcnt(11)
    v_mfma_f32_16x16x32_bf16 a[244:247], v[32:35], v[176:179], a[244:247]
    v_lshl_add_u32 v26, v249, 3, v5
    v_add_u32 v26, s7, v26
    v_lshlrev_b32 v238, 16, v243
    v_mfma_f32_16x16x32_bf16 a[248:251], v[48:51], v[176:179], a[248:251]
    v_and_b32 v239, s71, v243
    s_xor_b32 s7, s60, 1
    s_mul_i32 s7, s7, 6144
    ds_write_b128 v13, a[240:243] offset:0
    v_mfma_f32_16x16x32_bf16 a[252:255], v[64:67], v[176:179], a[252:255]
    v_fmac_f32 v224, s68, v232
    s_add_u32 s7, s7, 131712
    v_add_u32 v27, s7, v6
    s_waitcnt lgkmcnt(11)
    v_mfma_f32_16x16x32_bf16 a[244:247], v[36:39], v[180:183], a[244:247]
    v_fmac_f32 v225, s68, v233
    s_xor_b32 s7, s60, 2
    s_mul_i32 s7, s7, 6144
    v_mfma_f32_16x16x32_bf16 a[248:251], v[52:55], v[180:183], a[248:251]
    v_fmac_f32 v226, s68, v234
    v_mfma_f32_16x16x32_bf16 a[252:255], v[68:71], v[180:183], a[252:255]
    s_add_u32 s7, s7, 133760
    v_add_u32 v28, s7, v6
    v_fmac_f32 v227, s68, v235
    s_waitcnt lgkmcnt(10)
    v_mfma_f32_16x16x32_bf16 a[244:247], v[40:43], v[184:187], a[244:247]
    s_xor_b32 s7, s60, 3
    s_mul_i32 s7, s7, 6144
    v_fmac_f32 v228, s69, v236
    v_mfma_f32_16x16x32_bf16 a[248:251], v[56:59], v[184:187], a[248:251]
    v_fmac_f32 v229, s69, v237
    s_add_u32 s7, s7, 135808
    v_add_u32 v29, s7, v6
    v_mfma_f32_16x16x32_bf16 a[252:255], v[72:75], v[184:187], a[252:255]
    v_fmac_f32 v230, s69, v238
    s_waitcnt lgkmcnt(9)
    s_mul_i32 s7, s60, 6144
    s_add_u32 s7, s7, 131712
    v_mfma_f32_16x16x32_bf16 a[244:247], v[44:47], v[188:191], a[244:247]
    v_fmac_f32 v231, s69, v239
    v_mfma_f32_16x16x32_bf16 a[248:251], v[60:63], v[188:191], a[248:251]
    v_add_u32 v30, s7, v6
    v_lshlrev_b32 v31, 4, v249
    v_mfma_f32_16x16x32_bf16 a[252:255], v[76:79], v[188:191], a[252:255]
    s_waitcnt lgkmcnt(8)
    v_mfma_f32_16x16x32_bf16 a[248:251], v[32:35], v[192:195], a[248:251]
    v_lshl_add_u32 v31, v250, 2, v31
    s_lshl_b32 s7, s64, 8
    v_mfma_f32_16x16x32_bf16 a[252:255], v[48:51], v[192:195], a[252:255]
    s_waitcnt lgkmcnt(7)
    v_mfma_f32_16x16x32_bf16 a[248:251], v[36:39], v[196:199], a[248:251]
    v_add_u32 v31, s7, v31
    v_lshlrev_b32 v0, 11, v249
    ds_write_b128 v13, a[244:247] offset:4096
    v_mfma_f32_16x16x32_bf16 a[252:255], v[52:55], v[196:199], a[252:255]
    s_waitcnt lgkmcnt(7)
    v_and_b32 v5, 1, v250
    v_lshl_add_u32 v0, v5, 10, v0
    v_mfma_f32_16x16x32_bf16 a[248:251], v[40:43], v[200:203], a[248:251]
    v_mfma_f32_16x16x32_bf16 a[252:255], v[56:59], v[200:203], a[252:255]
    s_waitcnt lgkmcnt(6)
    v_lshrrev_b32 v5, 1, v250
    v_lshl_add_u32 v0, v5, 4, v0
    v_mfma_f32_16x16x32_bf16 a[248:251], v[44:47], v[204:207], a[248:251]
    v_mfma_f32_16x16x32_bf16 a[252:255], v[60:63], v[204:207], a[252:255]
    s_waitcnt lgkmcnt(5)
    s_lshl_b32 s7, s64, 15
    s_lshl_b32 s8, s65, 7
    v_mfma_f32_16x16x32_bf16 a[252:255], v[32:35], v[208:211], a[252:255]
    s_waitcnt lgkmcnt(4)
    v_mfma_f32_16x16x32_bf16 a[252:255], v[36:39], v[212:215], a[252:255]
    s_add_u32 s7, s7, s8
    s_lshl_b32 s8, s60, 5
    s_waitcnt lgkmcnt(3)
    v_mfma_f32_16x16x32_bf16 a[252:255], v[40:43], v[216:219], a[252:255]
    s_waitcnt lgkmcnt(2)
    s_add_u32 s7, s7, s8
    v_add_u32 v0, s7, v0
    v_mfma_f32_16x16x32_bf16 a[252:255], v[44:47], v[220:223], a[252:255]
    ds_write_b128 v13, a[248:251] offset:8192
    s_nop 6
    ds_write_b128 v13, a[252:255] offset:12288
    s_waitcnt vmcnt(0)
    s_waitcnt lgkmcnt(0)
    s_barrier
    ds_read_b128 v[232:235], v14 offset:0
    ds_read_b128 v[236:239], v14 offset:1024
    ds_read_b128 v[240:243], v14 offset:2048
    ds_read_b128 v[244:247], v14 offset:3072
    s_mov_b32 s80, 4194304
    s_waitcnt lgkmcnt(2)
    v_pk_add_f32 v[232:233], v[232:233], v[236:237]
    v_pk_add_f32 v[234:235], v[234:235], v[238:239]
    v_pk_add_f32 v[224:225], v[224:225], v[232:233]
    v_pk_add_f32 v[226:227], v[226:227], v[234:235]
    s_waitcnt lgkmcnt(0)
    v_pk_add_f32 v[240:241], v[240:241], v[244:245]
    v_pk_add_f32 v[242:243], v[242:243], v[246:247]
    v_pk_add_f32 v[228:229], v[228:229], v[240:241]
    v_pk_add_f32 v[230:231], v[230:231], v[242:243]
    v_cvt_pk_bf16_f32 v244, v224, v228
    v_cvt_pk_bf16_f32 v245, v225, v229
    v_cvt_pk_bf16_f32 v246, v226, v230
    v_cvt_pk_bf16_f32 v247, v227, v231
    s_mov_b64 exec, s[100:101]
    v_swap_b32 v244, v245
    v_swap_b32 v246, v247
    s_mov_b64 exec, -1
    buffer_store_dwordx4 v[244:247], v8, s[44:47], s80 offen sc1
    s_mov_b32 s80, 0
    buffer_load_dword v3, v1, s[44:47], s80 offen sc1
    v_xor_b32 v252, 32, v16
    v_and_b32 v253, 32, v16
    v_mul_u32_u24 v253, 6, v253
    v_sub_u32 v253, v16, v253
    v_add_u32 v253, 384, v253
    s_lshr_b32 s6, s60, 1
    s_mul_i32 s6, s6, 57344
    s_lshl_b32 s5, s60, 6
    s_cmp_eq_u32 s60, 3
    s_cselect_b32 s5, 0, s5
    s_cselect_b64 vcc, -1, 0
    s_sub_u32 s5, s5, s6
    v_cndmask_b32 v248, v16, v253, vcc
    v_cndmask_b32 v249, v252, v253, vcc
    v_add_u32 v248, s5, v248
    v_add_u32 v249, s5, v249
    v_add_u32 v250, 57344, v248
    v_add_u32 v251, 57344, v249
    v_mov_b32 v240, s70
    v_mov_b32 v241, s70
    v_mov_b32 v242, s70
    v_mov_b32 v243, s70
    ds_read_b64_tr_b16 v[96:97], v248 offset:0
    ds_read_b64_tr_b16 v[98:99], v248 offset:3584
    ds_read_b64_tr_b16 v[128:129], v249 offset:0
    ds_read_b64_tr_b16 v[130:131], v249 offset:3584
    ds_read_b64_tr_b16 v[100:101], v248 offset:7168
    ds_read_b64_tr_b16 v[102:103], v248 offset:10752
    s_waitcnt vmcnt(0)
    v_cmp_gt_u32 vcc, 32, v3
    s_cbranch_vccnz .slow_10
.back_11:
    s_mov_b32 s78, 3145728
    buffer_load_dwordx2 v[32:33], v15, s[44:47], s78 offen offset:0 sc1
    ds_read_b64_tr_b16 v[132:133], v249 offset:7168
    ds_read_b64_tr_b16 v[134:135], v249 offset:10752
    ds_read_b64_tr_b16 v[104:105], v248 offset:14336
    ds_read_b64_tr_b16 v[106:107], v248 offset:17920
    ds_read_b64_tr_b16 v[136:137], v249 offset:14336
    ds_read_b64_tr_b16 v[138:139], v249 offset:17920
    buffer_load_dwordx2 v[36:37], v15, s[44:47], s78 offen offset:256 sc1
    ds_read_b64_tr_b16 v[108:109], v248 offset:21504
    ds_read_b64_tr_b16 v[110:111], v248 offset:25088
    ds_read_b64_tr_b16 v[140:141], v249 offset:21504
    ds_read_b64_tr_b16 v[142:143], v249 offset:25088
    s_waitcnt lgkmcnt(12)
    v_mfma_f32_16x16x32_bf16 v[232:235], v[96:99], v[240:243], 0
    v_mfma_f32_16x16x32_bf16 v[236:239], v[128:131], v[240:243], 0
    buffer_load_dwordx2 v[34:35], v15, s[44:47], s78 offen offset:2048 sc1
    ds_read_b64_tr_b16 v[112:113], v248 offset:28672
    ds_read_b64_tr_b16 v[114:115], v248 offset:32256
    ds_read_b64_tr_b16 v[144:145], v249 offset:28672
    ds_read_b64_tr_b16 v[146:147], v249 offset:32256
    s_waitcnt lgkmcnt(12)
    v_mfma_f32_16x16x32_bf16 v[232:235], v[100:103], v[240:243], v[232:235]
    v_mfma_f32_16x16x32_bf16 v[236:239], v[132:135], v[240:243], v[236:239]
    buffer_load_dwordx2 v[38:39], v15, s[44:47], s78 offen offset:2304 sc1
    ds_read_b64_tr_b16 v[116:117], v248 offset:35840
    ds_read_b64_tr_b16 v[118:119], v248 offset:39424
    ds_read_b64_tr_b16 v[148:149], v249 offset:35840
    ds_read_b64_tr_b16 v[150:151], v249 offset:39424
    s_waitcnt lgkmcnt(12)
    v_mfma_f32_16x16x32_bf16 v[232:235], v[104:107], v[240:243], v[232:235]
    v_mfma_f32_16x16x32_bf16 v[236:239], v[136:139], v[240:243], v[236:239]
    s_mov_b32 s78, 3149824
    buffer_load_dwordx2 v[40:41], v15, s[44:47], s78 offen offset:0 sc1
    ds_read_b64_tr_b16 v[120:121], v248 offset:43008
    ds_read_b64_tr_b16 v[122:123], v248 offset:46592
    ds_read_b64_tr_b16 v[152:153], v249 offset:43008
    ds_read_b64_tr_b16 v[154:155], v249 offset:46592
    s_waitcnt lgkmcnt(12)
    v_mfma_f32_16x16x32_bf16 v[232:235], v[108:111], v[240:243], v[232:235]
    v_mfma_f32_16x16x32_bf16 v[236:239], v[140:143], v[240:243], v[236:239]
    buffer_load_dwordx2 v[44:45], v15, s[44:47], s78 offen offset:256 sc1
    ds_read_b64_tr_b16 v[124:125], v248 offset:50176
    ds_read_b64_tr_b16 v[126:127], v248 offset:53760
    ds_read_b64_tr_b16 v[156:157], v249 offset:50176
    ds_read_b64_tr_b16 v[158:159], v249 offset:53760
    s_waitcnt lgkmcnt(12)
    v_mfma_f32_16x16x32_bf16 v[232:235], v[112:115], v[240:243], v[232:235]
    v_mfma_f32_16x16x32_bf16 v[236:239], v[144:147], v[240:243], v[236:239]
    buffer_load_dwordx2 v[42:43], v15, s[44:47], s78 offen offset:2048 sc1
    ds_read_b64_tr_b16 v[96:97], v250 offset:0
    ds_read_b64_tr_b16 v[98:99], v250 offset:3584
    ds_read_b64_tr_b16 v[128:129], v251 offset:0
    ds_read_b64_tr_b16 v[130:131], v251 offset:3584
    s_waitcnt lgkmcnt(12)
    v_mfma_f32_16x16x32_bf16 v[232:235], v[116:119], v[240:243], v[232:235]
    v_mfma_f32_16x16x32_bf16 v[236:239], v[148:151], v[240:243], v[236:239]
    buffer_load_dwordx2 v[46:47], v15, s[44:47], s78 offen offset:2304 sc1
    ds_read_b64_tr_b16 v[100:101], v250 offset:7168
    ds_read_b64_tr_b16 v[102:103], v250 offset:10752
    ds_read_b64_tr_b16 v[132:133], v251 offset:7168
    ds_read_b64_tr_b16 v[134:135], v251 offset:10752
    s_waitcnt lgkmcnt(12)
    v_mfma_f32_16x16x32_bf16 v[232:235], v[120:123], v[240:243], v[232:235]
    v_mfma_f32_16x16x32_bf16 v[236:239], v[152:155], v[240:243], v[236:239]
    s_mov_b32 s78, 3153920
    buffer_load_dwordx2 v[48:49], v15, s[44:47], s78 offen offset:0 sc1
    ds_read_b64_tr_b16 v[104:105], v250 offset:14336
    ds_read_b64_tr_b16 v[106:107], v250 offset:17920
    ds_read_b64_tr_b16 v[136:137], v251 offset:14336
    ds_read_b64_tr_b16 v[138:139], v251 offset:17920
    s_waitcnt lgkmcnt(12)
    v_mfma_f32_16x16x32_bf16 v[232:235], v[124:127], v[240:243], v[232:235]
    v_mfma_f32_16x16x32_bf16 v[236:239], v[156:159], v[240:243], v[236:239]
    buffer_load_dwordx2 v[52:53], v15, s[44:47], s78 offen offset:256 sc1
    ds_read_b64_tr_b16 v[108:109], v250 offset:21504
    ds_read_b64_tr_b16 v[110:111], v250 offset:25088
    ds_read_b64_tr_b16 v[140:141], v251 offset:21504
    ds_read_b64_tr_b16 v[142:143], v251 offset:25088
    s_waitcnt lgkmcnt(12)
    v_mfma_f32_16x16x32_bf16 v[232:235], v[96:99], v[240:243], v[232:235]
    v_mfma_f32_16x16x32_bf16 v[236:239], v[128:131], v[240:243], v[236:239]
    buffer_load_dwordx2 v[50:51], v15, s[44:47], s78 offen offset:2048 sc1
    ds_read_b64_tr_b16 v[112:113], v250 offset:28672
    ds_read_b64_tr_b16 v[114:115], v250 offset:32256
    ds_read_b64_tr_b16 v[144:145], v251 offset:28672
    ds_read_b64_tr_b16 v[146:147], v251 offset:32256
    s_waitcnt lgkmcnt(12)
    v_mfma_f32_16x16x32_bf16 v[232:235], v[100:103], v[240:243], v[232:235]
    v_mfma_f32_16x16x32_bf16 v[236:239], v[132:135], v[240:243], v[236:239]
    buffer_load_dwordx2 v[54:55], v15, s[44:47], s78 offen offset:2304 sc1
    ds_read_b64_tr_b16 v[116:117], v250 offset:35840
    ds_read_b64_tr_b16 v[118:119], v250 offset:39424
    ds_read_b64_tr_b16 v[148:149], v251 offset:35840
    ds_read_b64_tr_b16 v[150:151], v251 offset:39424
    s_waitcnt lgkmcnt(12)
    v_mfma_f32_16x16x32_bf16 v[232:235], v[104:107], v[240:243], v[232:235]
    v_mfma_f32_16x16x32_bf16 v[236:239], v[136:139], v[240:243], v[236:239]
    s_mov_b32 s78, 3158016
    buffer_load_dwordx2 v[56:57], v15, s[44:47], s78 offen offset:0 sc1
    ds_read_b64_tr_b16 v[120:121], v250 offset:43008
    ds_read_b64_tr_b16 v[122:123], v250 offset:46592
    ds_read_b64_tr_b16 v[152:153], v251 offset:43008
    ds_read_b64_tr_b16 v[154:155], v251 offset:46592
    s_waitcnt lgkmcnt(12)
    v_mfma_f32_16x16x32_bf16 v[232:235], v[108:111], v[240:243], v[232:235]
    v_mfma_f32_16x16x32_bf16 v[236:239], v[140:143], v[240:243], v[236:239]
    buffer_load_dwordx2 v[60:61], v15, s[44:47], s78 offen offset:256 sc1
    ds_read_b64_tr_b16 v[124:125], v250 offset:50176
    ds_read_b64_tr_b16 v[126:127], v250 offset:53760
    ds_read_b64_tr_b16 v[156:157], v251 offset:50176
    ds_read_b64_tr_b16 v[158:159], v251 offset:53760
    s_waitcnt lgkmcnt(12)
    v_mfma_f32_16x16x32_bf16 v[232:235], v[112:115], v[240:243], v[232:235]
    v_mfma_f32_16x16x32_bf16 v[236:239], v[144:147], v[240:243], v[236:239]
    buffer_load_dwordx2 v[58:59], v15, s[44:47], s78 offen offset:2048 sc1
    s_waitcnt lgkmcnt(8)
    v_mfma_f32_16x16x32_bf16 v[232:235], v[116:119], v[240:243], v[232:235]
    v_mfma_f32_16x16x32_bf16 v[236:239], v[148:151], v[240:243], v[236:239]
    s_waitcnt lgkmcnt(4)
    v_mfma_f32_16x16x32_bf16 v[232:235], v[120:123], v[240:243], v[232:235]
    v_mfma_f32_16x16x32_bf16 v[236:239], v[152:155], v[240:243], v[236:239]
    s_waitcnt lgkmcnt(0)
    buffer_load_dwordx2 v[62:63], v15, s[44:47], s78 offen offset:2304 sc1
    v_mfma_f32_16x16x32_bf16 v[232:235], v[124:127], v[240:243], v[232:235]
    v_mfma_f32_16x16x32_bf16 v[236:239], v[156:159], v[240:243], v[236:239]
    s_lshl_b32 s5, s60, 7
    v_add_u32 v5, s5, v21
    s_nop 4
    ds_write_b128 v5, v[232:235]
    ds_write_b128 v5, v[236:239] offset:64
    v_xor_b32 v252, 32, v16
    v_and_b32 v253, 32, v16
    v_mul_u32_u24 v253, 6, v253
    v_sub_u32 v253, v16, v253
    v_add_u32 v253, 384, v253
    ds_read_b64_tr_b16 v[160:161], v16 offset:0
    ds_read_b64_tr_b16 v[162:163], v16 offset:3584
    ds_read_b64_tr_b16 v[164:165], v252 offset:0
    ds_read_b64_tr_b16 v[166:167], v252 offset:3584
    ds_read_b64_tr_b16 v[168:169], v16 offset:64
    ds_read_b64_tr_b16 v[170:171], v16 offset:3648
    ds_read_b64_tr_b16 v[172:173], v252 offset:64
    ds_read_b64_tr_b16 v[174:175], v252 offset:3648
    ds_read_b64_tr_b16 v[176:177], v16 offset:128
    ds_read_b64_tr_b16 v[178:179], v16 offset:3712
    ds_read_b64_tr_b16 v[180:181], v252 offset:128
    ds_read_b64_tr_b16 v[182:183], v252 offset:3712
    ds_read_b64_tr_b16 v[184:185], v253 offset:0
    ds_read_b64_tr_b16 v[186:187], v253 offset:3584
    s_waitcnt lgkmcnt(14)
    s_waitcnt vmcnt(12)
    v_swap_b32 v33, v36
    v_swap_b32 v35, v38
    s_barrier
    s_mov_b32 s80, 32768
    s_mov_b64 exec, s[76:77]
    v_mov_b32 v5, 1
    buffer_atomic_add v5, v2, s[44:47], s80 offen sc1
    s_mov_b64 exec, -1
    s_waitcnt lgkmcnt(6)
    v_mfma_f32_16x16x32_bf16 a[224:227], v[160:163], v[36:39], 0
    ds_read_b64_tr_b16 v[188:189], v16 offset:7168
    s_mov_b32 s78, 3162112
    buffer_load_dwordx2 v[64:65], v15, s[44:47], s78 offen offset:0 sc1
    v_mfma_f32_16x16x32_bf16 v[224:227], v[160:163], v[32:35], 0
    ds_read_b64_tr_b16 v[190:191], v16 offset:10752
    v_mfma_f32_16x16x32_bf16 a[228:231], v[164:167], v[36:39], 0
    ds_read_b64_tr_b16 v[192:193], v252 offset:7168
    v_mfma_f32_16x16x32_bf16 v[228:231], v[164:167], v[32:35], 0
    ds_read_b64_tr_b16 v[194:195], v252 offset:10752
    v_mfma_f32_16x16x32_bf16 a[232:235], v[168:171], v[36:39], 0
    ds_read_b64_tr_b16 v[196:197], v16 offset:7232
    buffer_load_dwordx2 v[68:69], v15, s[44:47], s78 offen offset:256 sc1
    v_mfma_f32_16x16x32_bf16 v[232:235], v[168:171], v[32:35], 0
    ds_read_b64_tr_b16 v[198:199], v16 offset:10816
    v_mfma_f32_16x16x32_bf16 a[236:239], v[172:175], v[36:39], 0
    ds_read_b64_tr_b16 v[200:201], v252 offset:7232
    v_mfma_f32_16x16x32_bf16 v[236:239], v[172:175], v[32:35], 0
    ds_read_b64_tr_b16 v[202:203], v252 offset:10816
    s_waitcnt lgkmcnt(8)
    v_mfma_f32_16x16x32_bf16 a[240:243], v[176:179], v[36:39], 0
    ds_read_b64_tr_b16 v[204:205], v16 offset:7296
    buffer_load_dwordx2 v[66:67], v15, s[44:47], s78 offen offset:2048 sc1
    v_mfma_f32_16x16x32_bf16 v[240:243], v[176:179], v[32:35], 0
    ds_read_b64_tr_b16 v[206:207], v16 offset:10880
    v_mfma_f32_16x16x32_bf16 a[244:247], v[180:183], v[36:39], 0
    ds_read_b64_tr_b16 v[208:209], v252 offset:7296
    v_mfma_f32_16x16x32_bf16 v[244:247], v[180:183], v[32:35], 0
    ds_read_b64_tr_b16 v[210:211], v252 offset:10880
    s_waitcnt vmcnt(12)
    v_swap_b32 v41, v44
    v_swap_b32 v43, v46
    v_mfma_f32_16x16x32_bf16 a[248:251], v[184:187], v[36:39], 0
    ds_read_b64_tr_b16 v[212:213], v253 offset:7168
    buffer_load_dwordx2 v[70:71], v15, s[44:47], s78 offen offset:2304 sc1
    v_mfma_f32_16x16x32_bf16 v[248:251], v[184:187], v[32:35], 0
    ds_read_b64_tr_b16 v[214:215], v253 offset:10752
    s_waitcnt lgkmcnt(6)
    v_mfma_f32_16x16x32_bf16 a[224:227], v[188:191], v[44:47], a[224:227]
    ds_read_b64_tr_b16 v[160:161], v16 offset:14336
    s_mov_b32 s78, 3166208
    buffer_load_dwordx2 v[72:73], v15, s[44:47], s78 offen offset:0 sc1
    v_mfma_f32_16x16x32_bf16 v[224:227], v[188:191], v[40:43], v[224:227]
    ds_read_b64_tr_b16 v[162:163], v16 offset:17920
    v_mfma_f32_16x16x32_bf16 a[228:231], v[192:195], v[44:47], a[228:231]
    ds_read_b64_tr_b16 v[164:165], v252 offset:14336
    v_mfma_f32_16x16x32_bf16 v[228:231], v[192:195], v[40:43], v[228:231]
    ds_read_b64_tr_b16 v[166:167], v252 offset:17920
    v_mfma_f32_16x16x32_bf16 a[232:235], v[196:199], v[44:47], a[232:235]
    ds_read_b64_tr_b16 v[168:169], v16 offset:14400
    buffer_load_dwordx2 v[76:77], v15, s[44:47], s78 offen offset:256 sc1
    v_mfma_f32_16x16x32_bf16 v[232:235], v[196:199], v[40:43], v[232:235]
    ds_read_b64_tr_b16 v[170:171], v16 offset:17984
    v_mfma_f32_16x16x32_bf16 a[236:239], v[200:203], v[44:47], a[236:239]
    ds_read_b64_tr_b16 v[172:173], v252 offset:14400
    v_mfma_f32_16x16x32_bf16 v[236:239], v[200:203], v[40:43], v[236:239]
    ds_read_b64_tr_b16 v[174:175], v252 offset:17984
    s_waitcnt lgkmcnt(8)
    v_mfma_f32_16x16x32_bf16 a[240:243], v[204:207], v[44:47], a[240:243]
    ds_read_b64_tr_b16 v[176:177], v16 offset:14464
    buffer_load_dwordx2 v[74:75], v15, s[44:47], s78 offen offset:2048 sc1
    v_mfma_f32_16x16x32_bf16 v[240:243], v[204:207], v[40:43], v[240:243]
    ds_read_b64_tr_b16 v[178:179], v16 offset:18048
    v_mfma_f32_16x16x32_bf16 a[244:247], v[208:211], v[44:47], a[244:247]
    ds_read_b64_tr_b16 v[180:181], v252 offset:14464
    v_mfma_f32_16x16x32_bf16 v[244:247], v[208:211], v[40:43], v[244:247]
    ds_read_b64_tr_b16 v[182:183], v252 offset:18048
    s_waitcnt vmcnt(12)
    v_swap_b32 v49, v52
    v_swap_b32 v51, v54
    v_mfma_f32_16x16x32_bf16 a[248:251], v[212:215], v[44:47], a[248:251]
    ds_read_b64_tr_b16 v[184:185], v253 offset:14336
    buffer_load_dwordx2 v[78:79], v15, s[44:47], s78 offen offset:2304 sc1
    v_mfma_f32_16x16x32_bf16 v[248:251], v[212:215], v[40:43], v[248:251]
    ds_read_b64_tr_b16 v[186:187], v253 offset:17920
    s_waitcnt lgkmcnt(6)
    v_mfma_f32_16x16x32_bf16 a[224:227], v[160:163], v[52:55], a[224:227]
    ds_read_b64_tr_b16 v[188:189], v16 offset:21504
    s_mov_b32 s78, 3170304
    buffer_load_dwordx2 v[80:81], v15, s[44:47], s78 offen offset:0 sc1
    v_mfma_f32_16x16x32_bf16 v[224:227], v[160:163], v[48:51], v[224:227]
    ds_read_b64_tr_b16 v[190:191], v16 offset:25088
    v_mfma_f32_16x16x32_bf16 a[228:231], v[164:167], v[52:55], a[228:231]
    ds_read_b64_tr_b16 v[192:193], v252 offset:21504
    v_mfma_f32_16x16x32_bf16 v[228:231], v[164:167], v[48:51], v[228:231]
    ds_read_b64_tr_b16 v[194:195], v252 offset:25088
    v_mfma_f32_16x16x32_bf16 a[232:235], v[168:171], v[52:55], a[232:235]
    ds_read_b64_tr_b16 v[196:197], v16 offset:21568
    buffer_load_dwordx2 v[84:85], v15, s[44:47], s78 offen offset:256 sc1
    v_mfma_f32_16x16x32_bf16 v[232:235], v[168:171], v[48:51], v[232:235]
    ds_read_b64_tr_b16 v[198:199], v16 offset:25152
    v_mfma_f32_16x16x32_bf16 a[236:239], v[172:175], v[52:55], a[236:239]
    ds_read_b64_tr_b16 v[200:201], v252 offset:21568
    v_mfma_f32_16x16x32_bf16 v[236:239], v[172:175], v[48:51], v[236:239]
    ds_read_b64_tr_b16 v[202:203], v252 offset:25152
    s_waitcnt lgkmcnt(8)
    v_mfma_f32_16x16x32_bf16 a[240:243], v[176:179], v[52:55], a[240:243]
    ds_read_b64_tr_b16 v[204:205], v16 offset:21632
    buffer_load_dwordx2 v[82:83], v15, s[44:47], s78 offen offset:2048 sc1
    v_mfma_f32_16x16x32_bf16 v[240:243], v[176:179], v[48:51], v[240:243]
    ds_read_b64_tr_b16 v[206:207], v16 offset:25216
    v_mfma_f32_16x16x32_bf16 a[244:247], v[180:183], v[52:55], a[244:247]
    ds_read_b64_tr_b16 v[208:209], v252 offset:21632
    v_mfma_f32_16x16x32_bf16 v[244:247], v[180:183], v[48:51], v[244:247]
    ds_read_b64_tr_b16 v[210:211], v252 offset:25216
    s_waitcnt vmcnt(12)
    v_swap_b32 v57, v60
    v_swap_b32 v59, v62
    v_mfma_f32_16x16x32_bf16 a[248:251], v[184:187], v[52:55], a[248:251]
    ds_read_b64_tr_b16 v[212:213], v253 offset:21504
    buffer_load_dwordx2 v[86:87], v15, s[44:47], s78 offen offset:2304 sc1
    v_mfma_f32_16x16x32_bf16 v[248:251], v[184:187], v[48:51], v[248:251]
    ds_read_b64_tr_b16 v[214:215], v253 offset:25088
    s_waitcnt lgkmcnt(6)
    v_mfma_f32_16x16x32_bf16 a[224:227], v[188:191], v[60:63], a[224:227]
    ds_read_b64_tr_b16 v[160:161], v16 offset:28672
    s_mov_b32 s78, 3174400
    buffer_load_dwordx2 v[88:89], v15, s[44:47], s78 offen offset:0 sc1
    v_mfma_f32_16x16x32_bf16 v[224:227], v[188:191], v[56:59], v[224:227]
    ds_read_b64_tr_b16 v[162:163], v16 offset:32256
    v_mfma_f32_16x16x32_bf16 a[228:231], v[192:195], v[60:63], a[228:231]
    ds_read_b64_tr_b16 v[164:165], v252 offset:28672
    v_mfma_f32_16x16x32_bf16 v[228:231], v[192:195], v[56:59], v[228:231]
    ds_read_b64_tr_b16 v[166:167], v252 offset:32256
    v_mfma_f32_16x16x32_bf16 a[232:235], v[196:199], v[60:63], a[232:235]
    ds_read_b64_tr_b16 v[168:169], v16 offset:28736
    buffer_load_dwordx2 v[92:93], v15, s[44:47], s78 offen offset:256 sc1
    v_mfma_f32_16x16x32_bf16 v[232:235], v[196:199], v[56:59], v[232:235]
    ds_read_b64_tr_b16 v[170:171], v16 offset:32320
    v_mfma_f32_16x16x32_bf16 a[236:239], v[200:203], v[60:63], a[236:239]
    ds_read_b64_tr_b16 v[172:173], v252 offset:28736
    v_mfma_f32_16x16x32_bf16 v[236:239], v[200:203], v[56:59], v[236:239]
    ds_read_b64_tr_b16 v[174:175], v252 offset:32320
    s_waitcnt lgkmcnt(8)
    v_mfma_f32_16x16x32_bf16 a[240:243], v[204:207], v[60:63], a[240:243]
    ds_read_b64_tr_b16 v[176:177], v16 offset:28800
    buffer_load_dwordx2 v[90:91], v15, s[44:47], s78 offen offset:2048 sc1
    v_mfma_f32_16x16x32_bf16 v[240:243], v[204:207], v[56:59], v[240:243]
    ds_read_b64_tr_b16 v[178:179], v16 offset:32384
    v_mfma_f32_16x16x32_bf16 a[244:247], v[208:211], v[60:63], a[244:247]
    ds_read_b64_tr_b16 v[180:181], v252 offset:28800
    v_mfma_f32_16x16x32_bf16 v[244:247], v[208:211], v[56:59], v[244:247]
    ds_read_b64_tr_b16 v[182:183], v252 offset:32384
    s_waitcnt vmcnt(11)
    v_swap_b32 v65, v68
    v_swap_b32 v67, v70
    v_mfma_f32_16x16x32_bf16 a[248:251], v[212:215], v[60:63], a[248:251]
    ds_read_b64_tr_b16 v[184:185], v253 offset:28672
    buffer_load_dwordx2 v[94:95], v15, s[44:47], s78 offen offset:2304 sc1
    v_mfma_f32_16x16x32_bf16 v[248:251], v[212:215], v[56:59], v[248:251]
    ds_read_b64_tr_b16 v[186:187], v253 offset:32256
    s_waitcnt lgkmcnt(6)
    v_mfma_f32_16x16x32_bf16 a[224:227], v[160:163], v[68:71], a[224:227]
    ds_read_b64_tr_b16 v[188:189], v16 offset:35840
    s_add_u32 s79, s81, 0
    buffer_load_dwordx4 a[0:3], v6, s[44:47], s79 offen offset:0 sc1
    v_mfma_f32_16x16x32_bf16 v[224:227], v[160:163], v[64:67], v[224:227]
    ds_read_b64_tr_b16 v[190:191], v16 offset:39424
    v_mfma_f32_16x16x32_bf16 a[228:231], v[164:167], v[68:71], a[228:231]
    ds_read_b64_tr_b16 v[192:193], v252 offset:35840
    v_mfma_f32_16x16x32_bf16 v[228:231], v[164:167], v[64:67], v[228:231]
    ds_read_b64_tr_b16 v[194:195], v252 offset:39424
    v_mfma_f32_16x16x32_bf16 a[232:235], v[168:171], v[68:71], a[232:235]
    ds_read_b64_tr_b16 v[196:197], v16 offset:35904
    buffer_load_dwordx4 a[4:7], v6, s[44:47], s79 offen offset:1024 sc1
    v_mfma_f32_16x16x32_bf16 v[232:235], v[168:171], v[64:67], v[232:235]
    ds_read_b64_tr_b16 v[198:199], v16 offset:39488
    v_mfma_f32_16x16x32_bf16 a[236:239], v[172:175], v[68:71], a[236:239]
    ds_read_b64_tr_b16 v[200:201], v252 offset:35904
    v_mfma_f32_16x16x32_bf16 v[236:239], v[172:175], v[64:67], v[236:239]
    ds_read_b64_tr_b16 v[202:203], v252 offset:39488
    s_waitcnt lgkmcnt(8)
    v_mfma_f32_16x16x32_bf16 a[240:243], v[176:179], v[68:71], a[240:243]
    ds_read_b64_tr_b16 v[204:205], v16 offset:35968
    buffer_load_dwordx4 a[8:11], v6, s[44:47], s79 offen offset:2048 sc1
    v_mfma_f32_16x16x32_bf16 v[240:243], v[176:179], v[64:67], v[240:243]
    ds_read_b64_tr_b16 v[206:207], v16 offset:39552
    v_mfma_f32_16x16x32_bf16 a[244:247], v[180:183], v[68:71], a[244:247]
    ds_read_b64_tr_b16 v[208:209], v252 offset:35968
    v_mfma_f32_16x16x32_bf16 v[244:247], v[180:183], v[64:67], v[244:247]
    ds_read_b64_tr_b16 v[210:211], v252 offset:39552
    s_waitcnt vmcnt(11)
    v_swap_b32 v73, v76
    v_swap_b32 v75, v78
    v_mfma_f32_16x16x32_bf16 a[248:251], v[184:187], v[68:71], a[248:251]
    ds_read_b64_tr_b16 v[212:213], v253 offset:35840
    buffer_load_dwordx4 a[12:15], v6, s[44:47], s79 offen offset:3072 sc1
    v_mfma_f32_16x16x32_bf16 v[248:251], v[184:187], v[64:67], v[248:251]
    ds_read_b64_tr_b16 v[214:215], v253 offset:39424
    s_waitcnt lgkmcnt(6)
    v_mfma_f32_16x16x32_bf16 a[224:227], v[188:191], v[76:79], a[224:227]
    ds_read_b64_tr_b16 v[160:161], v16 offset:43008
    s_add_u32 s79, s81, 4096
    buffer_load_dwordx4 a[16:19], v6, s[44:47], s79 offen offset:0 sc1
    v_mfma_f32_16x16x32_bf16 v[224:227], v[188:191], v[72:75], v[224:227]
    ds_read_b64_tr_b16 v[162:163], v16 offset:46592
    v_mfma_f32_16x16x32_bf16 a[228:231], v[192:195], v[76:79], a[228:231]
    ds_read_b64_tr_b16 v[164:165], v252 offset:43008
    v_mfma_f32_16x16x32_bf16 v[228:231], v[192:195], v[72:75], v[228:231]
    ds_read_b64_tr_b16 v[166:167], v252 offset:46592
    v_mfma_f32_16x16x32_bf16 a[232:235], v[196:199], v[76:79], a[232:235]
    ds_read_b64_tr_b16 v[168:169], v16 offset:43072
    buffer_load_dwordx4 a[20:23], v6, s[44:47], s79 offen offset:1024 sc1
    v_mfma_f32_16x16x32_bf16 v[232:235], v[196:199], v[72:75], v[232:235]
    ds_read_b64_tr_b16 v[170:171], v16 offset:46656
    v_mfma_f32_16x16x32_bf16 a[236:239], v[200:203], v[76:79], a[236:239]
    ds_read_b64_tr_b16 v[172:173], v252 offset:43072
    v_mfma_f32_16x16x32_bf16 v[236:239], v[200:203], v[72:75], v[236:239]
    ds_read_b64_tr_b16 v[174:175], v252 offset:46656
    s_waitcnt lgkmcnt(8)
    v_mfma_f32_16x16x32_bf16 a[240:243], v[204:207], v[76:79], a[240:243]
    ds_read_b64_tr_b16 v[176:177], v16 offset:43136
    buffer_load_dwordx4 a[24:27], v6, s[44:47], s79 offen offset:2048 sc1
    v_mfma_f32_16x16x32_bf16 v[240:243], v[204:207], v[72:75], v[240:243]
    ds_read_b64_tr_b16 v[178:179], v16 offset:46720
    v_mfma_f32_16x16x32_bf16 a[244:247], v[208:211], v[76:79], a[244:247]
    ds_read_b64_tr_b16 v[180:181], v252 offset:43136
    v_mfma_f32_16x16x32_bf16 v[244:247], v[208:211], v[72:75], v[244:247]
    ds_read_b64_tr_b16 v[182:183], v252 offset:46720
    s_waitcnt vmcnt(11)
    v_swap_b32 v81, v84
    v_swap_b32 v83, v86
    v_mfma_f32_16x16x32_bf16 a[248:251], v[212:215], v[76:79], a[248:251]
    ds_read_b64_tr_b16 v[184:185], v253 offset:43008
    buffer_load_dwordx4 a[28:31], v6, s[44:47], s79 offen offset:3072 sc1
    v_mfma_f32_16x16x32_bf16 v[248:251], v[212:215], v[72:75], v[248:251]
    ds_read_b64_tr_b16 v[186:187], v253 offset:46592
    s_waitcnt lgkmcnt(6)
    v_mfma_f32_16x16x32_bf16 a[224:227], v[160:163], v[84:87], a[224:227]
    ds_read_b64_tr_b16 v[188:189], v16 offset:50176
    s_add_u32 s79, s81, 8192
    buffer_load_dwordx4 a[32:35], v6, s[44:47], s79 offen offset:0 sc1
    v_mfma_f32_16x16x32_bf16 v[224:227], v[160:163], v[80:83], v[224:227]
    ds_read_b64_tr_b16 v[190:191], v16 offset:53760
    v_mfma_f32_16x16x32_bf16 a[228:231], v[164:167], v[84:87], a[228:231]
    ds_read_b64_tr_b16 v[192:193], v252 offset:50176
    v_mfma_f32_16x16x32_bf16 v[228:231], v[164:167], v[80:83], v[228:231]
    ds_read_b64_tr_b16 v[194:195], v252 offset:53760
    v_mfma_f32_16x16x32_bf16 a[232:235], v[168:171], v[84:87], a[232:235]
    ds_read_b64_tr_b16 v[196:197], v16 offset:50240
    buffer_load_dwordx4 a[36:39], v6, s[44:47], s79 offen offset:1024 sc1
    v_mfma_f32_16x16x32_bf16 v[232:235], v[168:171], v[80:83], v[232:235]
    ds_read_b64_tr_b16 v[198:199], v16 offset:53824
    v_mfma_f32_16x16x32_bf16 a[236:239], v[172:175], v[84:87], a[236:239]
    ds_read_b64_tr_b16 v[200:201], v252 offset:50240
    v_mfma_f32_16x16x32_bf16 v[236:239], v[172:175], v[80:83], v[236:239]
    ds_read_b64_tr_b16 v[202:203], v252 offset:53824
    s_waitcnt lgkmcnt(8)
    v_mfma_f32_16x16x32_bf16 a[240:243], v[176:179], v[84:87], a[240:243]
    ds_read_b64_tr_b16 v[204:205], v16 offset:50304
    buffer_load_dwordx4 a[40:43], v6, s[44:47], s79 offen offset:2048 sc1
    v_mfma_f32_16x16x32_bf16 v[240:243], v[176:179], v[80:83], v[240:243]
    ds_read_b64_tr_b16 v[206:207], v16 offset:53888
    v_mfma_f32_16x16x32_bf16 a[244:247], v[180:183], v[84:87], a[244:247]
    ds_read_b64_tr_b16 v[208:209], v252 offset:50304
    v_mfma_f32_16x16x32_bf16 v[244:247], v[180:183], v[80:83], v[244:247]
    ds_read_b64_tr_b16 v[210:211], v252 offset:53888
    s_waitcnt vmcnt(11)
    v_swap_b32 v89, v92
    v_swap_b32 v91, v94
    v_mfma_f32_16x16x32_bf16 a[248:251], v[184:187], v[84:87], a[248:251]
    ds_read_b64_tr_b16 v[212:213], v253 offset:50176
    buffer_load_dwordx4 a[44:47], v6, s[44:47], s79 offen offset:3072 sc1
    v_mfma_f32_16x16x32_bf16 v[248:251], v[184:187], v[80:83], v[248:251]
    ds_read_b64_tr_b16 v[214:215], v253 offset:53760
    s_waitcnt lgkmcnt(6)
    v_mfma_f32_16x16x32_bf16 a[224:227], v[188:191], v[92:95], a[224:227]
    ds_read_b128 v[160:163], v21 offset:0
    v_mov_b32 v220, 0x3e803e80
    v_mfma_f32_16x16x32_bf16 a[228:231], v[192:195], v[92:95], a[228:231]
    ds_read_b128 v[164:167], v21 offset:64
    v_mov_b32 v221, 0x3e803e80
    v_mfma_f32_16x16x32_bf16 a[232:235], v[196:199], v[92:95], a[232:235]
    ds_read_b128 v[168:171], v21 offset:128
    v_mov_b32 v222, 0x3e803e80
    v_mfma_f32_16x16x32_bf16 a[236:239], v[200:203], v[92:95], a[236:239]
    ds_read_b128 v[172:175], v21 offset:192
    v_mov_b32 v223, 0x3e803e80
    s_waitcnt lgkmcnt(4)
    v_mfma_f32_16x16x32_bf16 a[240:243], v[204:207], v[92:95], a[240:243]
    ds_read_b128 v[176:179], v21 offset:256
    v_mfma_f32_16x16x32_bf16 a[244:247], v[208:211], v[92:95], a[244:247]
    ds_read_b128 v[180:183], v21 offset:320
    v_mfma_f32_16x16x32_bf16 a[248:251], v[212:215], v[92:95], a[248:251]
    ds_read_b128 v[184:187], v21 offset:384
    v_mfma_f32_16x16x32_bf16 v[224:227], v[188:191], v[88:91], v[224:227]
    ds_write_b128 v17, a[224:227] offset:0
    v_mfma_f32_16x16x32_bf16 v[228:231], v[192:195], v[88:91], v[228:231]
    v_mfma_f32_16x16x32_bf16 v[232:235], v[196:199], v[88:91], v[232:235]
    ds_write_b128 v17, a[228:231] offset:1024
    v_mfma_f32_16x16x32_bf16 v[236:239], v[200:203], v[88:91], v[236:239]
    v_mfma_f32_16x16x32_bf16 v[240:243], v[204:207], v[88:91], v[240:243]
    v_mfma_f32_16x16x32_bf16 v[244:247], v[208:211], v[88:91], v[244:247]
    v_mfma_f32_16x16x32_bf16 v[248:251], v[212:215], v[88:91], v[248:251]
    s_mov_b32 s80, 32768
    buffer_load_dword v3, v1, s[44:47], s80 offen sc1
    v_mfma_f32_16x16x32_bf16 v[188:191], v[220:223], v[32:35], 0
    ds_write_b128 v17, a[232:235] offset:2048
    s_add_u32 s79, s81, 12288
    buffer_load_dwordx4 a[48:51], v6, s[44:47], s79 offen offset:0 sc1
    v_mfma_f32_16x16x32_bf16 v[192:195], v[220:223], v[36:39], 0
    v_mfma_f32_16x16x32_bf16 v[188:191], v[220:223], v[40:43], v[188:191]
    v_mfma_f32_16x16x32_bf16 v[192:195], v[220:223], v[44:47], v[192:195]
    ds_write_b128 v17, a[236:239] offset:3072
    v_mfma_f32_16x16x32_bf16 v[188:191], v[220:223], v[48:51], v[188:191]
    buffer_load_dwordx4 a[52:55], v6, s[44:47], s79 offen offset:1024 sc1
    v_mfma_f32_16x16x32_bf16 v[192:195], v[220:223], v[52:55], v[192:195]
    v_mfma_f32_16x16x32_bf16 v[188:191], v[220:223], v[56:59], v[188:191]
    ds_write_b128 v17, a[240:243] offset:4096
    v_mfma_f32_16x16x32_bf16 v[192:195], v[220:223], v[60:63], v[192:195]
    v_mfma_f32_16x16x32_bf16 v[188:191], v[220:223], v[64:67], v[188:191]
    buffer_load_dwordx4 a[56:59], v6, s[44:47], s79 offen offset:2048 sc1
    v_mfma_f32_16x16x32_bf16 v[192:195], v[220:223], v[68:71], v[192:195]
    ds_write_b128 v17, a[244:247] offset:5120
    v_mfma_f32_16x16x32_bf16 v[188:191], v[220:223], v[72:75], v[188:191]
    v_mfma_f32_16x16x32_bf16 v[192:195], v[220:223], v[76:79], v[192:195]
    v_mfma_f32_16x16x32_bf16 v[188:191], v[220:223], v[80:83], v[188:191]
    buffer_load_dwordx4 a[60:63], v6, s[44:47], s79 offen offset:3072 sc1
    ds_write_b128 v17, a[248:251] offset:6144
    v_mfma_f32_16x16x32_bf16 v[192:195], v[220:223], v[84:87], v[192:195]
    v_mfma_f32_16x16x32_bf16 v[188:191], v[220:223], v[88:91], v[188:191]
    v_mfma_f32_16x16x32_bf16 v[192:195], v[220:223], v[92:95], v[192:195]
    s_add_u32 s79, s81, 16384
    buffer_load_dwordx4 a[64:67], v6, s[44:47], s79 offen offset:0 sc1
    v_dot2_f32_bf16 v217, v32, v32, 0
    v_dot2_f32_bf16 v219, v36, v36, 0
    v_dot2_f32_bf16 v221, v33, v33, 0
    v_dot2_f32_bf16 v223, v37, v37, 0
    v_dot2c_f32_bf16 v217, v34, v34
    v_dot2c_f32_bf16 v219, v38, v38
    buffer_load_dwordx4 a[68:71], v6, s[44:47], s79 offen offset:1024 sc1
    v_dot2c_f32_bf16 v221, v35, v35
    v_dot2c_f32_bf16 v223, v39, v39
    v_dot2c_f32_bf16 v217, v40, v40
    v_dot2c_f32_bf16 v219, v44, v44
    v_dot2c_f32_bf16 v221, v41, v41
    v_dot2c_f32_bf16 v223, v45, v45
    v_dot2c_f32_bf16 v217, v42, v42
    buffer_load_dwordx4 a[72:75], v6, s[44:47], s79 offen offset:2048 sc1
    v_dot2c_f32_bf16 v219, v46, v46
    v_dot2c_f32_bf16 v221, v43, v43
    v_dot2c_f32_bf16 v223, v47, v47
    v_dot2c_f32_bf16 v217, v48, v48
    v_dot2c_f32_bf16 v219, v52, v52
    v_dot2c_f32_bf16 v221, v49, v49
    buffer_load_dwordx4 a[76:79], v6, s[44:47], s79 offen offset:3072 sc1
    v_dot2c_f32_bf16 v223, v53, v53
    v_dot2c_f32_bf16 v217, v50, v50
    v_dot2c_f32_bf16 v219, v54, v54
    v_dot2c_f32_bf16 v221, v51, v51
    v_dot2c_f32_bf16 v223, v55, v55
    v_dot2c_f32_bf16 v217, v56, v56
    v_dot2c_f32_bf16 v219, v60, v60
    s_add_u32 s79, s81, 20480
    buffer_load_dwordx4 a[80:83], v6, s[44:47], s79 offen offset:0 sc1
    v_dot2c_f32_bf16 v221, v57, v57
    v_dot2c_f32_bf16 v223, v61, v61
    v_dot2c_f32_bf16 v217, v58, v58
    v_dot2c_f32_bf16 v219, v62, v62
    v_dot2c_f32_bf16 v221, v59, v59
    v_dot2c_f32_bf16 v223, v63, v63
    buffer_load_dwordx4 a[84:87], v6, s[44:47], s79 offen offset:1024 sc1
    v_dot2c_f32_bf16 v217, v64, v64
    v_dot2c_f32_bf16 v219, v68, v68
    v_dot2c_f32_bf16 v221, v65, v65
    v_dot2c_f32_bf16 v223, v69, v69
    v_dot2c_f32_bf16 v217, v66, v66
    v_dot2c_f32_bf16 v219, v70, v70
    v_dot2c_f32_bf16 v221, v67, v67
    buffer_load_dwordx4 a[88:91], v6, s[44:47], s79 offen offset:2048 sc1
    v_dot2c_f32_bf16 v223, v71, v71
    v_dot2c_f32_bf16 v217, v72, v72
    v_dot2c_f32_bf16 v219, v76, v76
    v_dot2c_f32_bf16 v221, v73, v73
    v_dot2c_f32_bf16 v223, v77, v77
    v_dot2c_f32_bf16 v217, v74, v74
    buffer_load_dwordx4 a[92:95], v6, s[44:47], s79 offen offset:3072 sc1
    v_dot2c_f32_bf16 v219, v78, v78
    v_dot2c_f32_bf16 v221, v75, v75
    v_dot2c_f32_bf16 v223, v79, v79
    v_dot2c_f32_bf16 v217, v80, v80
    v_dot2c_f32_bf16 v219, v84, v84
    v_dot2c_f32_bf16 v221, v81, v81
    v_dot2c_f32_bf16 v223, v85, v85
    s_add_u32 s79, s81, 24576
    buffer_load_dwordx4 a[96:99], v6, s[44:47], s79 offen offset:0 sc1
    v_dot2c_f32_bf16 v217, v82, v82
    v_dot2c_f32_bf16 v219, v86, v86
    v_dot2c_f32_bf16 v221, v83, v83
    v_dot2c_f32_bf16 v223, v87, v87
    v_dot2c_f32_bf16 v217, v88, v88
    v_dot2c_f32_bf16 v219, v92, v92
    buffer_load_dwordx4 a[100:103], v6, s[44:47], s79 offen offset:1024 sc1
    v_dot2c_f32_bf16 v221, v89, v89
    v_dot2c_f32_bf16 v223, v93, v93
    v_dot2c_f32_bf16 v217, v90, v90
    v_dot2c_f32_bf16 v219, v94, v94
    v_dot2c_f32_bf16 v221, v91, v91
    v_dot2c_f32_bf16 v223, v95, v95
    v_permlane32_swap_b32 v188, v192
    s_nop 0
    v_add_f32 v217, v217, v221
    v_add_f32 v219, v219, v223
    v_add_f32 v216, v188, v192
    s_nop 0
    v_permlane32_swap_b32 v217, v219
    v_add_f32 v217, v217, v219
    s_nop 1
    v_permlane16_swap_b32 v216, v217
    v_add_f32 v216, v216, v217
    ds_write_b32 v19, v216
    s_waitcnt lgkmcnt(0)
    s_barrier
    ds_read2_b32 v[216:217], v20 offset0:0 offset1:16
    ds_read2_b32 v[218:219], v20 offset0:32 offset1:48
    ds_read_b128 v[188:191], v18 offset:0
    ds_read_b128 v[192:195], v18 offset:1024
    ds_read_b128 v[196:199], v18 offset:2048
    ds_read_b128 v[200:203], v18 offset:3072
    ds_read_b128 v[204:207], v18 offset:4096
    ds_read_b128 v[208:211], v18 offset:5120
    ds_read_b128 v[212:215], v18 offset:6144
    s_waitcnt vmcnt(14)
    v_cmp_gt_u32 vcc, 32, v3
    s_cbranch_vccnz .slow_13
.back_14:
    s_mov_b32 s78, 4194304
    buffer_load_dwordx2 v[96:97], v15, s[44:47], s78 offen offset:0 sc1
    s_waitcnt lgkmcnt(7)
    v_pk_add_f32 v[216:217], v[216:217], v[218:219]
    v_pk_mul_f32 v[216:217], v[216:217], s[72:73]
    s_waitcnt lgkmcnt(6)
    v_pk_add_f32 v[188:189], v[188:189], v[224:225]
    v_pk_add_f32 v[190:191], v[190:191], v[226:227]
    buffer_load_dwordx2 v[100:101], v15, s[44:47], s78 offen offset:256 sc1
    v_fma_f32 v217, -v216, v216, v217
    s_waitcnt lgkmcnt(5)
    v_pk_add_f32 v[192:193], v[192:193], v[228:229]
    v_pk_add_f32 v[194:195], v[194:195], v[230:231]
    v_cvt_pk_bf16_f32 v217, 0, v217
    s_waitcnt lgkmcnt(4)
    v_pk_add_f32 v[196:197], v[196:197], v[232:233]
    buffer_load_dwordx2 v[98:99], v15, s[44:47], s78 offen offset:2048 sc1
    v_pk_add_f32 v[198:199], v[198:199], v[234:235]
    v_cvt_pk_bf16_f32 v216, 0, v216
    s_waitcnt lgkmcnt(3)
    v_pk_add_f32 v[200:201], v[200:201], v[236:237]
    v_pk_add_f32 v[202:203], v[202:203], v[238:239]
    v_add_f32 v217, s74, v217
    s_waitcnt lgkmcnt(2)
    buffer_load_dwordx2 v[102:103], v15, s[44:47], s78 offen offset:2304 sc1
    v_pk_add_f32 v[204:205], v[204:205], v[240:241]
    v_pk_add_f32 v[206:207], v[206:207], v[242:243]
    v_cvt_pk_bf16_f32 v217, 0, v217
    s_waitcnt lgkmcnt(1)
    v_pk_add_f32 v[208:209], v[208:209], v[244:245]
    v_pk_add_f32 v[210:211], v[210:211], v[246:247]
    v_sqrt_f32 v217, abs(v217)
    s_mov_b32 s78, 4198400
    buffer_load_dwordx2 v[104:105], v15, s[44:47], s78 offen offset:0 sc1
    s_waitcnt lgkmcnt(0)
    v_pk_add_f32 v[212:213], v[212:213], v[248:249]
    v_pk_add_f32 v[214:215], v[214:215], v[250:251]
    v_cvt_pk_bf16_f32 v217, 0, v217
    v_rcp_f32 v218, v217
    s_nop 0
    v_mul_f32 v218, s75, v218
    v_pk_fma_f32 v[188:189], v[160:161], v[216:217], v[188:189] op_sel_hi:[1,0,1] neg_lo:[0,1,0] neg_hi:[0,1,0]
    buffer_load_dwordx2 v[108:109], v15, s[44:47], s78 offen offset:256 sc1
    v_pk_fma_f32 v[190:191], v[162:163], v[216:217], v[190:191] op_sel_hi:[1,0,1] neg_lo:[0,1,0] neg_hi:[0,1,0]
    v_pk_fma_f32 v[192:193], v[164:165], v[216:217], v[192:193] op_sel_hi:[1,0,1] neg_lo:[0,1,0] neg_hi:[0,1,0]
    v_pk_fma_f32 v[194:195], v[166:167], v[216:217], v[194:195] op_sel_hi:[1,0,1] neg_lo:[0,1,0] neg_hi:[0,1,0]
    v_pk_fma_f32 v[196:197], v[168:169], v[216:217], v[196:197] op_sel_hi:[1,0,1] neg_lo:[0,1,0] neg_hi:[0,1,0]
    v_pk_fma_f32 v[198:199], v[170:171], v[216:217], v[198:199] op_sel_hi:[1,0,1] neg_lo:[0,1,0] neg_hi:[0,1,0]
    v_pk_fma_f32 v[200:201], v[172:173], v[216:217], v[200:201] op_sel_hi:[1,0,1] neg_lo:[0,1,0] neg_hi:[0,1,0]
    v_pk_fma_f32 v[202:203], v[174:175], v[216:217], v[202:203] op_sel_hi:[1,0,1] neg_lo:[0,1,0] neg_hi:[0,1,0]
    buffer_load_dwordx2 v[106:107], v15, s[44:47], s78 offen offset:2048 sc1
    v_pk_mul_f32 v[160:161], v[188:189], v[218:219] op_sel_hi:[1,0]
    v_pk_mul_f32 v[162:163], v[190:191], v[218:219] op_sel_hi:[1,0]
    v_pk_mul_f32 v[164:165], v[192:193], v[218:219] op_sel_hi:[1,0]
    v_pk_mul_f32 v[166:167], v[194:195], v[218:219] op_sel_hi:[1,0]
    v_pk_mul_f32 v[168:169], v[196:197], v[218:219] op_sel_hi:[1,0]
    v_pk_mul_f32 v[170:171], v[198:199], v[218:219] op_sel_hi:[1,0]
    v_pk_mul_f32 v[172:173], v[200:201], v[218:219] op_sel_hi:[1,0]
    buffer_load_dwordx2 v[110:111], v15, s[44:47], s78 offen offset:2304 sc1
    v_pk_mul_f32 v[174:175], v[202:203], v[218:219] op_sel_hi:[1,0]
    v_exp_f32 v160, v160
    v_exp_f32 v161, v161
    v_exp_f32 v162, v162
    v_exp_f32 v163, v163
    v_exp_f32 v164, v164
    v_exp_f32 v165, v165
    s_mov_b32 s78, 4202496
    buffer_load_dwordx2 v[112:113], v15, s[44:47], s78 offen offset:0 sc1
    v_exp_f32 v166, v166
    v_exp_f32 v167, v167
    v_exp_f32 v168, v168
    v_exp_f32 v169, v169
    v_exp_f32 v170, v170
    v_exp_f32 v171, v171
    buffer_load_dwordx2 v[116:117], v15, s[44:47], s78 offen offset:256 sc1
    v_exp_f32 v172, v172
    v_exp_f32 v173, v173
    v_exp_f32 v174, v174
    v_exp_f32 v175, v175
    v_pk_fma_f32 v[160:161], v[160:161], v[216:217], v[216:217] op_sel:[0,1,1] op_sel_hi:[1,1,1]
    v_pk_fma_f32 v[162:163], v[162:163], v[216:217], v[216:217] op_sel:[0,1,1] op_sel_hi:[1,1,1]
    v_pk_fma_f32 v[164:165], v[164:165], v[216:217], v[216:217] op_sel:[0,1,1] op_sel_hi:[1,1,1]
    buffer_load_dwordx2 v[114:115], v15, s[44:47], s78 offen offset:2048 sc1
    v_pk_fma_f32 v[166:167], v[166:167], v[216:217], v[216:217] op_sel:[0,1,1] op_sel_hi:[1,1,1]
    v_pk_fma_f32 v[168:169], v[168:169], v[216:217], v[216:217] op_sel:[0,1,1] op_sel_hi:[1,1,1]
    v_pk_fma_f32 v[170:171], v[170:171], v[216:217], v[216:217] op_sel:[0,1,1] op_sel_hi:[1,1,1]
    v_pk_fma_f32 v[172:173], v[172:173], v[216:217], v[216:217] op_sel:[0,1,1] op_sel_hi:[1,1,1]
    v_pk_fma_f32 v[174:175], v[174:175], v[216:217], v[216:217] op_sel:[0,1,1] op_sel_hi:[1,1,1]
    v_rcp_f32 v160, v160
    v_rcp_f32 v161, v161
    buffer_load_dwordx2 v[118:119], v15, s[44:47], s78 offen offset:2304 sc1
    v_rcp_f32 v162, v162
    v_rcp_f32 v163, v163
    v_rcp_f32 v164, v164
    v_rcp_f32 v165, v165
    v_rcp_f32 v166, v166
    v_rcp_f32 v167, v167
    v_rcp_f32 v168, v168
    s_mov_b32 s78, 4206592
    buffer_load_dwordx2 v[120:121], v15, s[44:47], s78 offen offset:0 sc1
    v_rcp_f32 v169, v169
    v_rcp_f32 v170, v170
    v_rcp_f32 v171, v171
    v_rcp_f32 v172, v172
    v_rcp_f32 v173, v173
    v_rcp_f32 v174, v174
    v_rcp_f32 v175, v175
    buffer_load_dwordx2 v[124:125], v15, s[44:47], s78 offen offset:256 sc1
    v_pk_mul_f32 v[160:161], v[160:161], v[188:189]
    v_pk_mul_f32 v[162:163], v[162:163], v[190:191]
    v_pk_mul_f32 v[164:165], v[164:165], v[192:193]
    v_pk_mul_f32 v[166:167], v[166:167], v[194:195]
    v_pk_mul_f32 v[168:169], v[168:169], v[196:197]
    v_pk_mul_f32 v[170:171], v[170:171], v[198:199]
    v_pk_mul_f32 v[172:173], v[172:173], v[200:201]
    buffer_load_dwordx2 v[122:123], v15, s[44:47], s78 offen offset:2048 sc1
    v_pk_mul_f32 v[174:175], v[174:175], v[202:203]
    v_cvt_pk_bf16_f32 v224, v160, v161
    v_cvt_pk_bf16_f32 v225, v162, v163
    v_cvt_pk_bf16_f32 v226, v164, v165
    v_cvt_pk_bf16_f32 v227, v166, v167
    v_cvt_pk_bf16_f32 v232, v168, v169
    v_cvt_pk_bf16_f32 v233, v170, v171
    buffer_load_dwordx2 v[126:127], v15, s[44:47], s78 offen offset:2304 sc1
    v_cvt_pk_bf16_f32 v234, v172, v173
    v_cvt_pk_bf16_f32 v235, v174, v175
    v_permlane16_swap_b32 v224, v226
    v_permlane16_swap_b32 v225, v227
    v_permlane16_swap_b32 v232, v234
    v_permlane16_swap_b32 v233, v235
    s_mov_b32 s80, 9437184
    s_mov_b32 s5, 9441280
    buffer_store_dwordx4 v[224:227], v22, s[44:47], s80 offen offset:0 sc1
    buffer_store_dwordx4 v[232:235], v22, s[44:47], s80 offen offset:2048 sc1
    v_pk_fma_f32 v[204:205], v[176:177], v[216:217], v[204:205] op_sel_hi:[1,0,1] neg_lo:[0,1,0] neg_hi:[0,1,0]
    v_pk_fma_f32 v[206:207], v[178:179], v[216:217], v[206:207] op_sel_hi:[1,0,1] neg_lo:[0,1,0] neg_hi:[0,1,0]
    v_pk_fma_f32 v[208:209], v[180:181], v[216:217], v[208:209] op_sel_hi:[1,0,1] neg_lo:[0,1,0] neg_hi:[0,1,0]
    v_pk_fma_f32 v[210:211], v[182:183], v[216:217], v[210:211] op_sel_hi:[1,0,1] neg_lo:[0,1,0] neg_hi:[0,1,0]
    v_pk_mul_f32 v[176:177], v[204:205], v[218:219] op_sel_hi:[1,0]
    v_pk_mul_f32 v[178:179], v[206:207], v[218:219] op_sel_hi:[1,0]
    v_pk_mul_f32 v[180:181], v[208:209], v[218:219] op_sel_hi:[1,0]
    v_pk_mul_f32 v[182:183], v[210:211], v[218:219] op_sel_hi:[1,0]
    v_exp_f32 v176, v176
    v_exp_f32 v177, v177
    v_exp_f32 v178, v178
    v_exp_f32 v179, v179
    v_exp_f32 v180, v180
    v_exp_f32 v181, v181
    v_exp_f32 v182, v182
    v_exp_f32 v183, v183
    v_pk_fma_f32 v[176:177], v[176:177], v[216:217], v[216:217] op_sel:[0,1,1] op_sel_hi:[1,1,1]
    v_pk_fma_f32 v[178:179], v[178:179], v[216:217], v[216:217] op_sel:[0,1,1] op_sel_hi:[1,1,1]
    v_pk_fma_f32 v[180:181], v[180:181], v[216:217], v[216:217] op_sel:[0,1,1] op_sel_hi:[1,1,1]
    v_pk_fma_f32 v[182:183], v[182:183], v[216:217], v[216:217] op_sel:[0,1,1] op_sel_hi:[1,1,1]
    v_rcp_f32 v176, v176
    v_rcp_f32 v177, v177
    v_rcp_f32 v178, v178
    v_rcp_f32 v179, v179
    v_rcp_f32 v180, v180
    v_rcp_f32 v181, v181
    v_rcp_f32 v182, v182
    v_rcp_f32 v183, v183
    v_pk_mul_f32 v[176:177], v[176:177], v[204:205]
    v_pk_mul_f32 v[178:179], v[178:179], v[206:207]
    v_pk_mul_f32 v[180:181], v[180:181], v[208:209]
    v_pk_mul_f32 v[182:183], v[182:183], v[210:211]
    v_cvt_pk_bf16_f32 v240, v176, v177
    v_cvt_pk_bf16_f32 v241, v178, v179
    v_cvt_pk_bf16_f32 v242, v180, v181
    v_cvt_pk_bf16_f32 v243, v182, v183
    s_nop 0
    v_permlane16_swap_b32 v240, v242
    v_permlane16_swap_b32 v241, v243
    buffer_store_dwordx4 v[240:243], v22, s[44:47], s5 offen offset:0 sc1
    v_pk_fma_f32 v[212:213], v[184:185], v[216:217], v[212:213] op_sel_hi:[1,0,1] neg_lo:[0,1,0] neg_hi:[0,1,0]
    v_pk_fma_f32 v[214:215], v[186:187], v[216:217], v[214:215] op_sel_hi:[1,0,1] neg_lo:[0,1,0] neg_hi:[0,1,0]
    v_pk_mul_f32 v[184:185], v[212:213], v[218:219] op_sel_hi:[1,0]
    v_pk_mul_f32 v[186:187], v[214:215], v[218:219] op_sel_hi:[1,0]
    v_exp_f32 v184, v184
    v_exp_f32 v185, v185
    v_exp_f32 v186, v186
    v_exp_f32 v187, v187
    v_pk_fma_f32 v[184:185], v[184:185], v[216:217], v[216:217] op_sel:[0,1,1] op_sel_hi:[1,1,1]
    v_pk_fma_f32 v[186:187], v[186:187], v[216:217], v[216:217] op_sel:[0,1,1] op_sel_hi:[1,1,1]
    v_rcp_f32 v184, v184
    v_rcp_f32 v185, v185
    v_rcp_f32 v186, v186
    v_rcp_f32 v187, v187
    v_pk_mul_f32 v[184:185], v[184:185], v[212:213]
    v_pk_mul_f32 v[186:187], v[186:187], v[214:215]
    v_cvt_pk_bf16_f32 v248, v184, v185
    v_cvt_pk_bf16_f32 v249, v186, v187
    v_xor_b32 v252, 32, v16
    v_and_b32 v253, 32, v16
    v_mul_u32_u24 v253, 6, v253
    v_sub_u32 v253, v16, v253
    v_add_u32 v253, 384, v253
    ds_read_b64_tr_b16 v[160:161], v16 offset:0
    ds_read_b64_tr_b16 v[162:163], v16 offset:3584
    ds_read_b64_tr_b16 v[164:165], v252 offset:0
    ds_read_b64_tr_b16 v[166:167], v252 offset:3584
    ds_read_b64_tr_b16 v[168:169], v16 offset:64
    ds_read_b64_tr_b16 v[170:171], v16 offset:3648
    ds_read_b64_tr_b16 v[172:173], v252 offset:64
    ds_read_b64_tr_b16 v[174:175], v252 offset:3648
    ds_read_b64_tr_b16 v[176:177], v16 offset:128
    ds_read_b64_tr_b16 v[178:179], v16 offset:3712
    ds_read_b64_tr_b16 v[180:181], v252 offset:128
    ds_read_b64_tr_b16 v[182:183], v252 offset:3712
    ds_read_b64_tr_b16 v[184:185], v253 offset:0
    ds_read_b64_tr_b16 v[186:187], v253 offset:3584
    buffer_store_dwordx2 v[248:249], v23, s[44:47], s5 offen offset:2048 sc1
    s_waitcnt vmcnt(16)
    v_swap_b32 v97, v100
    v_swap_b32 v99, v102
    s_waitcnt lgkmcnt(6)
    s_nop 0
    v_mfma_f32_16x16x32_bf16 a[224:227], v[160:163], v[100:103], 0
    ds_read_b64_tr_b16 v[188:189], v16 offset:7168
    v_mfma_f32_16x16x32_bf16 v[224:227], v[160:163], v[96:99], 0
    ds_read_b64_tr_b16 v[190:191], v16 offset:10752
    v_mfma_f32_16x16x32_bf16 a[228:231], v[164:167], v[100:103], 0
    ds_read_b64_tr_b16 v[192:193], v252 offset:7168
    v_mfma_f32_16x16x32_bf16 v[228:231], v[164:167], v[96:99], 0
    ds_read_b64_tr_b16 v[194:195], v252 offset:10752
    v_mfma_f32_16x16x32_bf16 a[232:235], v[168:171], v[100:103], 0
    ds_read_b64_tr_b16 v[196:197], v16 offset:7232
    v_mfma_f32_16x16x32_bf16 v[232:235], v[168:171], v[96:99], 0
    ds_read_b64_tr_b16 v[198:199], v16 offset:10816
    v_mfma_f32_16x16x32_bf16 a[236:239], v[172:175], v[100:103], 0
    ds_read_b64_tr_b16 v[200:201], v252 offset:7232
    v_mfma_f32_16x16x32_bf16 v[236:239], v[172:175], v[96:99], 0
    ds_read_b64_tr_b16 v[202:203], v252 offset:10816
    s_waitcnt lgkmcnt(8)
    v_mfma_f32_16x16x32_bf16 a[240:243], v[176:179], v[100:103], 0
    ds_read_b64_tr_b16 v[204:205], v16 offset:7296
    s_mov_b32 s78, 4210688
    buffer_load_dwordx2 v[128:129], v15, s[44:47], s78 offen offset:0 sc1
    v_mfma_f32_16x16x32_bf16 v[240:243], v[176:179], v[96:99], 0
    ds_read_b64_tr_b16 v[206:207], v16 offset:10880
    v_mfma_f32_16x16x32_bf16 a[244:247], v[180:183], v[100:103], 0
    ds_read_b64_tr_b16 v[208:209], v252 offset:7296
    v_mfma_f32_16x16x32_bf16 v[244:247], v[180:183], v[96:99], 0
    ds_read_b64_tr_b16 v[210:211], v252 offset:10880
    s_waitcnt vmcnt(13)
    v_swap_b32 v105, v108
    v_swap_b32 v107, v110
    v_mfma_f32_16x16x32_bf16 a[248:251], v[184:187], v[100:103], 0
    ds_read_b64_tr_b16 v[212:213], v253 offset:7168
    buffer_load_dwordx2 v[132:133], v15, s[44:47], s78 offen offset:256 sc1
    v_mfma_f32_16x16x32_bf16 v[248:251], v[184:187], v[96:99], 0
    ds_read_b64_tr_b16 v[214:215], v253 offset:10752
    s_waitcnt lgkmcnt(6)
    v_mfma_f32_16x16x32_bf16 a[224:227], v[188:191], v[108:111], a[224:227]
    ds_read_b64_tr_b16 v[160:161], v16 offset:14336
    buffer_load_dwordx2 v[130:131], v15, s[44:47], s78 offen offset:2048 sc1
    v_mfma_f32_16x16x32_bf16 v[224:227], v[188:191], v[104:107], v[224:227]
    ds_read_b64_tr_b16 v[162:163], v16 offset:17920
    v_mfma_f32_16x16x32_bf16 a[228:231], v[192:195], v[108:111], a[228:231]
    ds_read_b64_tr_b16 v[164:165], v252 offset:14336
    v_mfma_f32_16x16x32_bf16 v[228:231], v[192:195], v[104:107], v[228:231]
    ds_read_b64_tr_b16 v[166:167], v252 offset:17920
    v_mfma_f32_16x16x32_bf16 a[232:235], v[196:199], v[108:111], a[232:235]
    ds_read_b64_tr_b16 v[168:169], v16 offset:14400
    buffer_load_dwordx2 v[134:135], v15, s[44:47], s78 offen offset:2304 sc1
    v_mfma_f32_16x16x32_bf16 v[232:235], v[196:199], v[104:107], v[232:235]
    ds_read_b64_tr_b16 v[170:171], v16 offset:17984
    v_mfma_f32_16x16x32_bf16 a[236:239], v[200:203], v[108:111], a[236:239]
    ds_read_b64_tr_b16 v[172:173], v252 offset:14400
    v_mfma_f32_16x16x32_bf16 v[236:239], v[200:203], v[104:107], v[236:239]
    ds_read_b64_tr_b16 v[174:175], v252 offset:17984
    s_waitcnt lgkmcnt(8)
    v_mfma_f32_16x16x32_bf16 a[240:243], v[204:207], v[108:111], a[240:243]
    ds_read_b64_tr_b16 v[176:177], v16 offset:14464
    s_mov_b32 s78, 4214784
    buffer_load_dwordx2 v[136:137], v15, s[44:47], s78 offen offset:0 sc1
    v_mfma_f32_16x16x32_bf16 v[240:243], v[204:207], v[104:107], v[240:243]
    ds_read_b64_tr_b16 v[178:179], v16 offset:18048
    v_mfma_f32_16x16x32_bf16 a[244:247], v[208:211], v[108:111], a[244:247]
    ds_read_b64_tr_b16 v[180:181], v252 offset:14464
    v_mfma_f32_16x16x32_bf16 v[244:247], v[208:211], v[104:107], v[244:247]
    ds_read_b64_tr_b16 v[182:183], v252 offset:18048
    s_waitcnt vmcnt(13)
    v_swap_b32 v113, v116
    v_swap_b32 v115, v118
    v_mfma_f32_16x16x32_bf16 a[248:251], v[212:215], v[108:111], a[248:251]
    ds_read_b64_tr_b16 v[184:185], v253 offset:14336
    buffer_load_dwordx2 v[140:141], v15, s[44:47], s78 offen offset:256 sc1
    v_mfma_f32_16x16x32_bf16 v[248:251], v[212:215], v[104:107], v[248:251]
    ds_read_b64_tr_b16 v[186:187], v253 offset:17920
    s_waitcnt lgkmcnt(6)
    v_mfma_f32_16x16x32_bf16 a[224:227], v[160:163], v[116:119], a[224:227]
    ds_read_b64_tr_b16 v[188:189], v16 offset:21504
    buffer_load_dwordx2 v[138:139], v15, s[44:47], s78 offen offset:2048 sc1
    v_mfma_f32_16x16x32_bf16 v[224:227], v[160:163], v[112:115], v[224:227]
    ds_read_b64_tr_b16 v[190:191], v16 offset:25088
    v_mfma_f32_16x16x32_bf16 a[228:231], v[164:167], v[116:119], a[228:231]
    ds_read_b64_tr_b16 v[192:193], v252 offset:21504
    v_mfma_f32_16x16x32_bf16 v[228:231], v[164:167], v[112:115], v[228:231]
    ds_read_b64_tr_b16 v[194:195], v252 offset:25088
    v_mfma_f32_16x16x32_bf16 a[232:235], v[168:171], v[116:119], a[232:235]
    ds_read_b64_tr_b16 v[196:197], v16 offset:21568
    buffer_load_dwordx2 v[142:143], v15, s[44:47], s78 offen offset:2304 sc1
    v_mfma_f32_16x16x32_bf16 v[232:235], v[168:171], v[112:115], v[232:235]
    ds_read_b64_tr_b16 v[198:199], v16 offset:25152
    v_mfma_f32_16x16x32_bf16 a[236:239], v[172:175], v[116:119], a[236:239]
    ds_read_b64_tr_b16 v[200:201], v252 offset:21568
    v_mfma_f32_16x16x32_bf16 v[236:239], v[172:175], v[112:115], v[236:239]
    ds_read_b64_tr_b16 v[202:203], v252 offset:25152
    s_waitcnt lgkmcnt(8)
    v_mfma_f32_16x16x32_bf16 a[240:243], v[176:179], v[116:119], a[240:243]
    ds_read_b64_tr_b16 v[204:205], v16 offset:21632
    s_mov_b32 s78, 4218880
    buffer_load_dwordx2 v[144:145], v15, s[44:47], s78 offen offset:0 sc1
    v_mfma_f32_16x16x32_bf16 v[240:243], v[176:179], v[112:115], v[240:243]
    ds_read_b64_tr_b16 v[206:207], v16 offset:25216
    v_mfma_f32_16x16x32_bf16 a[244:247], v[180:183], v[116:119], a[244:247]
    ds_read_b64_tr_b16 v[208:209], v252 offset:21632
    v_mfma_f32_16x16x32_bf16 v[244:247], v[180:183], v[112:115], v[244:247]
    ds_read_b64_tr_b16 v[210:211], v252 offset:25216
    s_waitcnt vmcnt(13)
    v_swap_b32 v121, v124
    v_swap_b32 v123, v126
    v_mfma_f32_16x16x32_bf16 a[248:251], v[184:187], v[116:119], a[248:251]
    ds_read_b64_tr_b16 v[212:213], v253 offset:21504
    buffer_load_dwordx2 v[148:149], v15, s[44:47], s78 offen offset:256 sc1
    v_mfma_f32_16x16x32_bf16 v[248:251], v[184:187], v[112:115], v[248:251]
    ds_read_b64_tr_b16 v[214:215], v253 offset:25088
    s_waitcnt vmcnt(10)
    s_add_u32 s80, s82, 0
    s_mov_b64 exec, 1
    v_mov_b32 v5, 1
    buffer_atomic_add v5, off, s[44:47], s80 sc1
    s_mov_b64 exec, -1
    s_barrier
    s_waitcnt lgkmcnt(6)
    v_mfma_f32_16x16x32_bf16 a[224:227], v[188:191], v[124:127], a[224:227]
    ds_read_b64_tr_b16 v[160:161], v16 offset:28672
    buffer_load_dwordx2 v[146:147], v15, s[44:47], s78 offen offset:2048 sc1
    v_mfma_f32_16x16x32_bf16 v[224:227], v[188:191], v[120:123], v[224:227]
    ds_read_b64_tr_b16 v[162:163], v16 offset:32256
    v_mfma_f32_16x16x32_bf16 a[228:231], v[192:195], v[124:127], a[228:231]
    ds_read_b64_tr_b16 v[164:165], v252 offset:28672
    v_mfma_f32_16x16x32_bf16 v[228:231], v[192:195], v[120:123], v[228:231]
    ds_read_b64_tr_b16 v[166:167], v252 offset:32256
    v_mfma_f32_16x16x32_bf16 a[232:235], v[196:199], v[124:127], a[232:235]
    ds_read_b64_tr_b16 v[168:169], v16 offset:28736
    buffer_load_dwordx2 v[150:151], v15, s[44:47], s78 offen offset:2304 sc1
    v_mfma_f32_16x16x32_bf16 v[232:235], v[196:199], v[120:123], v[232:235]
    ds_read_b64_tr_b16 v[170:171], v16 offset:32320
    v_mfma_f32_16x16x32_bf16 a[236:239], v[200:203], v[124:127], a[236:239]
    ds_read_b64_tr_b16 v[172:173], v252 offset:28736
    v_mfma_f32_16x16x32_bf16 v[236:239], v[200:203], v[120:123], v[236:239]
    ds_read_b64_tr_b16 v[174:175], v252 offset:32320
    s_waitcnt lgkmcnt(8)
    v_mfma_f32_16x16x32_bf16 a[240:243], v[204:207], v[124:127], a[240:243]
    ds_read_b64_tr_b16 v[176:177], v16 offset:28800
    s_mov_b32 s78, 4222976
    buffer_load_dwordx2 v[152:153], v15, s[44:47], s78 offen offset:0 sc1
    v_mfma_f32_16x16x32_bf16 v[240:243], v[204:207], v[120:123], v[240:243]
    ds_read_b64_tr_b16 v[178:179], v16 offset:32384
    v_mfma_f32_16x16x32_bf16 a[244:247], v[208:211], v[124:127], a[244:247]
    ds_read_b64_tr_b16 v[180:181], v252 offset:28800
    v_mfma_f32_16x16x32_bf16 v[244:247], v[208:211], v[120:123], v[244:247]
    ds_read_b64_tr_b16 v[182:183], v252 offset:32384
    s_waitcnt vmcnt(10)
    v_swap_b32 v129, v132
    v_swap_b32 v131, v134
    v_mfma_f32_16x16x32_bf16 a[248:251], v[212:215], v[124:127], a[248:251]
    ds_read_b64_tr_b16 v[184:185], v253 offset:28672
    buffer_load_dwordx2 v[156:157], v15, s[44:47], s78 offen offset:256 sc1
    v_mfma_f32_16x16x32_bf16 v[248:251], v[212:215], v[120:123], v[248:251]
    ds_read_b64_tr_b16 v[186:187], v253 offset:32256
    s_waitcnt lgkmcnt(6)
    v_mfma_f32_16x16x32_bf16 a[224:227], v[160:163], v[132:135], a[224:227]
    ds_read_b64_tr_b16 v[188:189], v16 offset:35840
    buffer_load_dwordx2 v[154:155], v15, s[44:47], s78 offen offset:2048 sc1
    v_mfma_f32_16x16x32_bf16 v[224:227], v[160:163], v[128:131], v[224:227]
    ds_read_b64_tr_b16 v[190:191], v16 offset:39424
    v_mfma_f32_16x16x32_bf16 a[228:231], v[164:167], v[132:135], a[228:231]
    ds_read_b64_tr_b16 v[192:193], v252 offset:35840
    v_mfma_f32_16x16x32_bf16 v[228:231], v[164:167], v[128:131], v[228:231]
    ds_read_b64_tr_b16 v[194:195], v252 offset:39424
    v_mfma_f32_16x16x32_bf16 a[232:235], v[168:171], v[132:135], a[232:235]
    ds_read_b64_tr_b16 v[196:197], v16 offset:35904
    buffer_load_dwordx2 v[158:159], v15, s[44:47], s78 offen offset:2304 sc1
    v_mfma_f32_16x16x32_bf16 v[232:235], v[168:171], v[128:131], v[232:235]
    ds_read_b64_tr_b16 v[198:199], v16 offset:39488
    v_mfma_f32_16x16x32_bf16 a[236:239], v[172:175], v[132:135], a[236:239]
    ds_read_b64_tr_b16 v[200:201], v252 offset:35904
    v_mfma_f32_16x16x32_bf16 v[236:239], v[172:175], v[128:131], v[236:239]
    ds_read_b64_tr_b16 v[202:203], v252 offset:39488
    s_waitcnt lgkmcnt(8)
    v_mfma_f32_16x16x32_bf16 a[240:243], v[176:179], v[132:135], a[240:243]
    ds_read_b64_tr_b16 v[204:205], v16 offset:35968
    buffer_load_dwordx4 a[104:107], v6, s[44:47], s79 offen offset:2048 sc1
    v_mfma_f32_16x16x32_bf16 v[240:243], v[176:179], v[128:131], v[240:243]
    ds_read_b64_tr_b16 v[206:207], v16 offset:39552
    v_mfma_f32_16x16x32_bf16 a[244:247], v[180:183], v[132:135], a[244:247]
    ds_read_b64_tr_b16 v[208:209], v252 offset:35968
    v_mfma_f32_16x16x32_bf16 v[244:247], v[180:183], v[128:131], v[244:247]
    ds_read_b64_tr_b16 v[210:211], v252 offset:39552
    s_waitcnt vmcnt(10)
    v_swap_b32 v137, v140
    v_swap_b32 v139, v142
    v_mfma_f32_16x16x32_bf16 a[248:251], v[184:187], v[132:135], a[248:251]
    ds_read_b64_tr_b16 v[212:213], v253 offset:35840
    buffer_load_dwordx4 a[108:111], v6, s[44:47], s79 offen offset:3072 sc1
    v_mfma_f32_16x16x32_bf16 v[248:251], v[184:187], v[128:131], v[248:251]
    ds_read_b64_tr_b16 v[214:215], v253 offset:39424
    s_waitcnt lgkmcnt(6)
    v_mfma_f32_16x16x32_bf16 a[224:227], v[188:191], v[140:143], a[224:227]
    ds_read_b64_tr_b16 v[160:161], v16 offset:43008
    s_add_u32 s79, s81, 28672
    buffer_load_dwordx4 a[112:115], v6, s[44:47], s79 offen offset:0 sc1
    v_mfma_f32_16x16x32_bf16 v[224:227], v[188:191], v[136:139], v[224:227]
    ds_read_b64_tr_b16 v[162:163], v16 offset:46592
    v_mfma_f32_16x16x32_bf16 a[228:231], v[192:195], v[140:143], a[228:231]
    ds_read_b64_tr_b16 v[164:165], v252 offset:43008
    v_mfma_f32_16x16x32_bf16 v[228:231], v[192:195], v[136:139], v[228:231]
    ds_read_b64_tr_b16 v[166:167], v252 offset:46592
    v_mfma_f32_16x16x32_bf16 a[232:235], v[196:199], v[140:143], a[232:235]
    ds_read_b64_tr_b16 v[168:169], v16 offset:43072
    buffer_load_dwordx4 a[116:119], v6, s[44:47], s79 offen offset:1024 sc1
    v_mfma_f32_16x16x32_bf16 v[232:235], v[196:199], v[136:139], v[232:235]
    ds_read_b64_tr_b16 v[170:171], v16 offset:46656
    v_mfma_f32_16x16x32_bf16 a[236:239], v[200:203], v[140:143], a[236:239]
    ds_read_b64_tr_b16 v[172:173], v252 offset:43072
    v_mfma_f32_16x16x32_bf16 v[236:239], v[200:203], v[136:139], v[236:239]
    ds_read_b64_tr_b16 v[174:175], v252 offset:46656
    s_waitcnt lgkmcnt(8)
    v_mfma_f32_16x16x32_bf16 a[240:243], v[204:207], v[140:143], a[240:243]
    ds_read_b64_tr_b16 v[176:177], v16 offset:43136
    buffer_load_dwordx4 a[120:123], v6, s[44:47], s79 offen offset:2048 sc1
    v_mfma_f32_16x16x32_bf16 v[240:243], v[204:207], v[136:139], v[240:243]
    ds_read_b64_tr_b16 v[178:179], v16 offset:46720
    v_mfma_f32_16x16x32_bf16 a[244:247], v[208:211], v[140:143], a[244:247]
    ds_read_b64_tr_b16 v[180:181], v252 offset:43136
    v_mfma_f32_16x16x32_bf16 v[244:247], v[208:211], v[136:139], v[244:247]
    ds_read_b64_tr_b16 v[182:183], v252 offset:46720
    s_waitcnt vmcnt(9)
    v_swap_b32 v145, v148
    v_swap_b32 v147, v150
    v_mfma_f32_16x16x32_bf16 a[248:251], v[212:215], v[140:143], a[248:251]
    ds_read_b64_tr_b16 v[184:185], v253 offset:43008
    buffer_load_dwordx4 a[124:127], v6, s[44:47], s79 offen offset:3072 sc1
    v_mfma_f32_16x16x32_bf16 v[248:251], v[212:215], v[136:139], v[248:251]
    ds_read_b64_tr_b16 v[186:187], v253 offset:46592
    s_waitcnt lgkmcnt(6)
    v_mfma_f32_16x16x32_bf16 a[224:227], v[160:163], v[148:151], a[224:227]
    ds_read_b64_tr_b16 v[188:189], v16 offset:50176
    s_add_u32 s79, s81, 32768
    buffer_load_dwordx4 a[128:131], v6, s[44:47], s79 offen offset:0 sc1
    v_mfma_f32_16x16x32_bf16 v[224:227], v[160:163], v[144:147], v[224:227]
    ds_read_b64_tr_b16 v[190:191], v16 offset:53760
    v_mfma_f32_16x16x32_bf16 a[228:231], v[164:167], v[148:151], a[228:231]
    ds_read_b64_tr_b16 v[192:193], v252 offset:50176
    v_mfma_f32_16x16x32_bf16 v[228:231], v[164:167], v[144:147], v[228:231]
    ds_read_b64_tr_b16 v[194:195], v252 offset:53760
    v_mfma_f32_16x16x32_bf16 a[232:235], v[168:171], v[148:151], a[232:235]
    ds_read_b64_tr_b16 v[196:197], v16 offset:50240
    buffer_load_dwordx4 a[132:135], v6, s[44:47], s79 offen offset:1024 sc1
    v_mfma_f32_16x16x32_bf16 v[232:235], v[168:171], v[144:147], v[232:235]
    ds_read_b64_tr_b16 v[198:199], v16 offset:53824
    v_mfma_f32_16x16x32_bf16 a[236:239], v[172:175], v[148:151], a[236:239]
    ds_read_b64_tr_b16 v[200:201], v252 offset:50240
    v_mfma_f32_16x16x32_bf16 v[236:239], v[172:175], v[144:147], v[236:239]
    ds_read_b64_tr_b16 v[202:203], v252 offset:53824
    s_waitcnt lgkmcnt(8)
    v_mfma_f32_16x16x32_bf16 a[240:243], v[176:179], v[148:151], a[240:243]
    ds_read_b64_tr_b16 v[204:205], v16 offset:50304
    buffer_load_dwordx4 a[136:139], v6, s[44:47], s79 offen offset:2048 sc1
    v_mfma_f32_16x16x32_bf16 v[240:243], v[176:179], v[144:147], v[240:243]
    ds_read_b64_tr_b16 v[206:207], v16 offset:53888
    v_mfma_f32_16x16x32_bf16 a[244:247], v[180:183], v[148:151], a[244:247]
    ds_read_b64_tr_b16 v[208:209], v252 offset:50304
    v_mfma_f32_16x16x32_bf16 v[244:247], v[180:183], v[144:147], v[244:247]
    ds_read_b64_tr_b16 v[210:211], v252 offset:53888
    s_waitcnt vmcnt(9)
    v_swap_b32 v153, v156
    v_swap_b32 v155, v158
    v_mfma_f32_16x16x32_bf16 a[248:251], v[184:187], v[148:151], a[248:251]
    ds_read_b64_tr_b16 v[212:213], v253 offset:50176
    buffer_load_dwordx4 a[140:143], v6, s[44:47], s79 offen offset:3072 sc1
    v_mfma_f32_16x16x32_bf16 v[248:251], v[184:187], v[144:147], v[248:251]
    ds_read_b64_tr_b16 v[214:215], v253 offset:53760
    s_waitcnt lgkmcnt(6)
    v_mfma_f32_16x16x32_bf16 a[224:227], v[188:191], v[156:159], a[224:227]
    ds_read_b128 v[160:163], v21 offset:0
    v_mov_b32 v220, 0x3e803e80
    s_add_u32 s79, s81, 36864
    buffer_load_dwordx4 a[144:147], v6, s[44:47], s79 offen offset:0 sc1
    v_mfma_f32_16x16x32_bf16 a[228:231], v[192:195], v[156:159], a[228:231]
    ds_read_b128 v[164:167], v21 offset:64
    v_mov_b32 v221, 0x3e803e80
    v_mfma_f32_16x16x32_bf16 a[232:235], v[196:199], v[156:159], a[232:235]
    ds_read_b128 v[168:171], v21 offset:128
    v_mov_b32 v222, 0x3e803e80
    buffer_load_dwordx4 a[148:151], v6, s[44:47], s79 offen offset:1024 sc1
    v_mfma_f32_16x16x32_bf16 a[236:239], v[200:203], v[156:159], a[236:239]
    ds_read_b128 v[172:175], v21 offset:192
    v_mov_b32 v223, 0x3e803e80
    s_waitcnt lgkmcnt(4)
    v_mfma_f32_16x16x32_bf16 a[240:243], v[204:207], v[156:159], a[240:243]
    ds_read_b128 v[176:179], v21 offset:256
    buffer_load_dwordx4 a[152:155], v6, s[44:47], s79 offen offset:2048 sc1
    v_mfma_f32_16x16x32_bf16 a[244:247], v[208:211], v[156:159], a[244:247]
    ds_read_b128 v[180:183], v21 offset:320
    v_mfma_f32_16x16x32_bf16 a[248:251], v[212:215], v[156:159], a[248:251]
    ds_read_b128 v[184:187], v21 offset:384
    buffer_load_dwordx4 a[156:159], v6, s[44:47], s79 offen offset:3072 sc1
    v_mfma_f32_16x16x32_bf16 v[224:227], v[188:191], v[152:155], v[224:227]
    ds_write_b128 v17, a[224:227] offset:0
    v_mfma_f32_16x16x32_bf16 v[228:231], v[192:195], v[152:155], v[228:231]
    v_mfma_f32_16x16x32_bf16 v[232:235], v[196:199], v[152:155], v[232:235]
    ds_write_b128 v17, a[228:231] offset:1024
    v_mfma_f32_16x16x32_bf16 v[236:239], v[200:203], v[152:155], v[236:239]
    v_mfma_f32_16x16x32_bf16 v[240:243], v[204:207], v[152:155], v[240:243]
    v_mfma_f32_16x16x32_bf16 v[244:247], v[208:211], v[152:155], v[244:247]
    v_mfma_f32_16x16x32_bf16 v[248:251], v[212:215], v[152:155], v[248:251]
    s_add_u32 s80, s91, 0
    v_mov_b32 v5, 0
    buffer_load_dword v3, v5, s[44:47], s80 offen sc1
    v_mfma_f32_16x16x32_bf16 v[188:191], v[220:223], v[96:99], 0
    ds_write_b128 v17, a[232:235] offset:2048
    s_add_u32 s79, s81, 40960
    buffer_load_dwordx4 a[160:163], v6, s[44:47], s79 offen offset:0 sc1
    v_mfma_f32_16x16x32_bf16 v[192:195], v[220:223], v[100:103], 0
    v_mfma_f32_16x16x32_bf16 v[188:191], v[220:223], v[104:107], v[188:191]
    v_mfma_f32_16x16x32_bf16 v[192:195], v[220:223], v[108:111], v[192:195]
    ds_write_b128 v17, a[236:239] offset:3072
    v_mfma_f32_16x16x32_bf16 v[188:191], v[220:223], v[112:115], v[188:191]
    buffer_load_dwordx4 a[164:167], v6, s[44:47], s79 offen offset:1024 sc1
    v_mfma_f32_16x16x32_bf16 v[192:195], v[220:223], v[116:119], v[192:195]
    v_mfma_f32_16x16x32_bf16 v[188:191], v[220:223], v[120:123], v[188:191]
    ds_write_b128 v17, a[240:243] offset:4096
    v_mfma_f32_16x16x32_bf16 v[192:195], v[220:223], v[124:127], v[192:195]
    v_mfma_f32_16x16x32_bf16 v[188:191], v[220:223], v[128:131], v[188:191]
    buffer_load_dwordx4 a[168:171], v6, s[44:47], s79 offen offset:2048 sc1
    v_mfma_f32_16x16x32_bf16 v[192:195], v[220:223], v[132:135], v[192:195]
    ds_write_b128 v17, a[244:247] offset:5120
    v_mfma_f32_16x16x32_bf16 v[188:191], v[220:223], v[136:139], v[188:191]
    v_mfma_f32_16x16x32_bf16 v[192:195], v[220:223], v[140:143], v[192:195]
    v_mfma_f32_16x16x32_bf16 v[188:191], v[220:223], v[144:147], v[188:191]
    buffer_load_dwordx4 a[172:175], v6, s[44:47], s79 offen offset:3072 sc1
    ds_write_b128 v17, a[248:251] offset:6144
    v_mfma_f32_16x16x32_bf16 v[192:195], v[220:223], v[148:151], v[192:195]
    v_mfma_f32_16x16x32_bf16 v[188:191], v[220:223], v[152:155], v[188:191]
    v_mfma_f32_16x16x32_bf16 v[192:195], v[220:223], v[156:159], v[192:195]
    s_add_u32 s79, s81, 45056
    buffer_load_dwordx4 a[176:179], v6, s[44:47], s79 offen offset:0 sc1
    v_dot2_f32_bf16 v217, v96, v96, 0
    v_dot2_f32_bf16 v219, v100, v100, 0
    v_dot2_f32_bf16 v221, v97, v97, 0
    v_dot2_f32_bf16 v223, v101, v101, 0
    v_dot2c_f32_bf16 v217, v98, v98
    v_dot2c_f32_bf16 v219, v102, v102
    buffer_load_dwordx4 a[180:183], v6, s[44:47], s79 offen offset:1024 sc1
    v_dot2c_f32_bf16 v221, v99, v99
    v_dot2c_f32_bf16 v223, v103, v103
    v_dot2c_f32_bf16 v217, v104, v104
    v_dot2c_f32_bf16 v219, v108, v108
    v_dot2c_f32_bf16 v221, v105, v105
    v_dot2c_f32_bf16 v223, v109, v109
    v_dot2c_f32_bf16 v217, v106, v106
    buffer_load_dwordx4 a[184:187], v6, s[44:47], s79 offen offset:2048 sc1
    v_dot2c_f32_bf16 v219, v110, v110
    v_dot2c_f32_bf16 v221, v107, v107
    v_dot2c_f32_bf16 v223, v111, v111
    v_dot2c_f32_bf16 v217, v112, v112
    v_dot2c_f32_bf16 v219, v116, v116
    v_dot2c_f32_bf16 v221, v113, v113
    buffer_load_dwordx4 a[188:191], v6, s[44:47], s79 offen offset:3072 sc1
    v_dot2c_f32_bf16 v223, v117, v117
    v_dot2c_f32_bf16 v217, v114, v114
    v_dot2c_f32_bf16 v219, v118, v118
    v_dot2c_f32_bf16 v221, v115, v115
    v_dot2c_f32_bf16 v223, v119, v119
    v_dot2c_f32_bf16 v217, v120, v120
    v_dot2c_f32_bf16 v219, v124, v124
    s_add_u32 s79, s81, 49152
    buffer_load_dwordx4 a[192:195], v6, s[44:47], s79 offen offset:0 sc1
    v_dot2c_f32_bf16 v221, v121, v121
    v_dot2c_f32_bf16 v223, v125, v125
    v_dot2c_f32_bf16 v217, v122, v122
    v_dot2c_f32_bf16 v219, v126, v126
    v_dot2c_f32_bf16 v221, v123, v123
    v_dot2c_f32_bf16 v223, v127, v127
    buffer_load_dwordx4 a[196:199], v6, s[44:47], s79 offen offset:1024 sc1
    v_dot2c_f32_bf16 v217, v128, v128
    v_dot2c_f32_bf16 v219, v132, v132
    v_dot2c_f32_bf16 v221, v129, v129
    v_dot2c_f32_bf16 v223, v133, v133
    v_dot2c_f32_bf16 v217, v130, v130
    v_dot2c_f32_bf16 v219, v134, v134
    v_dot2c_f32_bf16 v221, v131, v131
    buffer_load_dwordx4 a[200:203], v6, s[44:47], s79 offen offset:2048 sc1
    v_dot2c_f32_bf16 v223, v135, v135
    v_dot2c_f32_bf16 v217, v136, v136
    v_dot2c_f32_bf16 v219, v140, v140
    v_dot2c_f32_bf16 v221, v137, v137
    v_dot2c_f32_bf16 v223, v141, v141
    v_dot2c_f32_bf16 v217, v138, v138
    buffer_load_dwordx4 a[204:207], v6, s[44:47], s79 offen offset:3072 sc1
    v_dot2c_f32_bf16 v219, v142, v142
    v_dot2c_f32_bf16 v221, v139, v139
    v_dot2c_f32_bf16 v223, v143, v143
    v_dot2c_f32_bf16 v217, v144, v144
    v_dot2c_f32_bf16 v219, v148, v148
    v_dot2c_f32_bf16 v221, v145, v145
    v_dot2c_f32_bf16 v223, v149, v149
    s_add_u32 s79, s81, 53248
    buffer_load_dwordx4 a[208:211], v6, s[44:47], s79 offen offset:0 sc1
    v_dot2c_f32_bf16 v217, v146, v146
    v_dot2c_f32_bf16 v219, v150, v150
    v_dot2c_f32_bf16 v221, v147, v147
    v_dot2c_f32_bf16 v223, v151, v151
    v_dot2c_f32_bf16 v217, v152, v152
    v_dot2c_f32_bf16 v219, v156, v156
    buffer_load_dwordx4 a[212:215], v6, s[44:47], s79 offen offset:1024 sc1
    v_dot2c_f32_bf16 v221, v153, v153
    v_dot2c_f32_bf16 v223, v157, v157
    v_dot2c_f32_bf16 v217, v154, v154
    v_dot2c_f32_bf16 v219, v158, v158
    v_dot2c_f32_bf16 v221, v155, v155
    v_dot2c_f32_bf16 v223, v159, v159
    v_permlane32_swap_b32 v188, v192
    s_nop 0
    v_add_f32 v217, v217, v221
    v_add_f32 v219, v219, v223
    v_add_f32 v216, v188, v192
    s_nop 0
    v_permlane32_swap_b32 v217, v219
    v_add_f32 v217, v217, v219
    s_nop 1
    v_permlane16_swap_b32 v216, v217
    v_add_f32 v216, v216, v217
    ds_write_b32 v19, v216
    s_waitcnt lgkmcnt(0)
    s_barrier
    ds_read2_b32 v[216:217], v20 offset0:0 offset1:16
    ds_read2_b32 v[218:219], v20 offset0:32 offset1:48
    ds_read_b128 v[188:191], v18 offset:0
    ds_read_b128 v[192:195], v18 offset:1024
    ds_read_b128 v[196:199], v18 offset:2048
    ds_read_b128 v[200:203], v18 offset:3072
    ds_read_b128 v[204:207], v18 offset:4096
    ds_read_b128 v[208:211], v18 offset:5120
    ds_read_b128 v[212:215], v18 offset:6144
    s_waitcnt vmcnt(14)
    v_cmp_gt_u32 vcc, 8, v3
    s_cbranch_vccnz .slow_16
.back_17:
    s_mov_b32 s80, 3145728
    buffer_load_dwordx2 v[144:145], v26, s[44:47], s80 offen offset:0 sc1
    buffer_load_dwordx2 v[146:147], v26, s[44:47], s80 offen offset:256 sc1
    s_waitcnt lgkmcnt(7)
    v_pk_add_f32 v[216:217], v[216:217], v[218:219]
    v_pk_mul_f32 v[216:217], v[216:217], s[72:73]
    s_waitcnt lgkmcnt(6)
    v_pk_add_f32 v[188:189], v[188:189], v[224:225]
    v_pk_add_f32 v[190:191], v[190:191], v[226:227]
    v_fma_f32 v217, -v216, v216, v217
    s_mov_b32 s78, 9437184
    buffer_load_dwordx4 v[32:35], v24, s[44:47], s78 offen offset:0 sc1
    s_waitcnt lgkmcnt(5)
    v_pk_add_f32 v[192:193], v[192:193], v[228:229]
    v_pk_add_f32 v[194:195], v[194:195], v[230:231]
    v_cvt_pk_bf16_f32 v217, 0, v217
    s_waitcnt lgkmcnt(4)
    v_pk_add_f32 v[196:197], v[196:197], v[232:233]
    v_pk_add_f32 v[198:199], v[198:199], v[234:235]
    buffer_load_dwordx4 v[36:39], v24, s[44:47], s78 offen offset:256 sc1
    v_cvt_pk_bf16_f32 v216, 0, v216
    s_waitcnt lgkmcnt(3)
    v_pk_add_f32 v[200:201], v[200:201], v[236:237]
    v_pk_add_f32 v[202:203], v[202:203], v[238:239]
    v_add_f32 v217, s74, v217
    s_waitcnt lgkmcnt(2)
    v_pk_add_f32 v[204:205], v[204:205], v[240:241]
    v_pk_add_f32 v[206:207], v[206:207], v[242:243]
    buffer_load_dwordx4 v[40:43], v24, s[44:47], s78 offen offset:2048 sc1
    v_cvt_pk_bf16_f32 v217, 0, v217
    s_waitcnt lgkmcnt(1)
    v_pk_add_f32 v[208:209], v[208:209], v[244:245]
    v_pk_add_f32 v[210:211], v[210:211], v[246:247]
    v_sqrt_f32 v217, abs(v217)
    s_waitcnt lgkmcnt(0)
    v_pk_add_f32 v[212:213], v[212:213], v[248:249]
    buffer_load_dwordx4 v[44:47], v24, s[44:47], s78 offen offset:2304 sc1
    v_pk_add_f32 v[214:215], v[214:215], v[250:251]
    v_cvt_pk_bf16_f32 v217, 0, v217
    v_rcp_f32 v218, v217
    s_nop 0
    v_mul_f32 v218, s75, v218
    v_pk_fma_f32 v[188:189], v[160:161], v[216:217], v[188:189] op_sel_hi:[1,0,1] neg_lo:[0,1,0] neg_hi:[0,1,0]
    v_pk_fma_f32 v[190:191], v[162:163], v[216:217], v[190:191] op_sel_hi:[1,0,1] neg_lo:[0,1,0] neg_hi:[0,1,0]
    v_pk_fma_f32 v[192:193], v[164:165], v[216:217], v[192:193] op_sel_hi:[1,0,1] neg_lo:[0,1,0] neg_hi:[0,1,0]
    s_mov_b32 s78, 9441280
    buffer_load_dwordx4 v[48:51], v24, s[44:47], s78 offen offset:0 sc1
    v_pk_fma_f32 v[194:195], v[166:167], v[216:217], v[194:195] op_sel_hi:[1,0,1] neg_lo:[0,1,0] neg_hi:[0,1,0]
    v_pk_fma_f32 v[196:197], v[168:169], v[216:217], v[196:197] op_sel_hi:[1,0,1] neg_lo:[0,1,0] neg_hi:[0,1,0]
    v_pk_fma_f32 v[198:199], v[170:171], v[216:217], v[198:199] op_sel_hi:[1,0,1] neg_lo:[0,1,0] neg_hi:[0,1,0]
    v_pk_fma_f32 v[200:201], v[172:173], v[216:217], v[200:201] op_sel_hi:[1,0,1] neg_lo:[0,1,0] neg_hi:[0,1,0]
    v_pk_fma_f32 v[202:203], v[174:175], v[216:217], v[202:203] op_sel_hi:[1,0,1] neg_lo:[0,1,0] neg_hi:[0,1,0]
    v_pk_mul_f32 v[160:161], v[188:189], v[218:219] op_sel_hi:[1,0]
    v_pk_mul_f32 v[162:163], v[190:191], v[218:219] op_sel_hi:[1,0]
    v_pk_mul_f32 v[164:165], v[192:193], v[218:219] op_sel_hi:[1,0]
    buffer_load_dwordx4 v[52:55], v24, s[44:47], s78 offen offset:256 sc1
    v_pk_mul_f32 v[166:167], v[194:195], v[218:219] op_sel_hi:[1,0]
    v_pk_mul_f32 v[168:169], v[196:197], v[218:219] op_sel_hi:[1,0]
    v_pk_mul_f32 v[170:171], v[198:199], v[218:219] op_sel_hi:[1,0]
    v_pk_mul_f32 v[172:173], v[200:201], v[218:219] op_sel_hi:[1,0]
    v_pk_mul_f32 v[174:175], v[202:203], v[218:219] op_sel_hi:[1,0]
    v_exp_f32 v160, v160
    v_exp_f32 v161, v161
    buffer_load_dwordx4 v[56:59], v24, s[44:47], s78 offen offset:2048 sc1
    v_exp_f32 v162, v162
    v_exp_f32 v163, v163
    v_exp_f32 v164, v164
    v_exp_f32 v165, v165
    v_exp_f32 v166, v166
    v_exp_f32 v167, v167
    v_exp_f32 v168, v168
    buffer_load_dwordx4 v[60:63], v24, s[44:47], s78 offen offset:2304 sc1
    v_exp_f32 v169, v169
    v_exp_f32 v170, v170
    v_exp_f32 v171, v171
    v_exp_f32 v172, v172
    v_exp_f32 v173, v173
    v_exp_f32 v174, v174
    v_exp_f32 v175, v175
    v_pk_fma_f32 v[160:161], v[160:161], v[216:217], v[216:217] op_sel:[0,1,1] op_sel_hi:[1,1,1]
    s_mov_b32 s78, 9445376
    buffer_load_dwordx4 v[64:67], v24, s[44:47], s78 offen offset:0 sc1
    v_pk_fma_f32 v[162:163], v[162:163], v[216:217], v[216:217] op_sel:[0,1,1] op_sel_hi:[1,1,1]
    v_pk_fma_f32 v[164:165], v[164:165], v[216:217], v[216:217] op_sel:[0,1,1] op_sel_hi:[1,1,1]
    v_pk_fma_f32 v[166:167], v[166:167], v[216:217], v[216:217] op_sel:[0,1,1] op_sel_hi:[1,1,1]
    v_pk_fma_f32 v[168:169], v[168:169], v[216:217], v[216:217] op_sel:[0,1,1] op_sel_hi:[1,1,1]
    v_pk_fma_f32 v[170:171], v[170:171], v[216:217], v[216:217] op_sel:[0,1,1] op_sel_hi:[1,1,1]
    v_pk_fma_f32 v[172:173], v[172:173], v[216:217], v[216:217] op_sel:[0,1,1] op_sel_hi:[1,1,1]
    v_pk_fma_f32 v[174:175], v[174:175], v[216:217], v[216:217] op_sel:[0,1,1] op_sel_hi:[1,1,1]
    buffer_load_dwordx4 v[68:71], v24, s[44:47], s78 offen offset:256 sc1
    v_rcp_f32 v160, v160
    v_rcp_f32 v161, v161
    v_rcp_f32 v162, v162
    v_rcp_f32 v163, v163
    v_rcp_f32 v164, v164
    v_rcp_f32 v165, v165
    v_rcp_f32 v166, v166
    buffer_load_dwordx4 v[72:75], v24, s[44:47], s78 offen offset:2048 sc1
    v_rcp_f32 v167, v167
    v_rcp_f32 v168, v168
    v_rcp_f32 v169, v169
    v_rcp_f32 v170, v170
    v_rcp_f32 v171, v171
    v_rcp_f32 v172, v172
    v_rcp_f32 v173, v173
    v_rcp_f32 v174, v174
    buffer_load_dwordx4 v[76:79], v24, s[44:47], s78 offen offset:2304 sc1
    v_rcp_f32 v175, v175
    v_pk_mul_f32 v[160:161], v[160:161], v[188:189]
    v_pk_mul_f32 v[162:163], v[162:163], v[190:191]
    v_pk_mul_f32 v[164:165], v[164:165], v[192:193]
    v_pk_mul_f32 v[166:167], v[166:167], v[194:195]
    v_pk_mul_f32 v[168:169], v[168:169], v[196:197]
    v_pk_mul_f32 v[170:171], v[170:171], v[198:199]
    s_mov_b32 s78, 9449472
    buffer_load_dwordx4 v[80:83], v24, s[44:47], s78 offen offset:0 sc1
    v_pk_mul_f32 v[172:173], v[172:173], v[200:201]
    v_pk_mul_f32 v[174:175], v[174:175], v[202:203]
    v_cvt_pk_bf16_f32 v224, v160, v161
    v_cvt_pk_bf16_f32 v225, v162, v163
    v_cvt_pk_bf16_f32 v226, v164, v165
    v_cvt_pk_bf16_f32 v227, v166, v167
    v_cvt_pk_bf16_f32 v232, v168, v169
    buffer_load_dwordx4 v[84:87], v24, s[44:47], s78 offen offset:256 sc1
    v_cvt_pk_bf16_f32 v233, v170, v171
    v_cvt_pk_bf16_f32 v234, v172, v173
    v_cvt_pk_bf16_f32 v235, v174, v175
    v_permlane16_swap_b32 v224, v226
    v_permlane16_swap_b32 v225, v227
    v_permlane16_swap_b32 v232, v234
    v_permlane16_swap_b32 v233, v235
    s_mov_b32 s80, 13107200
    s_mov_b32 s5, 13111296
    buffer_store_dwordx4 v[224:227], v22, s[44:47], s80 offen offset:0 sc1
    buffer_store_dwordx4 v[232:235], v22, s[44:47], s80 offen offset:2048 sc1
    v_pk_fma_f32 v[204:205], v[176:177], v[216:217], v[204:205] op_sel_hi:[1,0,1] neg_lo:[0,1,0] neg_hi:[0,1,0]
    v_pk_fma_f32 v[206:207], v[178:179], v[216:217], v[206:207] op_sel_hi:[1,0,1] neg_lo:[0,1,0] neg_hi:[0,1,0]
    v_pk_fma_f32 v[208:209], v[180:181], v[216:217], v[208:209] op_sel_hi:[1,0,1] neg_lo:[0,1,0] neg_hi:[0,1,0]
    v_pk_fma_f32 v[210:211], v[182:183], v[216:217], v[210:211] op_sel_hi:[1,0,1] neg_lo:[0,1,0] neg_hi:[0,1,0]
    v_pk_mul_f32 v[176:177], v[204:205], v[218:219] op_sel_hi:[1,0]
    v_pk_mul_f32 v[178:179], v[206:207], v[218:219] op_sel_hi:[1,0]
    v_pk_mul_f32 v[180:181], v[208:209], v[218:219] op_sel_hi:[1,0]
    v_pk_mul_f32 v[182:183], v[210:211], v[218:219] op_sel_hi:[1,0]
    v_exp_f32 v176, v176
    v_exp_f32 v177, v177
    v_exp_f32 v178, v178
    v_exp_f32 v179, v179
    v_exp_f32 v180, v180
    v_exp_f32 v181, v181
    v_exp_f32 v182, v182
    v_exp_f32 v183, v183
    v_pk_fma_f32 v[176:177], v[176:177], v[216:217], v[216:217] op_sel:[0,1,1] op_sel_hi:[1,1,1]
    v_pk_fma_f32 v[178:179], v[178:179], v[216:217], v[216:217] op_sel:[0,1,1] op_sel_hi:[1,1,1]
    v_pk_fma_f32 v[180:181], v[180:181], v[216:217], v[216:217] op_sel:[0,1,1] op_sel_hi:[1,1,1]
    v_pk_fma_f32 v[182:183], v[182:183], v[216:217], v[216:217] op_sel:[0,1,1] op_sel_hi:[1,1,1]
    v_rcp_f32 v176, v176
    v_rcp_f32 v177, v177
    v_rcp_f32 v178, v178
    v_rcp_f32 v179, v179
    v_rcp_f32 v180, v180
    v_rcp_f32 v181, v181
    v_rcp_f32 v182, v182
    v_rcp_f32 v183, v183
    v_pk_mul_f32 v[176:177], v[176:177], v[204:205]
    v_pk_mul_f32 v[178:179], v[178:179], v[206:207]
    v_pk_mul_f32 v[180:181], v[180:181], v[208:209]
    v_pk_mul_f32 v[182:183], v[182:183], v[210:211]
    v_cvt_pk_bf16_f32 v240, v176, v177
    v_cvt_pk_bf16_f32 v241, v178, v179
    v_cvt_pk_bf16_f32 v242, v180, v181
    v_cvt_pk_bf16_f32 v243, v182, v183
    s_nop 0
    v_permlane16_swap_b32 v240, v242
    v_permlane16_swap_b32 v241, v243
    buffer_store_dwordx4 v[240:243], v22, s[44:47], s5 offen offset:0 sc1
    v_pk_fma_f32 v[212:213], v[184:185], v[216:217], v[212:213] op_sel_hi:[1,0,1] neg_lo:[0,1,0] neg_hi:[0,1,0]
    v_pk_fma_f32 v[214:215], v[186:187], v[216:217], v[214:215] op_sel_hi:[1,0,1] neg_lo:[0,1,0] neg_hi:[0,1,0]
    v_pk_mul_f32 v[184:185], v[212:213], v[218:219] op_sel_hi:[1,0]
    v_pk_mul_f32 v[186:187], v[214:215], v[218:219] op_sel_hi:[1,0]
    v_exp_f32 v184, v184
    v_exp_f32 v185, v185
    v_exp_f32 v186, v186
    v_exp_f32 v187, v187
    v_pk_fma_f32 v[184:185], v[184:185], v[216:217], v[216:217] op_sel:[0,1,1] op_sel_hi:[1,1,1]
    v_pk_fma_f32 v[186:187], v[186:187], v[216:217], v[216:217] op_sel:[0,1,1] op_sel_hi:[1,1,1]
    v_rcp_f32 v184, v184
    v_rcp_f32 v185, v185
    v_rcp_f32 v186, v186
    v_rcp_f32 v187, v187
    v_pk_mul_f32 v[184:185], v[184:185], v[212:213]
    v_pk_mul_f32 v[186:187], v[186:187], v[214:215]
    v_cvt_pk_bf16_f32 v248, v184, v185
    v_cvt_pk_bf16_f32 v249, v186, v187
    buffer_store_dwordx2 v[248:249], v23, s[44:47], s5 offen offset:2048 sc1
    s_waitcnt vmcnt(16)
    v_mfma_f32_16x16x32_bf16 v[216:219], a[12:15], v[32:35], 0
    v_mfma_f32_16x16x32_bf16 v[220:223], a[12:15], v[36:39], 0
    v_mfma_f32_16x16x32_bf16 v[208:211], a[8:11], v[32:35], 0
    v_mfma_f32_16x16x32_bf16 v[212:215], a[8:11], v[36:39], 0
    v_mfma_f32_16x16x32_bf16 v[200:203], a[4:7], v[32:35], 0
    v_mfma_f32_16x16x32_bf16 v[204:207], a[4:7], v[36:39], 0
    v_mfma_f32_16x16x32_bf16 v[192:195], a[0:3], v[32:35], 0
    v_mfma_f32_16x16x32_bf16 v[196:199], a[0:3], v[36:39], 0
    s_waitcnt vmcnt(14)
    v_mfma_f32_16x16x32_bf16 v[216:219], a[28:31], v[40:43], v[216:219]
    buffer_load_dwordx4 v[88:91], v24, s[44:47], s78 offen offset:2048 sc1
    buffer_load_dwordx4 a[216:219], v6, s[44:47], s79 offen offset:2048 sc1
    v_mfma_f32_16x16x32_bf16 v[220:223], a[28:31], v[44:47], v[220:223]
    v_mfma_f32_16x16x32_bf16 v[208:211], a[24:27], v[40:43], v[208:211]
    v_mfma_f32_16x16x32_bf16 v[212:215], a[24:27], v[44:47], v[212:215]
    v_mfma_f32_16x16x32_bf16 v[200:203], a[20:23], v[40:43], v[200:203]
    buffer_load_dwordx4 v[92:95], v24, s[44:47], s78 offen offset:2304 sc1
    buffer_load_dwordx4 a[220:223], v6, s[44:47], s79 offen offset:3072 sc1
    v_mfma_f32_16x16x32_bf16 v[204:207], a[20:23], v[44:47], v[204:207]
    v_mfma_f32_16x16x32_bf16 v[192:195], a[16:19], v[40:43], v[192:195]
    v_mfma_f32_16x16x32_bf16 v[196:199], a[16:19], v[44:47], v[196:199]
    s_waitcnt vmcnt(16)
    v_mfma_f32_16x16x32_bf16 v[216:219], a[44:47], v[48:51], v[216:219]
    s_mov_b32 s78, 9453568
    buffer_load_dwordx4 v[96:99], v24, s[44:47], s78 offen offset:0 sc1
    v_mfma_f32_16x16x32_bf16 v[220:223], a[44:47], v[52:55], v[220:223]
    v_mfma_f32_16x16x32_bf16 v[208:211], a[40:43], v[48:51], v[208:211]
    v_mfma_f32_16x16x32_bf16 v[212:215], a[40:43], v[52:55], v[212:215]
    v_mfma_f32_16x16x32_bf16 v[200:203], a[36:39], v[48:51], v[200:203]
    buffer_load_dwordx4 v[100:103], v24, s[44:47], s78 offen offset:256 sc1
    v_mfma_f32_16x16x32_bf16 v[204:207], a[36:39], v[52:55], v[204:207]
    v_mfma_f32_16x16x32_bf16 v[192:195], a[32:35], v[48:51], v[192:195]
    v_mfma_f32_16x16x32_bf16 v[196:199], a[32:35], v[52:55], v[196:199]
    s_waitcnt vmcnt(16)
    v_mfma_f32_16x16x32_bf16 v[216:219], a[60:63], v[56:59], v[216:219]
    buffer_load_dwordx4 v[104:107], v24, s[44:47], s78 offen offset:2048 sc1
    v_mfma_f32_16x16x32_bf16 v[220:223], a[60:63], v[60:63], v[220:223]
    v_mfma_f32_16x16x32_bf16 v[208:211], a[56:59], v[56:59], v[208:211]
    v_mfma_f32_16x16x32_bf16 v[212:215], a[56:59], v[60:63], v[212:215]
    v_mfma_f32_16x16x32_bf16 v[200:203], a[52:55], v[56:59], v[200:203]
    buffer_load_dwordx4 v[108:111], v24, s[44:47], s78 offen offset:2304 sc1
    v_mfma_f32_16x16x32_bf16 v[204:207], a[52:55], v[60:63], v[204:207]
    v_mfma_f32_16x16x32_bf16 v[192:195], a[48:51], v[56:59], v[192:195]
    v_mfma_f32_16x16x32_bf16 v[196:199], a[48:51], v[60:63], v[196:199]
    s_waitcnt vmcnt(8)
    s_add_u32 s80, s82, 16384
    s_mov_b64 exec, 1
    v_mov_b32 v5, 1
    buffer_atomic_add v5, off, s[44:47], s80 sc1
    s_mov_b64 exec, -1
    s_barrier
    v_mfma_f32_16x16x32_bf16 v[216:219], a[76:79], v[64:67], v[216:219]
    s_mov_b32 s78, 9457664
    buffer_load_dwordx4 v[112:115], v24, s[44:47], s78 offen offset:0 sc1
    v_mfma_f32_16x16x32_bf16 v[220:223], a[76:79], v[68:71], v[220:223]
    v_mfma_f32_16x16x32_bf16 v[208:211], a[72:75], v[64:67], v[208:211]
    v_mfma_f32_16x16x32_bf16 v[212:215], a[72:75], v[68:71], v[212:215]
    v_mfma_f32_16x16x32_bf16 v[200:203], a[68:71], v[64:67], v[200:203]
    buffer_load_dwordx4 v[116:119], v24, s[44:47], s78 offen offset:256 sc1
    v_mfma_f32_16x16x32_bf16 v[204:207], a[68:71], v[68:71], v[204:207]
    v_mfma_f32_16x16x32_bf16 v[192:195], a[64:67], v[64:67], v[192:195]
    v_mfma_f32_16x16x32_bf16 v[196:199], a[64:67], v[68:71], v[196:199]
    v_mfma_f32_16x16x32_bf16 v[216:219], a[92:95], v[72:75], v[216:219]
    buffer_load_dwordx4 v[120:123], v24, s[44:47], s78 offen offset:2048 sc1
    v_mfma_f32_16x16x32_bf16 v[220:223], a[92:95], v[76:79], v[220:223]
    v_mfma_f32_16x16x32_bf16 v[208:211], a[88:91], v[72:75], v[208:211]
    v_mfma_f32_16x16x32_bf16 v[212:215], a[88:91], v[76:79], v[212:215]
    v_mfma_f32_16x16x32_bf16 v[200:203], a[84:87], v[72:75], v[200:203]
    buffer_load_dwordx4 v[124:127], v24, s[44:47], s78 offen offset:2304 sc1
    v_mfma_f32_16x16x32_bf16 v[204:207], a[84:87], v[76:79], v[204:207]
    v_mfma_f32_16x16x32_bf16 v[192:195], a[80:83], v[72:75], v[192:195]
    v_mfma_f32_16x16x32_bf16 v[196:199], a[80:83], v[76:79], v[196:199]
    v_mfma_f32_16x16x32_bf16 v[216:219], a[108:111], v[80:83], v[216:219]
    s_mov_b32 s78, 9461760
    buffer_load_dwordx4 v[128:131], v24, s[44:47], s78 offen offset:0 sc1
    v_mfma_f32_16x16x32_bf16 v[220:223], a[108:111], v[84:87], v[220:223]
    v_mfma_f32_16x16x32_bf16 v[208:211], a[104:107], v[80:83], v[208:211]
    v_mfma_f32_16x16x32_bf16 v[212:215], a[104:107], v[84:87], v[212:215]
    v_mfma_f32_16x16x32_bf16 v[200:203], a[100:103], v[80:83], v[200:203]
    buffer_load_dwordx4 v[132:135], v24, s[44:47], s78 offen offset:256 sc1
    v_mfma_f32_16x16x32_bf16 v[204:207], a[100:103], v[84:87], v[204:207]
    v_mfma_f32_16x16x32_bf16 v[192:195], a[96:99], v[80:83], v[192:195]
    v_mfma_f32_16x16x32_bf16 v[196:199], a[96:99], v[84:87], v[196:199]
    s_waitcnt vmcnt(12)
    v_mfma_f32_16x16x32_bf16 v[216:219], a[124:127], v[88:91], v[216:219]
    buffer_load_dwordx4 v[136:139], v24, s[44:47], s78 offen offset:2048 sc1
    v_mfma_f32_16x16x32_bf16 v[220:223], a[124:127], v[92:95], v[220:223]
    v_mfma_f32_16x16x32_bf16 v[208:211], a[120:123], v[88:91], v[208:211]
    v_mfma_f32_16x16x32_bf16 v[212:215], a[120:123], v[92:95], v[212:215]
    v_mfma_f32_16x16x32_bf16 v[200:203], a[116:119], v[88:91], v[200:203]
    buffer_load_dwordx4 v[140:143], v24, s[44:47], s78 offen offset:2304 sc1
    v_mfma_f32_16x16x32_bf16 v[204:207], a[116:119], v[92:95], v[204:207]
    v_mfma_f32_16x16x32_bf16 v[192:195], a[112:115], v[88:91], v[192:195]
    v_mfma_f32_16x16x32_bf16 v[196:199], a[112:115], v[92:95], v[196:199]
    s_waitcnt vmcnt(11)
    v_mfma_f32_16x16x32_bf16 v[216:219], a[140:143], v[96:99], v[216:219]
    v_mfma_f32_16x16x32_bf16 v[220:223], a[140:143], v[100:103], v[220:223]
    v_mfma_f32_16x16x32_bf16 v[208:211], a[136:139], v[96:99], v[208:211]
    v_mfma_f32_16x16x32_bf16 v[212:215], a[136:139], v[100:103], v[212:215]
    v_mfma_f32_16x16x32_bf16 v[200:203], a[132:135], v[96:99], v[200:203]
    v_mfma_f32_16x16x32_bf16 v[204:207], a[132:135], v[100:103], v[204:207]
    v_mfma_f32_16x16x32_bf16 v[192:195], a[128:131], v[96:99], v[192:195]
    v_mfma_f32_16x16x32_bf16 v[196:199], a[128:131], v[100:103], v[196:199]
    s_waitcnt vmcnt(9)
    v_mfma_f32_16x16x32_bf16 v[216:219], a[156:159], v[104:107], v[216:219]
    v_mfma_f32_16x16x32_bf16 v[220:223], a[156:159], v[108:111], v[220:223]
    v_mfma_f32_16x16x32_bf16 v[208:211], a[152:155], v[104:107], v[208:211]
    v_mfma_f32_16x16x32_bf16 v[212:215], a[152:155], v[108:111], v[212:215]
    v_mfma_f32_16x16x32_bf16 v[200:203], a[148:151], v[104:107], v[200:203]
    v_mfma_f32_16x16x32_bf16 v[204:207], a[148:151], v[108:111], v[204:207]
    v_mfma_f32_16x16x32_bf16 v[192:195], a[144:147], v[104:107], v[192:195]
    v_mfma_f32_16x16x32_bf16 v[196:199], a[144:147], v[108:111], v[196:199]
    s_add_u32 s80, s91, 16384
    v_mov_b32 v5, 0
    buffer_load_dword v3, v5, s[44:47], s80 offen sc1
    s_waitcnt vmcnt(7)
    v_mfma_f32_16x16x32_bf16 v[216:219], a[172:175], v[112:115], v[216:219]
    v_mfma_f32_16x16x32_bf16 v[220:223], a[172:175], v[116:119], v[220:223]
    v_mfma_f32_16x16x32_bf16 v[208:211], a[168:171], v[112:115], v[208:211]
    v_mfma_f32_16x16x32_bf16 v[212:215], a[168:171], v[116:119], v[212:215]
    s_waitcnt vmcnt(5)
    v_mfma_f32_16x16x32_bf16 v[216:219], a[188:191], v[120:123], v[216:219]
    v_mfma_f32_16x16x32_bf16 v[220:223], a[188:191], v[124:127], v[220:223]
    v_mfma_f32_16x16x32_bf16 v[208:211], a[184:187], v[120:123], v[208:211]
    v_mfma_f32_16x16x32_bf16 v[212:215], a[184:187], v[124:127], v[212:215]
    s_waitcnt vmcnt(3)
    v_mfma_f32_16x16x32_bf16 v[216:219], a[204:207], v[128:131], v[216:219]
    v_mfma_f32_16x16x32_bf16 v[220:223], a[204:207], v[132:135], v[220:223]
    v_mfma_f32_16x16x32_bf16 v[208:211], a[200:203], v[128:131], v[208:211]
    v_mfma_f32_16x16x32_bf16 v[212:215], a[200:203], v[132:135], v[212:215]
    s_waitcnt vmcnt(1)
    v_mfma_f32_16x16x32_bf16 v[216:219], a[220:223], v[136:139], v[216:219]
    v_mfma_f32_16x16x32_bf16 v[220:223], a[220:223], v[140:143], v[220:223]
    v_mfma_f32_16x16x32_bf16 v[208:211], a[216:219], v[136:139], v[208:211]
    v_mfma_f32_16x16x32_bf16 v[212:215], a[216:219], v[140:143], v[212:215]
    s_waitcnt vmcnt(0)
    v_cmp_gt_u32 vcc, 8, v3
    s_cbranch_vccnz .slow_19
.back_20:
    v_mfma_f32_16x16x32_bf16 v[200:203], a[164:167], v[112:115], v[200:203]
    v_mfma_f32_16x16x32_bf16 v[204:207], a[164:167], v[116:119], v[204:207]
    s_mov_b32 s78, 13107200
    buffer_load_dwordx4 v[32:35], v24, s[44:47], s78 offen offset:0 sc1
    v_mfma_f32_16x16x32_bf16 v[200:203], a[180:183], v[120:123], v[200:203]
    ds_write_b128 v29, v[216:219] offset:0
    v_mfma_f32_16x16x32_bf16 v[204:207], a[180:183], v[124:127], v[204:207]
    buffer_load_dwordx4 v[36:39], v24, s[44:47], s78 offen offset:256 sc1
    v_mfma_f32_16x16x32_bf16 v[200:203], a[196:199], v[128:131], v[200:203]
    ds_write_b128 v29, v[220:223] offset:1024
    v_mfma_f32_16x16x32_bf16 v[204:207], a[196:199], v[132:135], v[204:207]
    buffer_load_dwordx4 v[40:43], v24, s[44:47], s78 offen offset:2048 sc1
    v_mfma_f32_16x16x32_bf16 v[200:203], a[212:215], v[136:139], v[200:203]
    ds_write_b128 v28, v[208:211] offset:0
    v_mfma_f32_16x16x32_bf16 v[204:207], a[212:215], v[140:143], v[204:207]
    buffer_load_dwordx4 v[44:47], v24, s[44:47], s78 offen offset:2304 sc1
    v_mfma_f32_16x16x32_bf16 v[192:195], a[160:163], v[112:115], v[192:195]
    ds_write_b128 v28, v[212:215] offset:1024
    v_mfma_f32_16x16x32_bf16 v[196:199], a[160:163], v[116:119], v[196:199]
    s_mov_b32 s78, 13111296
    buffer_load_dwordx4 v[48:51], v24, s[44:47], s78 offen offset:0 sc1
    v_mfma_f32_16x16x32_bf16 v[192:195], a[176:179], v[120:123], v[192:195]
    v_mfma_f32_16x16x32_bf16 v[196:199], a[176:179], v[124:127], v[196:199]
    buffer_load_dwordx4 v[52:55], v24, s[44:47], s78 offen offset:256 sc1
    v_mfma_f32_16x16x32_bf16 v[192:195], a[192:195], v[128:131], v[192:195]
    ds_write_b128 v27, v[200:203] offset:0
    v_mfma_f32_16x16x32_bf16 v[196:199], a[192:195], v[132:135], v[196:199]
    buffer_load_dwordx4 v[56:59], v24, s[44:47], s78 offen offset:2048 sc1
    v_mfma_f32_16x16x32_bf16 v[192:195], a[208:211], v[136:139], v[192:195]
    ds_write_b128 v27, v[204:207] offset:1024
    v_mfma_f32_16x16x32_bf16 v[196:199], a[208:211], v[140:143], v[196:199]
    buffer_load_dwordx4 v[60:63], v24, s[44:47], s78 offen offset:2304 sc1
    s_mov_b32 s78, 13115392
    buffer_load_dwordx4 v[64:67], v24, s[44:47], s78 offen offset:0 sc1
    s_mov_b64 exec, s[86:87]
    v_swap_b32 v144, v145
    v_swap_b32 v146, v147
    s_mov_b64 exec, -1
    v_lshlrev_b32 v224, 16, v144
    v_and_b32 v225, s71, v144
    v_lshlrev_b32 v228, 16, v145
    v_and_b32 v229, s71, v145
    buffer_load_dwordx4 v[68:71], v24, s[44:47], s78 offen offset:256 sc1
    v_lshlrev_b32 v226, 16, v146
    v_and_b32 v227, s71, v146
    v_lshlrev_b32 v230, 16, v147
    v_and_b32 v231, s71, v147
    s_waitcnt lgkmcnt(0)
    s_barrier
    buffer_load_dwordx4 v[72:75], v24, s[44:47], s78 offen offset:2048 sc1
    ds_read_b128 v[160:163], v30 offset:0
    ds_read_b128 v[164:167], v30 offset:1024
    ds_read_b128 v[168:171], v30 offset:2048
    ds_read_b128 v[172:175], v30 offset:3072
    ds_read_b128 v[176:179], v30 offset:4096
    ds_read_b128 v[180:183], v30 offset:5120
    buffer_load_dwordx4 v[76:79], v24, s[44:47], s78 offen offset:2304 sc1
    s_waitcnt lgkmcnt(4)
    v_pk_add_f32 v[192:193], v[192:193], v[160:161]
    v_pk_add_f32 v[194:195], v[194:195], v[162:163]
    v_pk_add_f32 v[196:197], v[196:197], v[164:165]
    v_pk_add_f32 v[198:199], v[198:199], v[166:167]
    s_waitcnt lgkmcnt(2)
    s_mov_b32 s78, 13119488
    buffer_load_dwordx4 v[80:83], v24, s[44:47], s78 offen offset:0 sc1
    v_pk_add_f32 v[192:193], v[192:193], v[168:169]
    v_pk_add_f32 v[194:195], v[194:195], v[170:171]
    v_pk_add_f32 v[196:197], v[196:197], v[172:173]
    v_pk_add_f32 v[198:199], v[198:199], v[174:175]
    s_waitcnt lgkmcnt(0)
    v_pk_add_f32 v[192:193], v[192:193], v[176:177]
    buffer_load_dwordx4 v[84:87], v24, s[44:47], s78 offen offset:256 sc1
    v_pk_add_f32 v[194:195], v[194:195], v[178:179]
    v_pk_add_f32 v[196:197], v[196:197], v[180:181]
    v_pk_add_f32 v[198:199], v[198:199], v[182:183]
    v_cvt_pk_bf16_f32 v192, 0, v192
    v_cvt_pk_bf16_f32 v193, 0, v193
    v_cvt_pk_bf16_f32 v194, 0, v194
    v_cvt_pk_bf16_f32 v195, 0, v195
    v_cvt_pk_bf16_f32 v196, 0, v196
    v_cvt_pk_bf16_f32 v197, 0, v197
    v_cvt_pk_bf16_f32 v198, 0, v198
    v_cvt_pk_bf16_f32 v199, 0, v199
    v_pk_add_f32 v[192:193], v[192:193], v[224:225]
    v_pk_add_f32 v[194:195], v[194:195], v[226:227]
    v_pk_add_f32 v[196:197], v[196:197], v[228:229]
    v_pk_add_f32 v[198:199], v[198:199], v[230:231]
    v_cvt_pk_bf16_f32 v240, v192, v193
    v_cvt_pk_bf16_f32 v242, v194, v195
    v_cvt_pk_bf16_f32 v241, v196, v197
    v_cvt_pk_bf16_f32 v243, v198, v199
    s_mov_b32 s80, 5242880
    buffer_store_dwordx2 v[240:241], v26, s[44:47], s80 offen offset:0 sc1
    buffer_store_dwordx2 v[242:243], v26, s[44:47], s80 offen offset:256 sc1
    v_dot2_f32_bf16 v244, s70, v240, 0
    v_dot2_f32_bf16 v245, v240, v240, 0
    v_dot2_f32_bf16 v246, s70, v241, 0
    v_dot2_f32_bf16 v247, v241, v241, 0
    v_dot2_f32_bf16 v244, s70, v242, v244
    v_dot2_f32_bf16 v245, v242, v242, v245
    v_dot2_f32_bf16 v246, s70, v243, v246
    v_dot2_f32_bf16 v247, v243, v243, v247
    s_nop 1
    v_permlane32_swap_b32 v244, v246
    v_permlane32_swap_b32 v245, v247
    v_pk_add_f32 v[244:245], v[244:245], v[246:247]
    s_nop 1
    v_permlane16_swap_b32 v244, v245
    v_add_f32 v244, v244, v245
    v_lshrrev_b32 v246, 2, v6
    v_add_u32 v246, 156288, v246
    s_lshl_b32 s5, s60, 8
    v_add_u32 v247, s5, v246
    ds_write_b32 v247, v244
    s_waitcnt lgkmcnt(0)
    s_barrier
    ds_read2st64_b32 v[244:245], v246 offset0:0 offset1:1
    ds_read2st64_b32 v[246:247], v246 offset0:2 offset1:3
    s_mov_b32 s80, 540672
    s_waitcnt lgkmcnt(0)
    v_pk_add_f32 v[244:245], v[244:245], v[246:247]
    v_add_f32 v244, v244, v245
    s_mov_b64 exec, s[92:93]
    buffer_atomic_add_f32 v244, v31, s[44:47], s80 offen sc1
    s_mov_b64 exec, -1
    v_add_u32 v5, s90, v6
    global_load_dwordx4 v[252:255], v5, s[42:43]
    v_add_u32 v188, 7168, v12
    ds_read2_b32 v[144:145], v188 offset0:6 offset1:4
    ds_read2_b32 v[146:147], v188 offset0:2 offset1:0
    ds_read2_b32 v[148:149], v188 offset0:38 offset1:36
    ds_read2_b32 v[150:151], v188 offset0:34 offset1:32
    ds_read2_b32 v[152:153], v188 offset0:70 offset1:68
    ds_read2_b32 v[154:155], v188 offset0:66 offset1:64
    ds_read2_b32 v[156:157], v188 offset0:102 offset1:100
    ds_read2_b32 v[158:159], v188 offset0:98 offset1:96
    s_waitcnt vmcnt(16)
    v_mfma_f32_16x16x32_bf16 v[216:219], a[12:15], v[32:35], 0
    buffer_load_dwordx4 v[88:91], v24, s[44:47], s78 offen offset:2048 sc1
    v_mfma_f32_16x16x32_bf16 v[220:223], a[12:15], v[36:39], 0
    v_mfma_f32_16x16x32_bf16 v[208:211], a[8:11], v[32:35], 0
    v_mfma_f32_16x16x32_bf16 v[212:215], a[8:11], v[36:39], 0
    v_mfma_f32_16x16x32_bf16 v[200:203], a[4:7], v[32:35], 0
    buffer_load_dwordx4 v[92:95], v24, s[44:47], s78 offen offset:2304 sc1
    v_mfma_f32_16x16x32_bf16 v[204:207], a[4:7], v[36:39], 0
    v_mfma_f32_16x16x32_bf16 v[192:195], a[0:3], v[32:35], 0
    v_mfma_f32_16x16x32_bf16 v[196:199], a[0:3], v[36:39], 0
    s_waitcnt vmcnt(16)
    v_mfma_f32_16x16x32_bf16 v[216:219], a[28:31], v[40:43], v[216:219]
    s_mov_b32 s78, 13123584
    buffer_load_dwordx4 v[96:99], v24, s[44:47], s78 offen offset:0 sc1
    v_mfma_f32_16x16x32_bf16 v[220:223], a[28:31], v[44:47], v[220:223]
    v_mfma_f32_16x16x32_bf16 v[208:211], a[24:27], v[40:43], v[208:211]
    v_add_u32 v188, 0, v12
    ds_read2_b32 v[32:33], v188 offset0:6 offset1:4
    ds_read2_b32 v[34:35], v188 offset0:2 offset1:0
    v_mfma_f32_16x16x32_bf16 v[212:215], a[24:27], v[44:47], v[212:215]
    v_mfma_f32_16x16x32_bf16 v[200:203], a[20:23], v[40:43], v[200:203]
    buffer_load_dwordx4 v[100:103], v24, s[44:47], s78 offen offset:256 sc1
    v_mfma_f32_16x16x32_bf16 v[204:207], a[20:23], v[44:47], v[204:207]
    v_mfma_f32_16x16x32_bf16 v[192:195], a[16:19], v[40:43], v[192:195]
    ds_read2_b32 v[36:37], v188 offset0:38 offset1:36
    ds_read2_b32 v[38:39], v188 offset0:34 offset1:32
    v_mfma_f32_16x16x32_bf16 v[196:199], a[16:19], v[44:47], v[196:199]
    s_waitcnt vmcnt(5)
    s_barrier
    s_mov_b32 s80, 65536
    s_mov_b64 exec, s[76:77]
    v_mov_b32 v5, 1
    buffer_atomic_add v5, v2, s[44:47], s80 offen sc1
    s_mov_b64 exec, -1
    v_mfma_f32_16x16x32_bf16 v[216:219], a[44:47], v[48:51], v[216:219]
    buffer_load_dwordx4 v[104:107], v24, s[44:47], s78 offen offset:2048 sc1
    v_mfma_f32_16x16x32_bf16 v[220:223], a[44:47], v[52:55], v[220:223]
    v_mfma_f32_16x16x32_bf16 v[208:211], a[40:43], v[48:51], v[208:211]
    ds_read2_b32 v[40:41], v188 offset0:70 offset1:68
    ds_read2_b32 v[42:43], v188 offset0:66 offset1:64
    v_mfma_f32_16x16x32_bf16 v[212:215], a[40:43], v[52:55], v[212:215]
    v_mfma_f32_16x16x32_bf16 v[200:203], a[36:39], v[48:51], v[200:203]
    buffer_load_dwordx4 v[108:111], v24, s[44:47], s78 offen offset:2304 sc1
    v_mfma_f32_16x16x32_bf16 v[204:207], a[36:39], v[52:55], v[204:207]
    v_mfma_f32_16x16x32_bf16 v[192:195], a[32:35], v[48:51], v[192:195]
    ds_read2_b32 v[44:45], v188 offset0:102 offset1:100
    ds_read2_b32 v[46:47], v188 offset0:98 offset1:96
    v_mfma_f32_16x16x32_bf16 v[196:199], a[32:35], v[52:55], v[196:199]
    v_mfma_f32_16x16x32_bf16 v[216:219], a[60:63], v[56:59], v[216:219]
    s_mov_b32 s78, 13127680
    buffer_load_dwordx4 v[112:115], v24, s[44:47], s78 offen offset:0 sc1
    v_mfma_f32_16x16x32_bf16 v[220:223], a[60:63], v[60:63], v[220:223]
    v_mfma_f32_16x16x32_bf16 v[208:211], a[56:59], v[56:59], v[208:211]
    v_add_u32 v188, 1024, v12
    ds_read2_b32 v[48:49], v188 offset0:6 offset1:4
    ds_read2_b32 v[50:51], v188 offset0:2 offset1:0
    v_mfma_f32_16x16x32_bf16 v[212:215], a[56:59], v[60:63], v[212:215]
    v_mfma_f32_16x16x32_bf16 v[200:203], a[52:55], v[56:59], v[200:203]
    buffer_load_dwordx4 v[116:119], v24, s[44:47], s78 offen offset:256 sc1
    v_mfma_f32_16x16x32_bf16 v[204:207], a[52:55], v[60:63], v[204:207]
    v_mfma_f32_16x16x32_bf16 v[192:195], a[48:51], v[56:59], v[192:195]
    ds_read2_b32 v[52:53], v188 offset0:38 offset1:36
    ds_read2_b32 v[54:55], v188 offset0:34 offset1:32
    v_mfma_f32_16x16x32_bf16 v[196:199], a[48:51], v[60:63], v[196:199]
    v_mfma_f32_16x16x32_bf16 v[216:219], a[76:79], v[64:67], v[216:219]
    buffer_load_dwordx4 v[120:123], v24, s[44:47], s78 offen offset:2048 sc1
    v_mfma_f32_16x16x32_bf16 v[220:223], a[76:79], v[68:71], v[220:223]
    v_mfma_f32_16x16x32_bf16 v[208:211], a[72:75], v[64:67], v[208:211]
    ds_read2_b32 v[56:57], v188 offset0:70 offset1:68
    ds_read2_b32 v[58:59], v188 offset0:66 offset1:64
    v_mfma_f32_16x16x32_bf16 v[212:215], a[72:75], v[68:71], v[212:215]
    v_mfma_f32_16x16x32_bf16 v[200:203], a[68:71], v[64:67], v[200:203]
    buffer_load_dwordx4 v[124:127], v24, s[44:47], s78 offen offset:2304 sc1
    v_mfma_f32_16x16x32_bf16 v[204:207], a[68:71], v[68:71], v[204:207]
    v_mfma_f32_16x16x32_bf16 v[192:195], a[64:67], v[64:67], v[192:195]
    ds_read2_b32 v[60:61], v188 offset0:102 offset1:100
    ds_read2_b32 v[62:63], v188 offset0:98 offset1:96
    v_mfma_f32_16x16x32_bf16 v[196:199], a[64:67], v[68:71], v[196:199]
    v_mfma_f32_16x16x32_bf16 v[216:219], a[92:95], v[72:75], v[216:219]
    s_mov_b32 s78, 13131776
    buffer_load_dwordx4 v[128:131], v24, s[44:47], s78 offen offset:0 sc1
    v_mfma_f32_16x16x32_bf16 v[220:223], a[92:95], v[76:79], v[220:223]
    v_mfma_f32_16x16x32_bf16 v[208:211], a[88:91], v[72:75], v[208:211]
    v_add_u32 v188, 2048, v12
    ds_read2_b32 v[64:65], v188 offset0:6 offset1:4
    ds_read2_b32 v[66:67], v188 offset0:2 offset1:0
    v_mfma_f32_16x16x32_bf16 v[212:215], a[88:91], v[76:79], v[212:215]
    v_mfma_f32_16x16x32_bf16 v[200:203], a[84:87], v[72:75], v[200:203]
    buffer_load_dwordx4 v[132:135], v24, s[44:47], s78 offen offset:256 sc1
    v_mfma_f32_16x16x32_bf16 v[204:207], a[84:87], v[76:79], v[204:207]
    v_mfma_f32_16x16x32_bf16 v[192:195], a[80:83], v[72:75], v[192:195]
    ds_read2_b32 v[68:69], v188 offset0:38 offset1:36
    ds_read2_b32 v[70:71], v188 offset0:34 offset1:32
    v_mfma_f32_16x16x32_bf16 v[196:199], a[80:83], v[76:79], v[196:199]
    v_mfma_f32_16x16x32_bf16 v[216:219], a[108:111], v[80:83], v[216:219]
    buffer_load_dwordx4 v[136:139], v24, s[44:47], s78 offen offset:2048 sc1
    v_mfma_f32_16x16x32_bf16 v[220:223], a[108:111], v[84:87], v[220:223]
    v_mfma_f32_16x16x32_bf16 v[208:211], a[104:107], v[80:83], v[208:211]
    ds_read2_b32 v[72:73], v188 offset0:70 offset1:68
    ds_read2_b32 v[74:75], v188 offset0:66 offset1:64
    v_mfma_f32_16x16x32_bf16 v[212:215], a[104:107], v[84:87], v[212:215]
    v_mfma_f32_16x16x32_bf16 v[200:203], a[100:103], v[80:83], v[200:203]
    buffer_load_dwordx4 v[140:143], v24, s[44:47], s78 offen offset:2304 sc1
    v_mfma_f32_16x16x32_bf16 v[204:207], a[100:103], v[84:87], v[204:207]
    v_mfma_f32_16x16x32_bf16 v[192:195], a[96:99], v[80:83], v[192:195]
    ds_read2_b32 v[76:77], v188 offset0:102 offset1:100
    ds_read2_b32 v[78:79], v188 offset0:98 offset1:96
    v_mfma_f32_16x16x32_bf16 v[196:199], a[96:99], v[84:87], v[196:199]
    s_waitcnt vmcnt(13)
    v_mfma_f32_16x16x32_bf16 v[216:219], a[124:127], v[88:91], v[216:219]
    s_mov_b32 s80, 4194304
    buffer_load_dwordx2 v[184:185], v26, s[44:47], s80 offen offset:0 sc1
    buffer_load_dwordx2 v[186:187], v26, s[44:47], s80 offen offset:256 sc1
    v_mfma_f32_16x16x32_bf16 v[220:223], a[124:127], v[92:95], v[220:223]
    v_mfma_f32_16x16x32_bf16 v[208:211], a[120:123], v[88:91], v[208:211]
    v_add_u32 v188, 3072, v12
    ds_read2_b32 v[80:81], v188 offset0:6 offset1:4
    ds_read2_b32 v[82:83], v188 offset0:2 offset1:0
    v_mfma_f32_16x16x32_bf16 v[212:215], a[120:123], v[92:95], v[212:215]
    v_mfma_f32_16x16x32_bf16 v[200:203], a[116:119], v[88:91], v[200:203]
    v_mfma_f32_16x16x32_bf16 v[204:207], a[116:119], v[92:95], v[204:207]
    v_mfma_f32_16x16x32_bf16 v[192:195], a[112:115], v[88:91], v[192:195]
    ds_read2_b32 v[84:85], v188 offset0:38 offset1:36
    ds_read2_b32 v[86:87], v188 offset0:34 offset1:32
    v_mfma_f32_16x16x32_bf16 v[196:199], a[112:115], v[92:95], v[196:199]
    s_waitcnt vmcnt(13)
    v_mfma_f32_16x16x32_bf16 v[216:219], a[140:143], v[96:99], v[216:219]
    v_mfma_f32_16x16x32_bf16 v[220:223], a[140:143], v[100:103], v[220:223]
    v_mfma_f32_16x16x32_bf16 v[208:211], a[136:139], v[96:99], v[208:211]
    ds_read2_b32 v[88:89], v188 offset0:70 offset1:68
    ds_read2_b32 v[90:91], v188 offset0:66 offset1:64
    v_mfma_f32_16x16x32_bf16 v[212:215], a[136:139], v[100:103], v[212:215]
    v_mfma_f32_16x16x32_bf16 v[200:203], a[132:135], v[96:99], v[200:203]
    v_mfma_f32_16x16x32_bf16 v[204:207], a[132:135], v[100:103], v[204:207]
    v_mfma_f32_16x16x32_bf16 v[192:195], a[128:131], v[96:99], v[192:195]
    ds_read2_b32 v[92:93], v188 offset0:102 offset1:100
    ds_read2_b32 v[94:95], v188 offset0:98 offset1:96
    v_mfma_f32_16x16x32_bf16 v[196:199], a[128:131], v[100:103], v[196:199]
    s_waitcnt vmcnt(10)
    v_mfma_f32_16x16x32_bf16 v[216:219], a[156:159], v[104:107], v[216:219]
    v_mfma_f32_16x16x32_bf16 v[220:223], a[156:159], v[108:111], v[220:223]
    v_mfma_f32_16x16x32_bf16 v[208:211], a[152:155], v[104:107], v[208:211]
    v_add_u32 v188, 4096, v12
    ds_read2_b32 v[96:97], v188 offset0:6 offset1:4
    ds_read2_b32 v[98:99], v188 offset0:2 offset1:0
    v_mfma_f32_16x16x32_bf16 v[212:215], a[152:155], v[108:111], v[212:215]
    v_mfma_f32_16x16x32_bf16 v[200:203], a[148:151], v[104:107], v[200:203]
    v_mfma_f32_16x16x32_bf16 v[204:207], a[148:151], v[108:111], v[204:207]
    v_mfma_f32_16x16x32_bf16 v[192:195], a[144:147], v[104:107], v[192:195]
    ds_read2_b32 v[100:101], v188 offset0:38 offset1:36
    ds_read2_b32 v[102:103], v188 offset0:34 offset1:32
    v_mfma_f32_16x16x32_bf16 v[196:199], a[144:147], v[108:111], v[196:199]
    s_waitcnt vmcnt(8)
    v_mfma_f32_16x16x32_bf16 v[216:219], a[172:175], v[112:115], v[216:219]
    v_mfma_f32_16x16x32_bf16 v[220:223], a[172:175], v[116:119], v[220:223]
    v_mfma_f32_16x16x32_bf16 v[208:211], a[168:171], v[112:115], v[208:211]
    ds_read2_b32 v[104:105], v188 offset0:70 offset1:68
    ds_read2_b32 v[106:107], v188 offset0:66 offset1:64
    v_mfma_f32_16x16x32_bf16 v[212:215], a[168:171], v[116:119], v[212:215]
    s_waitcnt vmcnt(6)
    v_mfma_f32_16x16x32_bf16 v[216:219], a[188:191], v[120:123], v[216:219]
    v_mfma_f32_16x16x32_bf16 v[220:223], a[188:191], v[124:127], v[220:223]
    v_mfma_f32_16x16x32_bf16 v[208:211], a[184:187], v[120:123], v[208:211]
    ds_read2_b32 v[108:109], v188 offset0:102 offset1:100
    ds_read2_b32 v[110:111], v188 offset0:98 offset1:96
    v_mfma_f32_16x16x32_bf16 v[212:215], a[184:187], v[124:127], v[212:215]
    s_mov_b32 s80, 65536
    buffer_load_dword v3, v1, s[44:47], s80 offen sc1
    s_waitcnt vmcnt(5)
    v_mfma_f32_16x16x32_bf16 v[216:219], a[204:207], v[128:131], v[216:219]
    v_mfma_f32_16x16x32_bf16 v[220:223], a[204:207], v[132:135], v[220:223]
    v_mfma_f32_16x16x32_bf16 v[208:211], a[200:203], v[128:131], v[208:211]
    v_mfma_f32_16x16x32_bf16 v[212:215], a[200:203], v[132:135], v[212:215]
    s_waitcnt vmcnt(3)
    v_mfma_f32_16x16x32_bf16 v[216:219], a[220:223], v[136:139], v[216:219]
    v_mfma_f32_16x16x32_bf16 v[220:223], a[220:223], v[140:143], v[220:223]
    v_mfma_f32_16x16x32_bf16 v[208:211], a[216:219], v[136:139], v[208:211]
    v_mfma_f32_16x16x32_bf16 v[212:215], a[216:219], v[140:143], v[212:215]
    v_mfma_f32_16x16x32_bf16 v[200:203], a[164:167], v[112:115], v[200:203]
    v_mfma_f32_16x16x32_bf16 v[204:207], a[164:167], v[116:119], v[204:207]
    v_mfma_f32_16x16x32_bf16 v[200:203], a[180:183], v[120:123], v[200:203]
    s_nop 1
    ds_write_b128 v29, v[216:219] offset:0
    v_mfma_f32_16x16x32_bf16 v[204:207], a[180:183], v[124:127], v[204:207]
    v_mfma_f32_16x16x32_bf16 v[200:203], a[196:199], v[128:131], v[200:203]
    ds_write_b128 v29, v[220:223] offset:1024
    v_mfma_f32_16x16x32_bf16 v[204:207], a[196:199], v[132:135], v[204:207]
    v_mfma_f32_16x16x32_bf16 v[200:203], a[212:215], v[136:139], v[200:203]
    ds_write_b128 v28, v[208:211] offset:0
    v_mfma_f32_16x16x32_bf16 v[204:207], a[212:215], v[140:143], v[204:207]
    v_mfma_f32_16x16x32_bf16 v[192:195], a[160:163], v[112:115], v[192:195]
    ds_write_b128 v28, v[212:215] offset:1024
    v_mfma_f32_16x16x32_bf16 v[196:199], a[160:163], v[116:119], v[196:199]
    v_mfma_f32_16x16x32_bf16 v[192:195], a[176:179], v[120:123], v[192:195]
    v_mfma_f32_16x16x32_bf16 v[196:199], a[176:179], v[124:127], v[196:199]
    v_mfma_f32_16x16x32_bf16 v[192:195], a[192:195], v[128:131], v[192:195]
    ds_write_b128 v27, v[200:203] offset:0
    v_mfma_f32_16x16x32_bf16 v[196:199], a[192:195], v[132:135], v[196:199]
    v_mfma_f32_16x16x32_bf16 v[192:195], a[208:211], v[136:139], v[192:195]
    ds_write_b128 v27, v[204:207] offset:1024
    v_mfma_f32_16x16x32_bf16 v[196:199], a[208:211], v[140:143], v[196:199]
    s_waitcnt vmcnt(1)
    s_mov_b64 exec, s[86:87]
    v_swap_b32 v184, v185
    v_swap_b32 v186, v187
    s_mov_b64 exec, -1
    v_lshlrev_b32 v224, 16, v184
    v_and_b32 v225, s71, v184
    v_lshlrev_b32 v228, 16, v185
    v_and_b32 v229, s71, v185
    v_lshlrev_b32 v226, 16, v186
    v_and_b32 v227, s71, v186
    v_lshlrev_b32 v230, 16, v187
    v_and_b32 v231, s71, v187
    s_waitcnt lgkmcnt(0)
    s_barrier
    ds_read_b128 v[160:163], v30 offset:0
    ds_read_b128 v[164:167], v30 offset:1024
    ds_read_b128 v[168:171], v30 offset:2048
    ds_read_b128 v[172:175], v30 offset:3072
    ds_read_b128 v[176:179], v30 offset:4096
    ds_read_b128 v[180:183], v30 offset:5120
    s_waitcnt vmcnt(0)
    v_cmp_gt_u32 vcc, 32, v3
    s_cbranch_vccnz .slow_22
.back_23:
    s_mov_b32 s80, 5242880
    buffer_load_dwordx4 v[248:251], v8, s[44:47], s80 offen sc1
    s_mov_b32 s80, 540672
    buffer_load_dwordx4 v[232:235], v9, s[44:47], s80 offen sc1
    buffer_load_dwordx4 v[236:239], v9, s[44:47], s80 offen offset:16 sc1
    s_waitcnt lgkmcnt(4)
    v_pk_add_f32 v[192:193], v[192:193], v[160:161]
    v_pk_add_f32 v[194:195], v[194:195], v[162:163]
    v_pk_add_f32 v[196:197], v[196:197], v[164:165]
    v_pk_add_f32 v[198:199], v[198:199], v[166:167]
    s_waitcnt lgkmcnt(2)
    v_pk_add_f32 v[192:193], v[192:193], v[168:169]
    v_pk_add_f32 v[194:195], v[194:195], v[170:171]
    v_pk_add_f32 v[196:197], v[196:197], v[172:173]
    v_pk_add_f32 v[198:199], v[198:199], v[174:175]
    s_waitcnt lgkmcnt(0)
    v_pk_add_f32 v[192:193], v[192:193], v[176:177]
    v_pk_add_f32 v[194:195], v[194:195], v[178:179]
    v_pk_add_f32 v[196:197], v[196:197], v[180:181]
    v_pk_add_f32 v[198:199], v[198:199], v[182:183]
    v_cvt_pk_bf16_f32 v192, 0, v192
    v_cvt_pk_bf16_f32 v193, 0, v193
    v_cvt_pk_bf16_f32 v194, 0, v194
    v_cvt_pk_bf16_f32 v195, 0, v195
    v_cvt_pk_bf16_f32 v196, 0, v196
    v_cvt_pk_bf16_f32 v197, 0, v197
    v_cvt_pk_bf16_f32 v198, 0, v198
    v_cvt_pk_bf16_f32 v199, 0, v199
    v_pk_add_f32 v[192:193], v[192:193], v[224:225]
    v_pk_add_f32 v[194:195], v[194:195], v[226:227]
    v_pk_add_f32 v[196:197], v[196:197], v[228:229]
    v_pk_add_f32 v[198:199], v[198:199], v[230:231]
    v_cvt_pk_bf16_f32 v240, v192, v193
    v_cvt_pk_bf16_f32 v242, v194, v195
    v_cvt_pk_bf16_f32 v241, v196, v197
    v_cvt_pk_bf16_f32 v243, v198, v199
    s_mov_b32 s80, 6291456
    buffer_store_dwordx2 v[240:241], v26, s[44:47], s80 offen offset:0 sc1
    buffer_store_dwordx2 v[242:243], v26, s[44:47], s80 offen offset:256 sc1
    v_dot2_f32_bf16 v244, s70, v240, 0
    v_dot2_f32_bf16 v245, v240, v240, 0
    v_dot2_f32_bf16 v246, s70, v241, 0
    v_dot2_f32_bf16 v247, v241, v241, 0
    v_dot2_f32_bf16 v244, s70, v242, v244
    v_dot2_f32_bf16 v245, v242, v242, v245
    v_dot2_f32_bf16 v246, s70, v243, v246
    v_dot2_f32_bf16 v247, v243, v243, v247
    s_nop 1
    v_permlane32_swap_b32 v244, v246
    v_permlane32_swap_b32 v245, v247
    v_pk_add_f32 v[244:245], v[244:245], v[246:247]
    s_nop 1
    v_permlane16_swap_b32 v244, v245
    v_add_f32 v244, v244, v245
    v_lshrrev_b32 v246, 2, v6
    v_add_u32 v246, 156288, v246
    s_lshl_b32 s5, s60, 8
    v_add_u32 v247, s5, v246
    ds_write_b32 v247, v244
    s_waitcnt lgkmcnt(0)
    s_barrier
    ds_read2st64_b32 v[244:245], v246 offset0:0 offset1:1
    ds_read2st64_b32 v[246:247], v246 offset0:2 offset1:3
    s_mov_b32 s80, 548864
    s_waitcnt lgkmcnt(0)
    v_pk_add_f32 v[244:245], v[244:245], v[246:247]
    v_add_f32 v244, v244, v245
    s_mov_b64 exec, s[92:93]
    buffer_atomic_add_f32 v244, v31, s[44:47], s80 offen sc1
    s_mov_b64 exec, -1
    v_subrev_u32 v5, 140928, v13
    v_and_b32 v5, 0x3f0, v5
    v_lshrrev_b32 v5, 1, v5
    v_add_u32 v5, 131712, v5
    v_mov_b32 v240, 0
    v_mov_b32 v241, 0
    ds_write_b64 v5, v[240:241]
    ds_write_b64 v5, v[240:241] offset:4608
    s_waitcnt vmcnt(3)
    v_pk_mul_f32 v[232:233], v[232:233], s[72:73]
    v_pk_mul_f32 v[234:235], v[234:235], s[72:73]
    v_pk_mul_f32 v[236:237], v[236:237], s[72:73]
    v_pk_mul_f32 v[238:239], v[238:239], s[72:73]
    v_fma_f32 v196, -v232, v232, v233
    v_fma_f32 v197, -v234, v234, v235
    v_fma_f32 v198, -v236, v236, v237
    v_fma_f32 v199, -v238, v238, v239
    v_cvt_pk_bf16_f32 v196, 0, v196
    v_cvt_pk_bf16_f32 v197, 0, v197
    v_cvt_pk_bf16_f32 v198, 0, v198
    v_cvt_pk_bf16_f32 v199, 0, v199
    v_add_f32 v196, s74, v196
    v_add_f32 v197, s74, v197
    v_add_f32 v198, s74, v198
    v_add_f32 v199, s74, v199
    v_cvt_pk_bf16_f32 v196, 0, v196
    v_cvt_pk_bf16_f32 v197, 0, v197
    v_cvt_pk_bf16_f32 v198, 0, v198
    v_cvt_pk_bf16_f32 v199, 0, v199
    v_sqrt_f32 v196, abs(v196)
    v_sqrt_f32 v197, abs(v197)
    v_sqrt_f32 v198, abs(v198)
    v_sqrt_f32 v199, abs(v199)
    v_cvt_pk_bf16_f32 v192, 0, v232
    v_cvt_pk_bf16_f32 v193, 0, v234
    v_cvt_pk_bf16_f32 v194, 0, v236
    v_cvt_pk_bf16_f32 v195, 0, v238
    v_cvt_pk_bf16_f32 v196, 0, v196
    v_cvt_pk_bf16_f32 v197, 0, v197
    v_cvt_pk_bf16_f32 v198, 0, v198
    v_cvt_pk_bf16_f32 v199, 0, v199
    v_rcp_f32 v196, v196
    v_rcp_f32 v197, v197
    v_rcp_f32 v198, v198
    v_rcp_f32 v199, v199
    v_lshlrev_b32 v224, 16, v248
    v_and_b32 v228, s71, v248
    v_lshlrev_b32 v225, 16, v249
    v_and_b32 v229, s71, v249
    v_lshlrev_b32 v226, 16, v250
    v_and_b32 v230, s71, v250
    v_lshlrev_b32 v227, 16, v251
    v_and_b32 v231, s71, v251
    v_pk_add_f32 v[176:177], v[224:225], v[192:193] neg_lo:[0,1] neg_hi:[0,1]
    v_pk_add_f32 v[178:179], v[226:227], v[194:195] neg_lo:[0,1] neg_hi:[0,1]
    v_pk_add_f32 v[180:181], v[228:229], v[192:193] neg_lo:[0,1] neg_hi:[0,1]
    v_pk_add_f32 v[182:183], v[230:231], v[194:195] neg_lo:[0,1] neg_hi:[0,1]
    v_cvt_pk_bf16_f32 v176, 0, v176
    v_cvt_pk_bf16_f32 v177, 0, v177
    v_cvt_pk_bf16_f32 v178, 0, v178
    v_cvt_pk_bf16_f32 v179, 0, v179
    v_cvt_pk_bf16_f32 v180, 0, v180
    v_cvt_pk_bf16_f32 v181, 0, v181
    v_cvt_pk_bf16_f32 v182, 0, v182
    v_cvt_pk_bf16_f32 v183, 0, v183
    v_pk_mul_f32 v[176:177], v[176:177], v[196:197]
    v_pk_mul_f32 v[178:179], v[178:179], v[198:199]
    v_pk_mul_f32 v[180:181], v[180:181], v[196:197]
    v_pk_mul_f32 v[182:183], v[182:183], v[198:199]
    v_cvt_pk_bf16_f32 v240, v176, v177
    v_cvt_pk_bf16_f32 v241, v178, v179
    v_cvt_pk_bf16_f32 v242, v180, v181
    v_cvt_pk_bf16_f32 v243, v182, v183
    ds_write_b64 v10, v[240:241] offset:0
    ds_write_b64 v10, v[242:243] offset:4608
    s_waitcnt vmcnt(0)
    s_waitcnt lgkmcnt(0)
    s_barrier
    s_nop 0
    s_mov_b32 s80, 98304
    s_mov_b64 exec, s[76:77]
    v_mov_b32 v5, 1
    buffer_atomic_add v5, v2, s[44:47], s80 offen sc1
    s_mov_b64 exec, -1
    ds_read_b128 v[160:163], v11 offset:480
    ds_read_b128 v[164:167], v11 offset:416
    ds_read_b128 v[168:171], v11 offset:352
    ds_read_b128 v[172:175], v11 offset:288
    ds_read_b128 v[176:179], v11 offset:992
    ds_read_b128 v[180:183], v11 offset:928
    s_waitcnt lgkmcnt(5)
    v_mfma_f32_16x16x32_bf16 a[224:227], v[32:35], v[160:163], 0
    ds_read_b128 v[184:187], v11 offset:864
    v_mfma_f32_16x16x32_bf16 a[228:231], v[48:51], v[160:163], 0
    ds_read_b128 v[188:191], v11 offset:800
    v_mfma_f32_16x16x32_bf16 a[232:235], v[64:67], v[160:163], 0
    ds_read_b128 v[192:195], v11 offset:1504
    v_mfma_f32_16x16x32_bf16 a[236:239], v[80:83], v[160:163], 0
    ds_read_b128 v[196:199], v11 offset:1440
    s_waitcnt lgkmcnt(8)
    v_mfma_f32_16x16x32_bf16 a[224:227], v[36:39], v[164:167], a[224:227]
    ds_read_b128 v[200:203], v11 offset:1376
    v_mfma_f32_16x16x32_bf16 a[228:231], v[52:55], v[164:167], a[228:231]
    ds_read_b128 v[204:207], v11 offset:1312
    v_mfma_f32_16x16x32_bf16 a[232:235], v[68:71], v[164:167], a[232:235]
    ds_read_b128 v[208:211], v11 offset:2016
    v_mfma_f32_16x16x32_bf16 a[236:239], v[84:87], v[164:167], a[236:239]
    ds_read_b128 v[212:215], v11 offset:1952
    s_waitcnt lgkmcnt(11)
    v_mfma_f32_16x16x32_bf16 a[224:227], v[40:43], v[168:171], a[224:227]
    ds_read_b128 v[216:219], v11 offset:1888
    v_mfma_f32_16x16x32_bf16 a[228:231], v[56:59], v[168:171], a[228:231]
    ds_read_b128 v[220:223], v11 offset:1824
    v_mfma_f32_16x16x32_bf16 a[232:235], v[72:75], v[168:171], a[232:235]
    v_lshlrev_b32 v232, 16, v240
    v_mfma_f32_16x16x32_bf16 a[236:239], v[88:91], v[168:171], a[236:239]
    v_add_u32 v5, 5120, v12
    ds_read2_b32 v[112:113], v5 offset0:6 offset1:4
    ds_read2_b32 v[114:115], v5 offset0:2 offset1:0
    v_and_b32 v233, s71, v240
    s_waitcnt lgkmcnt(14)
    v_mfma_f32_16x16x32_bf16 a[224:227], v[44:47], v[172:175], a[224:227]
    v_lshlrev_b32 v234, 16, v241
    v_mfma_f32_16x16x32_bf16 a[228:231], v[60:63], v[172:175], a[228:231]
    v_and_b32 v235, s71, v241
    ds_read2_b32 v[116:117], v5 offset0:38 offset1:36
    ds_read2_b32 v[118:119], v5 offset0:34 offset1:32
    v_mfma_f32_16x16x32_bf16 a[232:235], v[76:79], v[172:175], a[232:235]
    v_lshlrev_b32 v236, 16, v242
    v_mfma_f32_16x16x32_bf16 a[236:239], v[92:95], v[172:175], a[236:239]
    v_and_b32 v237, s71, v242
    s_waitcnt lgkmcnt(15)
    v_mfma_f32_16x16x32_bf16 a[228:231], v[32:35], v[176:179], a[228:231]
    ds_read2_b32 v[120:121], v5 offset0:70 offset1:68
    ds_read2_b32 v[122:123], v5 offset0:66 offset1:64
    v_lshlrev_b32 v238, 16, v243
    v_mfma_f32_16x16x32_bf16 a[232:235], v[48:51], v[176:179], a[232:235]
    v_and_b32 v239, s71, v243
    ds_write_b128 v13, a[224:227] offset:0
    v_mfma_f32_16x16x32_bf16 a[236:239], v[64:67], v[176:179], a[236:239]
    v_fmac_f32 v224, s68, v232
    ds_read2_b32 v[124:125], v5 offset0:102 offset1:100
    ds_read2_b32 v[126:127], v5 offset0:98 offset1:96
    s_waitcnt lgkmcnt(15)
    v_mfma_f32_16x16x32_bf16 a[228:231], v[36:39], v[180:183], a[228:231]
    v_fmac_f32 v225, s68, v233
    v_mfma_f32_16x16x32_bf16 a[232:235], v[52:55], v[180:183], a[232:235]
    v_fmac_f32 v226, s68, v234
    v_mfma_f32_16x16x32_bf16 a[236:239], v[68:71], v[180:183], a[236:239]
    v_add_u32 v5, 6144, v12
    ds_read2_b32 v[128:129], v5 offset0:6 offset1:4
    ds_read2_b32 v[130:131], v5 offset0:2 offset1:0
    v_fmac_f32 v227, s68, v235
    v_mfma_f32_16x16x32_bf16 a[228:231], v[40:43], v[184:187], a[228:231]
    v_fmac_f32 v228, s69, v236
    v_mfma_f32_16x16x32_bf16 a[232:235], v[56:59], v[184:187], a[232:235]
    v_fmac_f32 v229, s69, v237
    ds_read2_b32 v[132:133], v5 offset0:38 offset1:36
    ds_read2_b32 v[134:135], v5 offset0:34 offset1:32
    v_mfma_f32_16x16x32_bf16 a[236:239], v[72:75], v[184:187], a[236:239]
    v_fmac_f32 v230, s69, v238
    v_mfma_f32_16x16x32_bf16 a[228:231], v[44:47], v[188:191], a[228:231]
    v_fmac_f32 v231, s69, v239
    v_mfma_f32_16x16x32_bf16 a[232:235], v[60:63], v[188:191], a[232:235]
    ds_read2_b32 v[136:137], v5 offset0:70 offset1:68
    ds_read2_b32 v[138:139], v5 offset0:66 offset1:64
    v_mfma_f32_16x16x32_bf16 a[236:239], v[76:79], v[188:191], a[236:239]
    v_mfma_f32_16x16x32_bf16 a[232:235], v[32:35], v[192:195], a[232:235]
    v_mfma_f32_16x16x32_bf16 a[236:239], v[48:51], v[192:195], a[236:239]
    v_mfma_f32_16x16x32_bf16 a[232:235], v[36:39], v[196:199], a[232:235]
    ds_read2_b32 v[140:141], v5 offset0:102 offset1:100
    ds_read2_b32 v[142:143], v5 offset0:98 offset1:96
    ds_write_b128 v13, a[228:231] offset:4096
    v_mfma_f32_16x16x32_bf16 a[236:239], v[52:55], v[196:199], a[236:239]
    s_waitcnt lgkmcnt(15)
    v_mfma_f32_16x16x32_bf16 a[232:235], v[40:43], v[200:203], a[232:235]
    v_mfma_f32_16x16x32_bf16 a[236:239], v[56:59], v[200:203], a[236:239]
    v_mfma_f32_16x16x32_bf16 a[232:235], v[44:47], v[204:207], a[232:235]
    v_mfma_f32_16x16x32_bf16 a[236:239], v[60:63], v[204:207], a[236:239]
    v_mfma_f32_16x16x32_bf16 a[236:239], v[32:35], v[208:211], a[236:239]
    v_mfma_f32_16x16x32_bf16 a[236:239], v[36:39], v[212:215], a[236:239]
    v_mfma_f32_16x16x32_bf16 a[236:239], v[40:43], v[216:219], a[236:239]
    v_mfma_f32_16x16x32_bf16 a[236:239], v[44:47], v[220:223], a[236:239]
    s_nop 2
    ds_write_b128 v13, a[232:235] offset:8192
    s_nop 3
    ds_write_b128 v13, a[236:239] offset:12288
    v_mfma_f32_16x16x32_bf16 a[240:243], v[80:83], v[176:179], 0
    v_mfma_f32_16x16x32_bf16 a[240:243], v[64:67], v[192:195], a[240:243]
    v_mfma_f32_16x16x32_bf16 a[240:243], v[48:51], v[208:211], a[240:243]
    v_mfma_f32_16x16x32_bf16 a[244:247], v[80:83], v[192:195], 0
    v_mfma_f32_16x16x32_bf16 a[244:247], v[64:67], v[208:211], a[244:247]
    s_waitcnt lgkmcnt(0)
    s_barrier
    ds_read_b128 v[232:235], v14 offset:0
    ds_read_b128 v[236:239], v14 offset:1024
    ds_read_b128 v[240:243], v14 offset:2048
    ds_read_b128 v[244:247], v14 offset:3072
    v_mfma_f32_16x16x32_bf16 a[248:251], v[80:83], v[208:211], 0
    v_mfma_f32_16x16x32_bf16 a[240:243], v[84:87], v[180:183], a[240:243]
    v_mfma_f32_16x16x32_bf16 a[240:243], v[68:71], v[196:199], a[240:243]
    v_mfma_f32_16x16x32_bf16 a[240:243], v[52:55], v[212:215], a[240:243]
    v_mfma_f32_16x16x32_bf16 a[244:247], v[84:87], v[196:199], a[244:247]
    v_mfma_f32_16x16x32_bf16 a[244:247], v[68:71], v[212:215], a[244:247]
    v_mfma_f32_16x16x32_bf16 a[248:251], v[84:87], v[212:215], a[248:251]
    s_mov_b32 s80, 7340032
    s_waitcnt lgkmcnt(2)
    v_pk_add_f32 v[232:233], v[232:233], v[236:237]
    v_pk_add_f32 v[234:235], v[234:235], v[238:239]
    v_pk_add_f32 v[224:225], v[224:225], v[232:233]
    v_pk_add_f32 v[226:227], v[226:227], v[234:235]
    s_waitcnt lgkmcnt(0)
    v_pk_add_f32 v[240:241], v[240:241], v[244:245]
    v_pk_add_f32 v[242:243], v[242:243], v[246:247]
    v_pk_add_f32 v[228:229], v[228:229], v[240:241]
    v_pk_add_f32 v[230:231], v[230:231], v[242:243]
    v_cvt_pk_bf16_f32 v244, v224, v228
    v_cvt_pk_bf16_f32 v245, v225, v229
    v_cvt_pk_bf16_f32 v246, v226, v230
    v_cvt_pk_bf16_f32 v247, v227, v231
    s_mov_b64 exec, s[100:101]
    v_swap_b32 v244, v245
    v_swap_b32 v246, v247
    s_mov_b64 exec, -1
    buffer_store_dwordx4 v[244:247], v8, s[44:47], s80 offen sc1
    v_mfma_f32_16x16x32_bf16 a[240:243], v[88:91], v[184:187], a[240:243]
    s_mov_b32 s80, 98304
    buffer_load_dword v3, v1, s[44:47], s80 offen sc1
    v_mfma_f32_16x16x32_bf16 a[240:243], v[72:75], v[200:203], a[240:243]
    v_mfma_f32_16x16x32_bf16 a[240:243], v[56:59], v[216:219], a[240:243]
    v_mfma_f32_16x16x32_bf16 a[244:247], v[88:91], v[200:203], a[244:247]
    v_mfma_f32_16x16x32_bf16 a[244:247], v[72:75], v[216:219], a[244:247]
    v_mfma_f32_16x16x32_bf16 a[248:251], v[88:91], v[216:219], a[248:251]
    v_mfma_f32_16x16x32_bf16 a[240:243], v[92:95], v[188:191], a[240:243]
    v_mfma_f32_16x16x32_bf16 a[240:243], v[76:79], v[204:207], a[240:243]
    v_mfma_f32_16x16x32_bf16 a[240:243], v[60:63], v[220:223], a[240:243]
    v_mfma_f32_16x16x32_bf16 a[244:247], v[92:95], v[204:207], a[244:247]
    v_mfma_f32_16x16x32_bf16 a[244:247], v[76:79], v[220:223], a[244:247]
    v_mfma_f32_16x16x32_bf16 a[248:251], v[92:95], v[220:223], a[248:251]
    v_mfma_f32_16x16x32_bf16 a[240:243], v[96:99], v[160:163], a[240:243]
    v_mfma_f32_16x16x32_bf16 a[244:247], v[112:115], v[160:163], a[244:247]
    v_mfma_f32_16x16x32_bf16 a[244:247], v[96:99], v[176:179], a[244:247]
    v_mfma_f32_16x16x32_bf16 a[248:251], v[128:131], v[160:163], a[248:251]
    v_mfma_f32_16x16x32_bf16 a[248:251], v[112:115], v[176:179], a[248:251]
    v_mfma_f32_16x16x32_bf16 a[248:251], v[96:99], v[192:195], a[248:251]
    v_mfma_f32_16x16x32_bf16 a[252:255], v[144:147], v[160:163], 0
    v_mfma_f32_16x16x32_bf16 a[252:255], v[128:131], v[176:179], a[252:255]
    v_mfma_f32_16x16x32_bf16 a[252:255], v[112:115], v[192:195], a[252:255]
    v_mfma_f32_16x16x32_bf16 a[252:255], v[96:99], v[208:211], a[252:255]
    v_mfma_f32_16x16x32_bf16 a[240:243], v[100:103], v[164:167], a[240:243]
    v_mfma_f32_16x16x32_bf16 a[244:247], v[116:119], v[164:167], a[244:247]
    v_mfma_f32_16x16x32_bf16 a[244:247], v[100:103], v[180:183], a[244:247]
    v_mfma_f32_16x16x32_bf16 a[248:251], v[132:135], v[164:167], a[248:251]
    v_mfma_f32_16x16x32_bf16 a[248:251], v[116:119], v[180:183], a[248:251]
    v_mfma_f32_16x16x32_bf16 a[248:251], v[100:103], v[196:199], a[248:251]
    v_mfma_f32_16x16x32_bf16 a[252:255], v[148:151], v[164:167], a[252:255]
    v_mfma_f32_16x16x32_bf16 a[252:255], v[132:135], v[180:183], a[252:255]
    v_mfma_f32_16x16x32_bf16 a[252:255], v[116:119], v[196:199], a[252:255]
    v_mfma_f32_16x16x32_bf16 a[252:255], v[100:103], v[212:215], a[252:255]
    v_mfma_f32_16x16x32_bf16 a[240:243], v[104:107], v[168:171], a[240:243]
    v_mfma_f32_16x16x32_bf16 a[244:247], v[120:123], v[168:171], a[244:247]
    v_mfma_f32_16x16x32_bf16 a[244:247], v[104:107], v[184:187], a[244:247]
    v_mfma_f32_16x16x32_bf16 a[248:251], v[136:139], v[168:171], a[248:251]
    v_mfma_f32_16x16x32_bf16 a[248:251], v[120:123], v[184:187], a[248:251]
    v_mfma_f32_16x16x32_bf16 a[248:251], v[104:107], v[200:203], a[248:251]
    v_mfma_f32_16x16x32_bf16 a[252:255], v[152:155], v[168:171], a[252:255]
    s_waitcnt vmcnt(0)
    v_cmp_gt_u32 vcc, 32, v3
    s_cbranch_vccnz .slow_25
.back_26:
    s_mov_b32 s80, 6291456
    buffer_load_dwordx4 v[248:251], v8, s[44:47], s80 offen sc1
    s_mov_b32 s80, 548864
    buffer_load_dwordx4 v[232:235], v9, s[44:47], s80 offen sc1
    buffer_load_dwordx4 v[236:239], v9, s[44:47], s80 offen offset:16 sc1
    v_mfma_f32_16x16x32_bf16 a[252:255], v[136:139], v[184:187], a[252:255]
    v_mfma_f32_16x16x32_bf16 a[252:255], v[120:123], v[200:203], a[252:255]
    v_mfma_f32_16x16x32_bf16 a[252:255], v[104:107], v[216:219], a[252:255]
    v_mfma_f32_16x16x32_bf16 a[240:243], v[108:111], v[172:175], a[240:243]
    v_mfma_f32_16x16x32_bf16 a[244:247], v[124:127], v[172:175], a[244:247]
    v_mfma_f32_16x16x32_bf16 a[244:247], v[108:111], v[188:191], a[244:247]
    v_mfma_f32_16x16x32_bf16 a[248:251], v[140:143], v[172:175], a[248:251]
    v_mfma_f32_16x16x32_bf16 a[248:251], v[124:127], v[188:191], a[248:251]
    v_mfma_f32_16x16x32_bf16 a[248:251], v[108:111], v[204:207], a[248:251]
    v_mfma_f32_16x16x32_bf16 a[252:255], v[156:159], v[172:175], a[252:255]
    v_mfma_f32_16x16x32_bf16 a[252:255], v[140:143], v[188:191], a[252:255]
    v_mfma_f32_16x16x32_bf16 a[252:255], v[124:127], v[204:207], a[252:255]
    s_barrier
    s_mov_b32 s80, 131072
    s_mov_b64 exec, s[76:77]
    v_mov_b32 v5, 1
    buffer_atomic_add v5, v2, s[44:47], s80 offen sc1
    s_mov_b64 exec, -1
    v_mfma_f32_16x16x32_bf16 a[252:255], v[108:111], v[220:223], a[252:255]
    s_waitcnt vmcnt(1)
    v_pk_mul_f32 v[232:233], v[232:233], s[72:73]
    v_pk_mul_f32 v[234:235], v[234:235], s[72:73]
    v_pk_mul_f32 v[236:237], v[236:237], s[72:73]
    v_pk_mul_f32 v[238:239], v[238:239], s[72:73]
    v_fma_f32 v196, -v232, v232, v233
    v_fma_f32 v197, -v234, v234, v235
    v_fma_f32 v198, -v236, v236, v237
    v_fma_f32 v199, -v238, v238, v239
    v_cvt_pk_bf16_f32 v196, 0, v196
    v_cvt_pk_bf16_f32 v197, 0, v197
    v_cvt_pk_bf16_f32 v198, 0, v198
    v_cvt_pk_bf16_f32 v199, 0, v199
    v_add_f32 v196, s74, v196
    v_add_f32 v197, s74, v197
    v_add_f32 v198, s74, v198
    v_add_f32 v199, s74, v199
    v_cvt_pk_bf16_f32 v196, 0, v196
    v_cvt_pk_bf16_f32 v197, 0, v197
    v_cvt_pk_bf16_f32 v198, 0, v198
    v_cvt_pk_bf16_f32 v199, 0, v199
    v_sqrt_f32 v196, abs(v196)
    v_sqrt_f32 v197, abs(v197)
    v_sqrt_f32 v198, abs(v198)
    v_sqrt_f32 v199, abs(v199)
    v_cvt_pk_bf16_f32 v192, 0, v232
    v_cvt_pk_bf16_f32 v193, 0, v234
    v_cvt_pk_bf16_f32 v194, 0, v236
    v_cvt_pk_bf16_f32 v195, 0, v238
    v_cvt_pk_bf16_f32 v196, 0, v196
    v_cvt_pk_bf16_f32 v197, 0, v197
    v_cvt_pk_bf16_f32 v198, 0, v198
    v_cvt_pk_bf16_f32 v199, 0, v199
    v_rcp_f32 v196, v196
    v_rcp_f32 v197, v197
    v_rcp_f32 v198, v198
    v_rcp_f32 v199, v199
    v_lshlrev_b32 v224, 16, v248
    v_and_b32 v228, s71, v248
    v_lshlrev_b32 v225, 16, v249
    v_and_b32 v229, s71, v249
    v_lshlrev_b32 v226, 16, v250
    v_and_b32 v230, s71, v250
    v_lshlrev_b32 v227, 16, v251
    v_and_b32 v231, s71, v251
    v_pk_add_f32 v[176:177], v[224:225], v[192:193] neg_lo:[0,1] neg_hi:[0,1]
    v_pk_add_f32 v[178:179], v[226:227], v[194:195] neg_lo:[0,1] neg_hi:[0,1]
    v_pk_add_f32 v[180:181], v[228:229], v[192:193] neg_lo:[0,1] neg_hi:[0,1]
    v_pk_add_f32 v[182:183], v[230:231], v[194:195] neg_lo:[0,1] neg_hi:[0,1]
    v_cvt_pk_bf16_f32 v176, 0, v176
    v_cvt_pk_bf16_f32 v177, 0, v177
    v_cvt_pk_bf16_f32 v178, 0, v178
    v_cvt_pk_bf16_f32 v179, 0, v179
    v_cvt_pk_bf16_f32 v180, 0, v180
    v_cvt_pk_bf16_f32 v181, 0, v181
    v_cvt_pk_bf16_f32 v182, 0, v182
    v_cvt_pk_bf16_f32 v183, 0, v183
    v_pk_mul_f32 v[176:177], v[176:177], v[196:197]
    v_pk_mul_f32 v[178:179], v[178:179], v[198:199]
    v_pk_mul_f32 v[180:181], v[180:181], v[196:197]
    v_pk_mul_f32 v[182:183], v[182:183], v[198:199]
    v_cvt_pk_bf16_f32 v240, v176, v177
    v_cvt_pk_bf16_f32 v241, v178, v179
    v_cvt_pk_bf16_f32 v242, v180, v181
    v_cvt_pk_bf16_f32 v243, v182, v183
    ds_write_b64 v10, v[240:241] offset:2048
    ds_write_b64 v10, v[242:243] offset:6656
    s_waitcnt lgkmcnt(0)
    s_barrier
    s_mov_b32 s80, 131072
    buffer_load_dword v3, v1, s[44:47], s80 offen sc1
    ds_read_b128 v[160:163], v11 offset:2528
    ds_read_b128 v[164:167], v11 offset:2464
    ds_read_b128 v[168:171], v11 offset:2400
    ds_read_b128 v[172:175], v11 offset:2336
    ds_read_b128 v[176:179], v11 offset:3040
    ds_read_b128 v[180:183], v11 offset:2976
    s_waitcnt lgkmcnt(5)
    v_mfma_f32_16x16x32_bf16 a[240:243], v[32:35], v[160:163], a[240:243]
    ds_read_b128 v[184:187], v11 offset:2912
    v_mfma_f32_16x16x32_bf16 a[244:247], v[48:51], v[160:163], a[244:247]
    ds_read_b128 v[188:191], v11 offset:2848
    v_mfma_f32_16x16x32_bf16 a[248:251], v[64:67], v[160:163], a[248:251]
    ds_read_b128 v[192:195], v11 offset:3552
    v_mfma_f32_16x16x32_bf16 a[252:255], v[80:83], v[160:163], a[252:255]
    ds_read_b128 v[196:199], v11 offset:3488
    s_waitcnt lgkmcnt(8)
    v_mfma_f32_16x16x32_bf16 a[240:243], v[36:39], v[164:167], a[240:243]
    ds_read_b128 v[200:203], v11 offset:3424
    v_mfma_f32_16x16x32_bf16 a[244:247], v[52:55], v[164:167], a[244:247]
    ds_read_b128 v[204:207], v11 offset:3360
    v_mfma_f32_16x16x32_bf16 a[248:251], v[68:71], v[164:167], a[248:251]
    ds_read_b128 v[208:211], v11 offset:4064
    v_mfma_f32_16x16x32_bf16 a[252:255], v[84:87], v[164:167], a[252:255]
    ds_read_b128 v[212:215], v11 offset:4000
    s_waitcnt lgkmcnt(11)
    v_mfma_f32_16x16x32_bf16 a[240:243], v[40:43], v[168:171], a[240:243]
    ds_read_b128 v[216:219], v11 offset:3936
    v_mfma_f32_16x16x32_bf16 a[244:247], v[56:59], v[168:171], a[244:247]
    ds_read_b128 v[220:223], v11 offset:3872
    v_mfma_f32_16x16x32_bf16 a[248:251], v[72:75], v[168:171], a[248:251]
    v_lshlrev_b32 v232, 16, v240
    v_mfma_f32_16x16x32_bf16 a[252:255], v[88:91], v[168:171], a[252:255]
    v_and_b32 v233, s71, v240
    s_waitcnt lgkmcnt(12)
    v_mfma_f32_16x16x32_bf16 a[240:243], v[44:47], v[172:175], a[240:243]
    v_lshlrev_b32 v234, 16, v241
    v_mfma_f32_16x16x32_bf16 a[244:247], v[60:63], v[172:175], a[244:247]
    v_and_b32 v235, s71, v241
    v_mfma_f32_16x16x32_bf16 a[248:251], v[76:79], v[172:175], a[248:251]
    v_lshlrev_b32 v236, 16, v242
    v_mfma_f32_16x16x32_bf16 a[252:255], v[92:95], v[172:175], a[252:255]
    v_and_b32 v237, s71, v242
    s_waitcnt lgkmcnt(11)
    v_mfma_f32_16x16x32_bf16 a[244:247], v[32:35], v[176:179], a[244:247]
    v_lshlrev_b32 v238, 16, v243
    v_mfma_f32_16x16x32_bf16 a[248:251], v[48:51], v[176:179], a[248:251]
    v_and_b32 v239, s71, v243
    ds_write_b128 v13, a[240:243] offset:0
    v_mfma_f32_16x16x32_bf16 a[252:255], v[64:67], v[176:179], a[252:255]
    v_fmac_f32 v224, s68, v232
    s_waitcnt lgkmcnt(11)
    v_mfma_f32_16x16x32_bf16 a[244:247], v[36:39], v[180:183], a[244:247]
    v_fmac_f32 v225, s68, v233
    v_mfma_f32_16x16x32_bf16 a[248:251], v[52:55], v[180:183], a[248:251]
    v_fmac_f32 v226, s68, v234
    v_mfma_f32_16x16x32_bf16 a[252:255], v[68:71], v[180:183], a[252:255]
    v_fmac_f32 v227, s68, v235
    s_waitcnt lgkmcnt(10)
    v_mfma_f32_16x16x32_bf16 a[244:247], v[40:43], v[184:187], a[244:247]
    v_fmac_f32 v228, s69, v236
    v_mfma_f32_16x16x32_bf16 a[248:251], v[56:59], v[184:187], a[248:251]
    v_fmac_f32 v229, s69, v237
    v_mfma_f32_16x16x32_bf16 a[252:255], v[72:75], v[184:187], a[252:255]
    v_fmac_f32 v230, s69, v238
    s_waitcnt lgkmcnt(9)
    v_mfma_f32_16x16x32_bf16 a[244:247], v[44:47], v[188:191], a[244:247]
    v_fmac_f32 v231, s69, v239
    v_mfma_f32_16x16x32_bf16 a[248:251], v[60:63], v[188:191], a[248:251]
    v_mfma_f32_16x16x32_bf16 a[252:255], v[76:79], v[188:191], a[252:255]
    s_waitcnt lgkmcnt(8)
    v_mfma_f32_16x16x32_bf16 a[248:251], v[32:35], v[192:195], a[248:251]
    v_mfma_f32_16x16x32_bf16 a[252:255], v[48:51], v[192:195], a[252:255]
    s_waitcnt lgkmcnt(7)
    v_mfma_f32_16x16x32_bf16 a[248:251], v[36:39], v[196:199], a[248:251]
    ds_write_b128 v13, a[244:247] offset:4096
    v_mfma_f32_16x16x32_bf16 a[252:255], v[52:55], v[196:199], a[252:255]
    s_waitcnt lgkmcnt(7)
    v_mfma_f32_16x16x32_bf16 a[248:251], v[40:43], v[200:203], a[248:251]
    v_mfma_f32_16x16x32_bf16 a[252:255], v[56:59], v[200:203], a[252:255]
    s_waitcnt lgkmcnt(6)
    v_mfma_f32_16x16x32_bf16 a[248:251], v[44:47], v[204:207], a[248:251]
    v_mfma_f32_16x16x32_bf16 a[252:255], v[60:63], v[204:207], a[252:255]
    s_waitcnt lgkmcnt(5)
    v_mfma_f32_16x16x32_bf16 a[252:255], v[32:35], v[208:211], a[252:255]
    s_waitcnt lgkmcnt(4)
    v_mfma_f32_16x16x32_bf16 a[252:255], v[36:39], v[212:215], a[252:255]
    s_waitcnt lgkmcnt(3)
    v_mfma_f32_16x16x32_bf16 a[252:255], v[40:43], v[216:219], a[252:255]
    s_waitcnt lgkmcnt(2)
    v_mfma_f32_16x16x32_bf16 a[252:255], v[44:47], v[220:223], a[252:255]
    ds_write_b128 v13, a[248:251] offset:8192
    s_waitcnt vmcnt(0)
    v_cmp_gt_u32 vcc, 32, v3
    s_cbranch_vccnz .slow_28
.back_29:
    s_nop 3
    ds_write_b128 v13, a[252:255] offset:12288
    s_mov_b32 s78, 7340032
    buffer_load_dwordx2 v[32:33], v15, s[44:47], s78 offen offset:0 sc1
    buffer_load_dwordx2 v[36:37], v15, s[44:47], s78 offen offset:256 sc1
    s_waitcnt lgkmcnt(0)
    s_barrier
    ds_read_b128 v[232:235], v14 offset:0
    ds_read_b128 v[236:239], v14 offset:1024
    ds_read_b128 v[240:243], v14 offset:2048
    ds_read_b128 v[244:247], v14 offset:3072
    buffer_load_dwordx2 v[34:35], v15, s[44:47], s78 offen offset:2048 sc1
    buffer_load_dwordx2 v[38:39], v15, s[44:47], s78 offen offset:2304 sc1
    s_mov_b32 s78, 7344128
    buffer_load_dwordx2 v[40:41], v15, s[44:47], s78 offen offset:0 sc1
    buffer_load_dwordx2 v[44:45], v15, s[44:47], s78 offen offset:256 sc1
    buffer_load_dwordx2 v[42:43], v15, s[44:47], s78 offen offset:2048 sc1
    buffer_load_dwordx2 v[46:47], v15, s[44:47], s78 offen offset:2304 sc1
    s_mov_b32 s78, 7348224
    buffer_load_dwordx2 v[48:49], v15, s[44:47], s78 offen offset:0 sc1
    buffer_load_dwordx2 v[52:53], v15, s[44:47], s78 offen offset:256 sc1
    s_mov_b32 s80, 8388608
    s_waitcnt lgkmcnt(2)
    v_pk_add_f32 v[232:233], v[232:233], v[236:237]
    v_pk_add_f32 v[234:235], v[234:235], v[238:239]
    v_pk_add_f32 v[224:225], v[224:225], v[232:233]
    v_pk_add_f32 v[226:227], v[226:227], v[234:235]
    s_waitcnt lgkmcnt(0)
    v_pk_add_f32 v[240:241], v[240:241], v[244:245]
    v_pk_add_f32 v[242:243], v[242:243], v[246:247]
    v_pk_add_f32 v[228:229], v[228:229], v[240:241]
    v_pk_add_f32 v[230:231], v[230:231], v[242:243]
    v_cvt_pk_bf16_f32 v244, v224, v228
    v_cvt_pk_bf16_f32 v245, v225, v229
    v_cvt_pk_bf16_f32 v246, v226, v230
    v_cvt_pk_bf16_f32 v247, v227, v231
    s_mov_b64 exec, s[100:101]
    v_swap_b32 v244, v245
    v_swap_b32 v246, v247
    s_mov_b64 exec, -1
    buffer_store_dwordx4 v[244:247], v8, s[44:47], s80 offen sc1
    v_xor_b32 v252, 32, v16
    v_and_b32 v253, 32, v16
    v_mul_u32_u24 v253, 6, v253
    v_sub_u32 v253, v16, v253
    v_add_u32 v253, 384, v253
    ds_read_b64_tr_b16 v[160:161], v16 offset:0
    ds_read_b64_tr_b16 v[162:163], v16 offset:3584
    ds_read_b64_tr_b16 v[164:165], v252 offset:0
    ds_read_b64_tr_b16 v[166:167], v252 offset:3584
    ds_read_b64_tr_b16 v[168:169], v16 offset:64
    ds_read_b64_tr_b16 v[170:171], v16 offset:3648
    ds_read_b64_tr_b16 v[172:173], v252 offset:64
    ds_read_b64_tr_b16 v[174:175], v252 offset:3648
    ds_read_b64_tr_b16 v[176:177], v16 offset:128
    ds_read_b64_tr_b16 v[178:179], v16 offset:3712
    ds_read_b64_tr_b16 v[180:181], v252 offset:128
    ds_read_b64_tr_b16 v[182:183], v252 offset:3712
    ds_read_b64_tr_b16 v[184:185], v253 offset:0
    ds_read_b64_tr_b16 v[186:187], v253 offset:3584
    buffer_load_dwordx2 v[50:51], v15, s[44:47], s78 offen offset:2048 sc1
    buffer_load_dwordx2 v[54:55], v15, s[44:47], s78 offen offset:2304 sc1
    s_mov_b32 s78, 7352320
    buffer_load_dwordx2 v[56:57], v15, s[44:47], s78 offen offset:0 sc1
    buffer_load_dwordx2 v[60:61], v15, s[44:47], s78 offen offset:256 sc1
    buffer_load_dwordx2 v[58:59], v15, s[44:47], s78 offen offset:2048 sc1
    buffer_load_dwordx2 v[62:63], v15, s[44:47], s78 offen offset:2304 sc1
    s_waitcnt vmcnt(13)
    v_swap_b32 v33, v36
    v_swap_b32 v35, v38
    s_waitcnt lgkmcnt(6)
    s_nop 0
    v_mfma_f32_16x16x32_bf16 a[224:227], v[160:163], v[36:39], 0
    ds_read_b64_tr_b16 v[188:189], v16 offset:7168
    s_mov_b32 s78, 7356416
    buffer_load_dwordx2 v[64:65], v15, s[44:47], s78 offen offset:0 sc1
    v_mfma_f32_16x16x32_bf16 v[224:227], v[160:163], v[32:35], 0
    ds_read_b64_tr_b16 v[190:191], v16 offset:10752
    v_mfma_f32_16x16x32_bf16 a[228:231], v[164:167], v[36:39], 0
    ds_read_b64_tr_b16 v[192:193], v252 offset:7168
    v_mfma_f32_16x16x32_bf16 v[228:231], v[164:167], v[32:35], 0
    ds_read_b64_tr_b16 v[194:195], v252 offset:10752
    v_mfma_f32_16x16x32_bf16 a[232:235], v[168:171], v[36:39], 0
    ds_read_b64_tr_b16 v[196:197], v16 offset:7232
    buffer_load_dwordx2 v[68:69], v15, s[44:47], s78 offen offset:256 sc1
    v_mfma_f32_16x16x32_bf16 v[232:235], v[168:171], v[32:35], 0
    ds_read_b64_tr_b16 v[198:199], v16 offset:10816
    v_mfma_f32_16x16x32_bf16 a[236:239], v[172:175], v[36:39], 0
    ds_read_b64_tr_b16 v[200:201], v252 offset:7232
    v_mfma_f32_16x16x32_bf16 v[236:239], v[172:175], v[32:35], 0
    ds_read_b64_tr_b16 v[202:203], v252 offset:10816
    s_waitcnt lgkmcnt(8)
    v_mfma_f32_16x16x32_bf16 a[240:243], v[176:179], v[36:39], 0
    ds_read_b64_tr_b16 v[204:205], v16 offset:7296
    buffer_load_dwordx2 v[66:67], v15, s[44:47], s78 offen offset:2048 sc1
    v_mfma_f32_16x16x32_bf16 v[240:243], v[176:179], v[32:35], 0
    ds_read_b64_tr_b16 v[206:207], v16 offset:10880
    v_mfma_f32_16x16x32_bf16 a[244:247], v[180:183], v[36:39], 0
    ds_read_b64_tr_b16 v[208:209], v252 offset:7296
    v_mfma_f32_16x16x32_bf16 v[244:247], v[180:183], v[32:35], 0
    ds_read_b64_tr_b16 v[210:211], v252 offset:10880
    s_waitcnt vmcnt(12)
    v_swap_b32 v41, v44
    v_swap_b32 v43, v46
    v_mfma_f32_16x16x32_bf16 a[248:251], v[184:187], v[36:39], 0
    ds_read_b64_tr_b16 v[212:213], v253 offset:7168
    buffer_load_dwordx2 v[70:71], v15, s[44:47], s78 offen offset:2304 sc1
    v_mfma_f32_16x16x32_bf16 v[248:251], v[184:187], v[32:35], 0
    ds_read_b64_tr_b16 v[214:215], v253 offset:10752
    s_waitcnt lgkmcnt(6)
    v_mfma_f32_16x16x32_bf16 a[224:227], v[188:191], v[44:47], a[224:227]
    ds_read_b64_tr_b16 v[160:161], v16 offset:14336
    s_mov_b32 s78, 7360512
    buffer_load_dwordx2 v[72:73], v15, s[44:47], s78 offen offset:0 sc1
    v_mfma_f32_16x16x32_bf16 v[224:227], v[188:191], v[40:43], v[224:227]
    ds_read_b64_tr_b16 v[162:163], v16 offset:17920
    v_mfma_f32_16x16x32_bf16 a[228:231], v[192:195], v[44:47], a[228:231]
    ds_read_b64_tr_b16 v[164:165], v252 offset:14336
    v_mfma_f32_16x16x32_bf16 v[228:231], v[192:195], v[40:43], v[228:231]
    ds_read_b64_tr_b16 v[166:167], v252 offset:17920
    v_mfma_f32_16x16x32_bf16 a[232:235], v[196:199], v[44:47], a[232:235]
    ds_read_b64_tr_b16 v[168:169], v16 offset:14400
    buffer_load_dwordx2 v[76:77], v15, s[44:47], s78 offen offset:256 sc1
    v_mfma_f32_16x16x32_bf16 v[232:235], v[196:199], v[40:43], v[232:235]
    ds_read_b64_tr_b16 v[170:171], v16 offset:17984
    v_mfma_f32_16x16x32_bf16 a[236:239], v[200:203], v[44:47], a[236:239]
    ds_read_b64_tr_b16 v[172:173], v252 offset:14400
    v_mfma_f32_16x16x32_bf16 v[236:239], v[200:203], v[40:43], v[236:239]
    ds_read_b64_tr_b16 v[174:175], v252 offset:17984
    s_waitcnt lgkmcnt(8)
    v_mfma_f32_16x16x32_bf16 a[240:243], v[204:207], v[44:47], a[240:243]
    ds_read_b64_tr_b16 v[176:177], v16 offset:14464
    buffer_load_dwordx2 v[74:75], v15, s[44:47], s78 offen offset:2048 sc1
    v_mfma_f32_16x16x32_bf16 v[240:243], v[204:207], v[40:43], v[240:243]
    ds_read_b64_tr_b16 v[178:179], v16 offset:18048
    v_mfma_f32_16x16x32_bf16 a[244:247], v[208:211], v[44:47], a[244:247]
    ds_read_b64_tr_b16 v[180:181], v252 offset:14464
    v_mfma_f32_16x16x32_bf16 v[244:247], v[208:211], v[40:43], v[244:247]
    ds_read_b64_tr_b16 v[182:183], v252 offset:18048
    s_waitcnt vmcnt(11)
    v_swap_b32 v49, v52
    v_swap_b32 v51, v54
    v_mfma_f32_16x16x32_bf16 a[248:251], v[212:215], v[44:47], a[248:251]
    ds_read_b64_tr_b16 v[184:185], v253 offset:14336
    buffer_load_dwordx2 v[78:79], v15, s[44:47], s78 offen offset:2304 sc1
    v_mfma_f32_16x16x32_bf16 v[248:251], v[212:215], v[40:43], v[248:251]
    ds_read_b64_tr_b16 v[186:187], v253 offset:17920
    s_barrier
    s_mov_b32 s80, 163840
    s_mov_b64 exec, s[76:77]
    v_mov_b32 v5, 1
    buffer_atomic_add v5, v2, s[44:47], s80 offen sc1
    s_mov_b64 exec, -1
    s_waitcnt lgkmcnt(6)
    v_mfma_f32_16x16x32_bf16 a[224:227], v[160:163], v[52:55], a[224:227]
    ds_read_b64_tr_b16 v[188:189], v16 offset:21504
    s_mov_b32 s78, 7364608
    buffer_load_dwordx2 v[80:81], v15, s[44:47], s78 offen offset:0 sc1
    v_mfma_f32_16x16x32_bf16 v[224:227], v[160:163], v[48:51], v[224:227]
    ds_read_b64_tr_b16 v[190:191], v16 offset:25088
    v_mfma_f32_16x16x32_bf16 a[228:231], v[164:167], v[52:55], a[228:231]
    ds_read_b64_tr_b16 v[192:193], v252 offset:21504
    v_mfma_f32_16x16x32_bf16 v[228:231], v[164:167], v[48:51], v[228:231]
    ds_read_b64_tr_b16 v[194:195], v252 offset:25088
    v_mfma_f32_16x16x32_bf16 a[232:235], v[168:171], v[52:55], a[232:235]
    ds_read_b64_tr_b16 v[196:197], v16 offset:21568
    buffer_load_dwordx2 v[84:85], v15, s[44:47], s78 offen offset:256 sc1
    v_mfma_f32_16x16x32_bf16 v[232:235], v[168:171], v[48:51], v[232:235]
    ds_read_b64_tr_b16 v[198:199], v16 offset:25152
    v_mfma_f32_16x16x32_bf16 a[236:239], v[172:175], v[52:55], a[236:239]
    ds_read_b64_tr_b16 v[200:201], v252 offset:21568
    v_mfma_f32_16x16x32_bf16 v[236:239], v[172:175], v[48:51], v[236:239]
    ds_read_b64_tr_b16 v[202:203], v252 offset:25152
    s_waitcnt lgkmcnt(8)
    v_mfma_f32_16x16x32_bf16 a[240:243], v[176:179], v[52:55], a[240:243]
    ds_read_b64_tr_b16 v[204:205], v16 offset:21632
    buffer_load_dwordx2 v[82:83], v15, s[44:47], s78 offen offset:2048 sc1
    v_mfma_f32_16x16x32_bf16 v[240:243], v[176:179], v[48:51], v[240:243]
    ds_read_b64_tr_b16 v[206:207], v16 offset:25216
    v_mfma_f32_16x16x32_bf16 a[244:247], v[180:183], v[52:55], a[244:247]
    ds_read_b64_tr_b16 v[208:209], v252 offset:21632
    v_mfma_f32_16x16x32_bf16 v[244:247], v[180:183], v[48:51], v[244:247]
    ds_read_b64_tr_b16 v[210:211], v252 offset:25216
    s_waitcnt vmcnt(12)
    v_swap_b32 v57, v60
    v_swap_b32 v59, v62
    v_mfma_f32_16x16x32_bf16 a[248:251], v[184:187], v[52:55], a[248:251]
    ds_read_b64_tr_b16 v[212:213], v253 offset:21504
    buffer_load_dwordx2 v[86:87], v15, s[44:47], s78 offen offset:2304 sc1
    v_mfma_f32_16x16x32_bf16 v[248:251], v[184:187], v[48:51], v[248:251]
    ds_read_b64_tr_b16 v[214:215], v253 offset:25088
    s_waitcnt lgkmcnt(6)
    v_mfma_f32_16x16x32_bf16 a[224:227], v[188:191], v[60:63], a[224:227]
    ds_read_b64_tr_b16 v[160:161], v16 offset:28672
    s_mov_b32 s78, 7368704
    buffer_load_dwordx2 v[88:89], v15, s[44:47], s78 offen offset:0 sc1
    v_mfma_f32_16x16x32_bf16 v[224:227], v[188:191], v[56:59], v[224:227]
    ds_read_b64_tr_b16 v[162:163], v16 offset:32256
    v_mfma_f32_16x16x32_bf16 a[228:231], v[192:195], v[60:63], a[228:231]
    ds_read_b64_tr_b16 v[164:165], v252 offset:28672
    v_mfma_f32_16x16x32_bf16 v[228:231], v[192:195], v[56:59], v[228:231]
    ds_read_b64_tr_b16 v[166:167], v252 offset:32256
    v_mfma_f32_16x16x32_bf16 a[232:235], v[196:199], v[60:63], a[232:235]
    ds_read_b64_tr_b16 v[168:169], v16 offset:28736
    buffer_load_dwordx2 v[92:93], v15, s[44:47], s78 offen offset:256 sc1
    v_mfma_f32_16x16x32_bf16 v[232:235], v[196:199], v[56:59], v[232:235]
    ds_read_b64_tr_b16 v[170:171], v16 offset:32320
    v_mfma_f32_16x16x32_bf16 a[236:239], v[200:203], v[60:63], a[236:239]
    ds_read_b64_tr_b16 v[172:173], v252 offset:28736
    v_mfma_f32_16x16x32_bf16 v[236:239], v[200:203], v[56:59], v[236:239]
    ds_read_b64_tr_b16 v[174:175], v252 offset:32320
    s_waitcnt lgkmcnt(8)
    v_mfma_f32_16x16x32_bf16 a[240:243], v[204:207], v[60:63], a[240:243]
    ds_read_b64_tr_b16 v[176:177], v16 offset:28800
    buffer_load_dwordx2 v[90:91], v15, s[44:47], s78 offen offset:2048 sc1
    v_mfma_f32_16x16x32_bf16 v[240:243], v[204:207], v[56:59], v[240:243]
    ds_read_b64_tr_b16 v[178:179], v16 offset:32384
    v_mfma_f32_16x16x32_bf16 a[244:247], v[208:211], v[60:63], a[244:247]
    ds_read_b64_tr_b16 v[180:181], v252 offset:28800
    v_mfma_f32_16x16x32_bf16 v[244:247], v[208:211], v[56:59], v[244:247]
    ds_read_b64_tr_b16 v[182:183], v252 offset:32384
    s_waitcnt vmcnt(12)
    v_swap_b32 v65, v68
    v_swap_b32 v67, v70
    v_mfma_f32_16x16x32_bf16 a[248:251], v[212:215], v[60:63], a[248:251]
    ds_read_b64_tr_b16 v[184:185], v253 offset:28672
    buffer_load_dwordx2 v[94:95], v15, s[44:47], s78 offen offset:2304 sc1
    v_mfma_f32_16x16x32_bf16 v[248:251], v[212:215], v[56:59], v[248:251]
    ds_read_b64_tr_b16 v[186:187], v253 offset:32256
    s_waitcnt lgkmcnt(6)
    v_mfma_f32_16x16x32_bf16 a[224:227], v[160:163], v[68:71], a[224:227]
    ds_read_b64_tr_b16 v[188:189], v16 offset:35840
    v_mfma_f32_16x16x32_bf16 v[224:227], v[160:163], v[64:67], v[224:227]
    ds_read_b64_tr_b16 v[190:191], v16 offset:39424
    v_mfma_f32_16x16x32_bf16 a[228:231], v[164:167], v[68:71], a[228:231]
    ds_read_b64_tr_b16 v[192:193], v252 offset:35840
    v_mfma_f32_16x16x32_bf16 v[228:231], v[164:167], v[64:67], v[228:231]
    ds_read_b64_tr_b16 v[194:195], v252 offset:39424
    v_mfma_f32_16x16x32_bf16 a[232:235], v[168:171], v[68:71], a[232:235]
    ds_read_b64_tr_b16 v[196:197], v16 offset:35904
    v_mfma_f32_16x16x32_bf16 v[232:235], v[168:171], v[64:67], v[232:235]
    ds_read_b64_tr_b16 v[198:199], v16 offset:39488
    v_mfma_f32_16x16x32_bf16 a[236:239], v[172:175], v[68:71], a[236:239]
    ds_read_b64_tr_b16 v[200:201], v252 offset:35904
    v_mfma_f32_16x16x32_bf16 v[236:239], v[172:175], v[64:67], v[236:239]
    ds_read_b64_tr_b16 v[202:203], v252 offset:39488
    s_waitcnt lgkmcnt(8)
    v_mfma_f32_16x16x32_bf16 a[240:243], v[176:179], v[68:71], a[240:243]
    ds_read_b64_tr_b16 v[204:205], v16 offset:35968
    v_mfma_f32_16x16x32_bf16 v[240:243], v[176:179], v[64:67], v[240:243]
    ds_read_b64_tr_b16 v[206:207], v16 offset:39552
    v_mfma_f32_16x16x32_bf16 a[244:247], v[180:183], v[68:71], a[244:247]
    ds_read_b64_tr_b16 v[208:209], v252 offset:35968
    v_mfma_f32_16x16x32_bf16 v[244:247], v[180:183], v[64:67], v[244:247]
    ds_read_b64_tr_b16 v[210:211], v252 offset:39552
    s_waitcnt vmcnt(9)
    v_swap_b32 v73, v76
    v_swap_b32 v75, v78
    v_mfma_f32_16x16x32_bf16 a[248:251], v[184:187], v[68:71], a[248:251]
    ds_read_b64_tr_b16 v[212:213], v253 offset:35840
    v_mfma_f32_16x16x32_bf16 v[248:251], v[184:187], v[64:67], v[248:251]
    ds_read_b64_tr_b16 v[214:215], v253 offset:39424
    s_waitcnt lgkmcnt(6)
    v_mfma_f32_16x16x32_bf16 a[224:227], v[188:191], v[76:79], a[224:227]
    ds_read_b64_tr_b16 v[160:161], v16 offset:43008
    v_mfma_f32_16x16x32_bf16 v[224:227], v[188:191], v[72:75], v[224:227]
    ds_read_b64_tr_b16 v[162:163], v16 offset:46592
    v_mfma_f32_16x16x32_bf16 a[228:231], v[192:195], v[76:79], a[228:231]
    ds_read_b64_tr_b16 v[164:165], v252 offset:43008
    v_mfma_f32_16x16x32_bf16 v[228:231], v[192:195], v[72:75], v[228:231]
    ds_read_b64_tr_b16 v[166:167], v252 offset:46592
    v_mfma_f32_16x16x32_bf16 a[232:235], v[196:199], v[76:79], a[232:235]
    ds_read_b64_tr_b16 v[168:169], v16 offset:43072
    v_mfma_f32_16x16x32_bf16 v[232:235], v[196:199], v[72:75], v[232:235]
    ds_read_b64_tr_b16 v[170:171], v16 offset:46656
    v_mfma_f32_16x16x32_bf16 a[236:239], v[200:203], v[76:79], a[236:239]
    ds_read_b64_tr_b16 v[172:173], v252 offset:43072
    v_mfma_f32_16x16x32_bf16 v[236:239], v[200:203], v[72:75], v[236:239]
    ds_read_b64_tr_b16 v[174:175], v252 offset:46656
    s_waitcnt lgkmcnt(8)
    v_mfma_f32_16x16x32_bf16 a[240:243], v[204:207], v[76:79], a[240:243]
    ds_read_b64_tr_b16 v[176:177], v16 offset:43136
    v_mfma_f32_16x16x32_bf16 v[240:243], v[204:207], v[72:75], v[240:243]
    ds_read_b64_tr_b16 v[178:179], v16 offset:46720
    v_mfma_f32_16x16x32_bf16 a[244:247], v[208:211], v[76:79], a[244:247]
    ds_read_b64_tr_b16 v[180:181], v252 offset:43136
    v_mfma_f32_16x16x32_bf16 v[244:247], v[208:211], v[72:75], v[244:247]
    ds_read_b64_tr_b16 v[182:183], v252 offset:46720
    s_waitcnt vmcnt(4)
    v_swap_b32 v81, v84
    v_swap_b32 v83, v86
    v_mfma_f32_16x16x32_bf16 a[248:251], v[212:215], v[76:79], a[248:251]
    ds_read_b64_tr_b16 v[184:185], v253 offset:43008
    v_mfma_f32_16x16x32_bf16 v[248:251], v[212:215], v[72:75], v[248:251]
    ds_read_b64_tr_b16 v[186:187], v253 offset:46592
    s_waitcnt lgkmcnt(6)
    v_mfma_f32_16x16x32_bf16 a[224:227], v[160:163], v[84:87], a[224:227]
    ds_read_b64_tr_b16 v[188:189], v16 offset:50176
    v_mfma_f32_16x16x32_bf16 v[224:227], v[160:163], v[80:83], v[224:227]
    ds_read_b64_tr_b16 v[190:191], v16 offset:53760
    v_mfma_f32_16x16x32_bf16 a[228:231], v[164:167], v[84:87], a[228:231]
    ds_read_b64_tr_b16 v[192:193], v252 offset:50176
    v_mfma_f32_16x16x32_bf16 v[228:231], v[164:167], v[80:83], v[228:231]
    ds_read_b64_tr_b16 v[194:195], v252 offset:53760
    v_mfma_f32_16x16x32_bf16 a[232:235], v[168:171], v[84:87], a[232:235]
    ds_read_b64_tr_b16 v[196:197], v16 offset:50240
    v_mfma_f32_16x16x32_bf16 v[232:235], v[168:171], v[80:83], v[232:235]
    ds_read_b64_tr_b16 v[198:199], v16 offset:53824
    v_mfma_f32_16x16x32_bf16 a[236:239], v[172:175], v[84:87], a[236:239]
    ds_read_b64_tr_b16 v[200:201], v252 offset:50240
    v_mfma_f32_16x16x32_bf16 v[236:239], v[172:175], v[80:83], v[236:239]
    ds_read_b64_tr_b16 v[202:203], v252 offset:53824
    s_waitcnt lgkmcnt(8)
    v_mfma_f32_16x16x32_bf16 a[240:243], v[176:179], v[84:87], a[240:243]
    ds_read_b64_tr_b16 v[204:205], v16 offset:50304
    v_mfma_f32_16x16x32_bf16 v[240:243], v[176:179], v[80:83], v[240:243]
    ds_read_b64_tr_b16 v[206:207], v16 offset:53888
    v_mfma_f32_16x16x32_bf16 a[244:247], v[180:183], v[84:87], a[244:247]
    ds_read_b64_tr_b16 v[208:209], v252 offset:50304
    v_mfma_f32_16x16x32_bf16 v[244:247], v[180:183], v[80:83], v[244:247]
    ds_read_b64_tr_b16 v[210:211], v252 offset:53888
    s_waitcnt vmcnt(0)
    v_swap_b32 v89, v92
    v_swap_b32 v91, v94
    v_mfma_f32_16x16x32_bf16 a[248:251], v[184:187], v[84:87], a[248:251]
    ds_read_b64_tr_b16 v[212:213], v253 offset:50176
    v_mfma_f32_16x16x32_bf16 v[248:251], v[184:187], v[80:83], v[248:251]
    ds_read_b64_tr_b16 v[214:215], v253 offset:53760
    s_waitcnt lgkmcnt(6)
    v_mfma_f32_16x16x32_bf16 a[224:227], v[188:191], v[92:95], a[224:227]
    ds_read_b128 v[160:163], v21 offset:0
    v_mov_b32 v220, 0x3e803e80
    v_mfma_f32_16x16x32_bf16 a[228:231], v[192:195], v[92:95], a[228:231]
    ds_read_b128 v[164:167], v21 offset:64
    v_mov_b32 v221, 0x3e803e80
    v_mfma_f32_16x16x32_bf16 a[232:235], v[196:199], v[92:95], a[232:235]
    ds_read_b128 v[168:171], v21 offset:128
    v_mov_b32 v222, 0x3e803e80
    v_mfma_f32_16x16x32_bf16 a[236:239], v[200:203], v[92:95], a[236:239]
    ds_read_b128 v[172:175], v21 offset:192
    v_mov_b32 v223, 0x3e803e80
    s_waitcnt lgkmcnt(4)
    v_mfma_f32_16x16x32_bf16 a[240:243], v[204:207], v[92:95], a[240:243]
    ds_read_b128 v[176:179], v21 offset:256
    v_mfma_f32_16x16x32_bf16 a[244:247], v[208:211], v[92:95], a[244:247]
    ds_read_b128 v[180:183], v21 offset:320
    v_mfma_f32_16x16x32_bf16 a[248:251], v[212:215], v[92:95], a[248:251]
    ds_read_b128 v[184:187], v21 offset:384
    v_mfma_f32_16x16x32_bf16 v[224:227], v[188:191], v[88:91], v[224:227]
    ds_write_b128 v17, a[224:227] offset:0
    v_mfma_f32_16x16x32_bf16 v[228:231], v[192:195], v[88:91], v[228:231]
    v_mfma_f32_16x16x32_bf16 v[232:235], v[196:199], v[88:91], v[232:235]
    ds_write_b128 v17, a[228:231] offset:1024
    v_mfma_f32_16x16x32_bf16 v[236:239], v[200:203], v[88:91], v[236:239]
    v_mfma_f32_16x16x32_bf16 v[240:243], v[204:207], v[88:91], v[240:243]
    v_mfma_f32_16x16x32_bf16 v[244:247], v[208:211], v[88:91], v[244:247]
    v_mfma_f32_16x16x32_bf16 v[248:251], v[212:215], v[88:91], v[248:251]
    s_mov_b32 s80, 163840
    buffer_load_dword v3, v1, s[44:47], s80 offen sc1
    v_mfma_f32_16x16x32_bf16 v[188:191], v[220:223], v[32:35], 0
    ds_write_b128 v17, a[232:235] offset:2048
    v_mfma_f32_16x16x32_bf16 v[192:195], v[220:223], v[36:39], 0
    v_mfma_f32_16x16x32_bf16 v[188:191], v[220:223], v[40:43], v[188:191]
    v_mfma_f32_16x16x32_bf16 v[192:195], v[220:223], v[44:47], v[192:195]
    ds_write_b128 v17, a[236:239] offset:3072
    v_mfma_f32_16x16x32_bf16 v[188:191], v[220:223], v[48:51], v[188:191]
    v_mfma_f32_16x16x32_bf16 v[192:195], v[220:223], v[52:55], v[192:195]
    v_mfma_f32_16x16x32_bf16 v[188:191], v[220:223], v[56:59], v[188:191]
    ds_write_b128 v17, a[240:243] offset:4096
    v_mfma_f32_16x16x32_bf16 v[192:195], v[220:223], v[60:63], v[192:195]
    v_mfma_f32_16x16x32_bf16 v[188:191], v[220:223], v[64:67], v[188:191]
    v_mfma_f32_16x16x32_bf16 v[192:195], v[220:223], v[68:71], v[192:195]
    ds_write_b128 v17, a[244:247] offset:5120
    v_mfma_f32_16x16x32_bf16 v[188:191], v[220:223], v[72:75], v[188:191]
    v_mfma_f32_16x16x32_bf16 v[192:195], v[220:223], v[76:79], v[192:195]
    v_mfma_f32_16x16x32_bf16 v[188:191], v[220:223], v[80:83], v[188:191]
    ds_write_b128 v17, a[248:251] offset:6144
    v_mfma_f32_16x16x32_bf16 v[192:195], v[220:223], v[84:87], v[192:195]
    v_mfma_f32_16x16x32_bf16 v[188:191], v[220:223], v[88:91], v[188:191]
    v_mfma_f32_16x16x32_bf16 v[192:195], v[220:223], v[92:95], v[192:195]
    v_dot2_f32_bf16 v217, v32, v32, 0
    v_dot2_f32_bf16 v219, v36, v36, 0
    v_dot2_f32_bf16 v221, v33, v33, 0
    v_dot2_f32_bf16 v223, v37, v37, 0
    v_dot2c_f32_bf16 v217, v34, v34
    v_dot2c_f32_bf16 v219, v38, v38
    v_dot2c_f32_bf16 v221, v35, v35
    v_dot2c_f32_bf16 v223, v39, v39
    v_dot2c_f32_bf16 v217, v40, v40
    v_dot2c_f32_bf16 v219, v44, v44
    v_dot2c_f32_bf16 v221, v41, v41
    v_dot2c_f32_bf16 v223, v45, v45
    v_dot2c_f32_bf16 v217, v42, v42
    v_dot2c_f32_bf16 v219, v46, v46
    v_dot2c_f32_bf16 v221, v43, v43
    v_dot2c_f32_bf16 v223, v47, v47
    v_dot2c_f32_bf16 v217, v48, v48
    v_dot2c_f32_bf16 v219, v52, v52
    v_dot2c_f32_bf16 v221, v49, v49
    v_dot2c_f32_bf16 v223, v53, v53
    v_dot2c_f32_bf16 v217, v50, v50
    v_dot2c_f32_bf16 v219, v54, v54
    v_dot2c_f32_bf16 v221, v51, v51
    v_dot2c_f32_bf16 v223, v55, v55
    v_dot2c_f32_bf16 v217, v56, v56
    v_dot2c_f32_bf16 v219, v60, v60
    v_dot2c_f32_bf16 v221, v57, v57
    v_dot2c_f32_bf16 v223, v61, v61
    v_dot2c_f32_bf16 v217, v58, v58
    v_dot2c_f32_bf16 v219, v62, v62
    v_dot2c_f32_bf16 v221, v59, v59
    v_dot2c_f32_bf16 v223, v63, v63
    v_dot2c_f32_bf16 v217, v64, v64
    v_dot2c_f32_bf16 v219, v68, v68
    v_dot2c_f32_bf16 v221, v65, v65
    v_dot2c_f32_bf16 v223, v69, v69
    v_dot2c_f32_bf16 v217, v66, v66
    v_dot2c_f32_bf16 v219, v70, v70
    v_dot2c_f32_bf16 v221, v67, v67
    v_dot2c_f32_bf16 v223, v71, v71
    v_dot2c_f32_bf16 v217, v72, v72
    v_dot2c_f32_bf16 v219, v76, v76
    v_dot2c_f32_bf16 v221, v73, v73
    v_dot2c_f32_bf16 v223, v77, v77
    v_dot2c_f32_bf16 v217, v74, v74
    v_dot2c_f32_bf16 v219, v78, v78
    v_dot2c_f32_bf16 v221, v75, v75
    v_dot2c_f32_bf16 v223, v79, v79
    v_dot2c_f32_bf16 v217, v80, v80
    v_dot2c_f32_bf16 v219, v84, v84
    v_dot2c_f32_bf16 v221, v81, v81
    v_dot2c_f32_bf16 v223, v85, v85
    v_dot2c_f32_bf16 v217, v82, v82
    v_dot2c_f32_bf16 v219, v86, v86
    v_dot2c_f32_bf16 v221, v83, v83
    v_dot2c_f32_bf16 v223, v87, v87
    v_dot2c_f32_bf16 v217, v88, v88
    v_dot2c_f32_bf16 v219, v92, v92
    v_dot2c_f32_bf16 v221, v89, v89
    v_dot2c_f32_bf16 v223, v93, v93
    v_dot2c_f32_bf16 v217, v90, v90
    v_dot2c_f32_bf16 v219, v94, v94
    v_dot2c_f32_bf16 v221, v91, v91
    v_dot2c_f32_bf16 v223, v95, v95
    v_permlane32_swap_b32 v188, v192
    s_nop 0
    v_add_f32 v217, v217, v221
    v_add_f32 v219, v219, v223
    v_add_f32 v216, v188, v192
    s_nop 0
    v_permlane32_swap_b32 v217, v219
    v_add_f32 v217, v217, v219
    s_nop 1
    v_permlane16_swap_b32 v216, v217
    v_add_f32 v216, v216, v217
    ds_write_b32 v19, v216
    s_waitcnt lgkmcnt(0)
    s_barrier
    ds_read2_b32 v[216:217], v20 offset0:0 offset1:16
    ds_read2_b32 v[218:219], v20 offset0:32 offset1:48
    ds_read_b128 v[188:191], v18 offset:0
    ds_read_b128 v[192:195], v18 offset:1024
    ds_read_b128 v[196:199], v18 offset:2048
    ds_read_b128 v[200:203], v18 offset:3072
    ds_read_b128 v[204:207], v18 offset:4096
    ds_read_b128 v[208:211], v18 offset:5120
    ds_read_b128 v[212:215], v18 offset:6144
    s_waitcnt vmcnt(0)
    v_cmp_gt_u32 vcc, 32, v3
    s_cbranch_vccnz .slow_31
.back_32:
    s_mov_b32 s78, 8388608
    buffer_load_dwordx2 v[96:97], v15, s[44:47], s78 offen offset:0 sc1
    s_waitcnt lgkmcnt(7)
    v_pk_add_f32 v[216:217], v[216:217], v[218:219]
    v_pk_mul_f32 v[216:217], v[216:217], s[72:73]
    s_waitcnt lgkmcnt(6)
    v_pk_add_f32 v[188:189], v[188:189], v[224:225]
    v_pk_add_f32 v[190:191], v[190:191], v[226:227]
    buffer_load_dwordx2 v[100:101], v15, s[44:47], s78 offen offset:256 sc1
    v_fma_f32 v217, -v216, v216, v217
    s_waitcnt lgkmcnt(5)
    v_pk_add_f32 v[192:193], v[192:193], v[228:229]
    v_pk_add_f32 v[194:195], v[194:195], v[230:231]
    v_cvt_pk_bf16_f32 v217, 0, v217
    s_waitcnt lgkmcnt(4)
    v_pk_add_f32 v[196:197], v[196:197], v[232:233]
    buffer_load_dwordx2 v[98:99], v15, s[44:47], s78 offen offset:2048 sc1
    v_pk_add_f32 v[198:199], v[198:199], v[234:235]
    v_cvt_pk_bf16_f32 v216, 0, v216
    s_waitcnt lgkmcnt(3)
    v_pk_add_f32 v[200:201], v[200:201], v[236:237]
    v_pk_add_f32 v[202:203], v[202:203], v[238:239]
    v_add_f32 v217, s74, v217
    s_waitcnt lgkmcnt(2)
    buffer_load_dwordx2 v[102:103], v15, s[44:47], s78 offen offset:2304 sc1
    v_pk_add_f32 v[204:205], v[204:205], v[240:241]
    v_pk_add_f32 v[206:207], v[206:207], v[242:243]
    v_cvt_pk_bf16_f32 v217, 0, v217
    s_waitcnt lgkmcnt(1)
    v_pk_add_f32 v[208:209], v[208:209], v[244:245]
    v_pk_add_f32 v[210:211], v[210:211], v[246:247]
    v_sqrt_f32 v217, abs(v217)
    s_mov_b32 s78, 8392704
    buffer_load_dwordx2 v[104:105], v15, s[44:47], s78 offen offset:0 sc1
    s_waitcnt lgkmcnt(0)
    v_pk_add_f32 v[212:213], v[212:213], v[248:249]
    v_pk_add_f32 v[214:215], v[214:215], v[250:251]
    v_cvt_pk_bf16_f32 v217, 0, v217
    v_rcp_f32 v218, v217
    s_nop 0
    v_mul_f32 v218, s75, v218
    v_pk_fma_f32 v[188:189], v[160:161], v[216:217], v[188:189] op_sel_hi:[1,0,1] neg_lo:[0,1,0] neg_hi:[0,1,0]
    buffer_load_dwordx2 v[108:109], v15, s[44:47], s78 offen offset:256 sc1
    v_pk_fma_f32 v[190:191], v[162:163], v[216:217], v[190:191] op_sel_hi:[1,0,1] neg_lo:[0,1,0] neg_hi:[0,1,0]
    v_pk_fma_f32 v[192:193], v[164:165], v[216:217], v[192:193] op_sel_hi:[1,0,1] neg_lo:[0,1,0] neg_hi:[0,1,0]
    v_pk_fma_f32 v[194:195], v[166:167], v[216:217], v[194:195] op_sel_hi:[1,0,1] neg_lo:[0,1,0] neg_hi:[0,1,0]
    v_pk_fma_f32 v[196:197], v[168:169], v[216:217], v[196:197] op_sel_hi:[1,0,1] neg_lo:[0,1,0] neg_hi:[0,1,0]
    v_pk_fma_f32 v[198:199], v[170:171], v[216:217], v[198:199] op_sel_hi:[1,0,1] neg_lo:[0,1,0] neg_hi:[0,1,0]
    v_pk_fma_f32 v[200:201], v[172:173], v[216:217], v[200:201] op_sel_hi:[1,0,1] neg_lo:[0,1,0] neg_hi:[0,1,0]
    v_pk_fma_f32 v[202:203], v[174:175], v[216:217], v[202:203] op_sel_hi:[1,0,1] neg_lo:[0,1,0] neg_hi:[0,1,0]
    buffer_load_dwordx2 v[106:107], v15, s[44:47], s78 offen offset:2048 sc1
    v_pk_mul_f32 v[160:161], v[188:189], v[218:219] op_sel_hi:[1,0]
    v_pk_mul_f32 v[162:163], v[190:191], v[218:219] op_sel_hi:[1,0]
    v_pk_mul_f32 v[164:165], v[192:193], v[218:219] op_sel_hi:[1,0]
    v_pk_mul_f32 v[166:167], v[194:195], v[218:219] op_sel_hi:[1,0]
    v_pk_mul_f32 v[168:169], v[196:197], v[218:219] op_sel_hi:[1,0]
    v_pk_mul_f32 v[170:171], v[198:199], v[218:219] op_sel_hi:[1,0]
    v_pk_mul_f32 v[172:173], v[200:201], v[218:219] op_sel_hi:[1,0]
    buffer_load_dwordx2 v[110:111], v15, s[44:47], s78 offen offset:2304 sc1
    v_pk_mul_f32 v[174:175], v[202:203], v[218:219] op_sel_hi:[1,0]
    v_exp_f32 v160, v160
    v_exp_f32 v161, v161
    v_exp_f32 v162, v162
    v_exp_f32 v163, v163
    v_exp_f32 v164, v164
    v_exp_f32 v165, v165
    s_mov_b32 s78, 8396800
    buffer_load_dwordx2 v[112:113], v15, s[44:47], s78 offen offset:0 sc1
    v_exp_f32 v166, v166
    v_exp_f32 v167, v167
    v_exp_f32 v168, v168
    v_exp_f32 v169, v169
    v_exp_f32 v170, v170
    v_exp_f32 v171, v171
    buffer_load_dwordx2 v[116:117], v15, s[44:47], s78 offen offset:256 sc1
    v_exp_f32 v172, v172
    v_exp_f32 v173, v173
    v_exp_f32 v174, v174
    v_exp_f32 v175, v175
    v_pk_fma_f32 v[160:161], v[160:161], v[216:217], v[216:217] op_sel:[0,1,1] op_sel_hi:[1,1,1]
    v_pk_fma_f32 v[162:163], v[162:163], v[216:217], v[216:217] op_sel:[0,1,1] op_sel_hi:[1,1,1]
    v_pk_fma_f32 v[164:165], v[164:165], v[216:217], v[216:217] op_sel:[0,1,1] op_sel_hi:[1,1,1]
    buffer_load_dwordx2 v[114:115], v15, s[44:47], s78 offen offset:2048 sc1
    v_pk_fma_f32 v[166:167], v[166:167], v[216:217], v[216:217] op_sel:[0,1,1] op_sel_hi:[1,1,1]
    v_pk_fma_f32 v[168:169], v[168:169], v[216:217], v[216:217] op_sel:[0,1,1] op_sel_hi:[1,1,1]
    v_pk_fma_f32 v[170:171], v[170:171], v[216:217], v[216:217] op_sel:[0,1,1] op_sel_hi:[1,1,1]
    v_pk_fma_f32 v[172:173], v[172:173], v[216:217], v[216:217] op_sel:[0,1,1] op_sel_hi:[1,1,1]
    v_pk_fma_f32 v[174:175], v[174:175], v[216:217], v[216:217] op_sel:[0,1,1] op_sel_hi:[1,1,1]
    v_rcp_f32 v160, v160
    v_rcp_f32 v161, v161
    buffer_load_dwordx2 v[118:119], v15, s[44:47], s78 offen offset:2304 sc1
    v_rcp_f32 v162, v162
    v_rcp_f32 v163, v163
    v_rcp_f32 v164, v164
    v_rcp_f32 v165, v165
    v_rcp_f32 v166, v166
    v_rcp_f32 v167, v167
    v_rcp_f32 v168, v168
    s_mov_b32 s78, 8400896
    buffer_load_dwordx2 v[120:121], v15, s[44:47], s78 offen offset:0 sc1
    v_rcp_f32 v169, v169
    v_rcp_f32 v170, v170
    v_rcp_f32 v171, v171
    v_rcp_f32 v172, v172
    v_rcp_f32 v173, v173
    v_rcp_f32 v174, v174
    v_rcp_f32 v175, v175
    buffer_load_dwordx2 v[124:125], v15, s[44:47], s78 offen offset:256 sc1
    v_pk_mul_f32 v[160:161], v[160:161], v[188:189]
    v_pk_mul_f32 v[162:163], v[162:163], v[190:191]
    v_pk_mul_f32 v[164:165], v[164:165], v[192:193]
    v_pk_mul_f32 v[166:167], v[166:167], v[194:195]
    v_pk_mul_f32 v[168:169], v[168:169], v[196:197]
    v_pk_mul_f32 v[170:171], v[170:171], v[198:199]
    v_pk_mul_f32 v[172:173], v[172:173], v[200:201]
    buffer_load_dwordx2 v[122:123], v15, s[44:47], s78 offen offset:2048 sc1
    v_pk_mul_f32 v[174:175], v[174:175], v[202:203]
    v_cvt_pk_bf16_f32 v224, v160, v161
    v_cvt_pk_bf16_f32 v225, v162, v163
    v_cvt_pk_bf16_f32 v226, v164, v165
    v_cvt_pk_bf16_f32 v227, v166, v167
    v_cvt_pk_bf16_f32 v232, v168, v169
    v_cvt_pk_bf16_f32 v233, v170, v171
    buffer_load_dwordx2 v[126:127], v15, s[44:47], s78 offen offset:2304 sc1
    v_cvt_pk_bf16_f32 v234, v172, v173
    v_cvt_pk_bf16_f32 v235, v174, v175
    v_permlane16_swap_b32 v224, v226
    v_permlane16_swap_b32 v225, v227
    v_permlane16_swap_b32 v232, v234
    v_permlane16_swap_b32 v233, v235
    s_mov_b32 s80, 16777216
    s_mov_b32 s5, 16781312
    buffer_store_dwordx4 v[224:227], v22, s[44:47], s80 offen offset:0 sc1
    buffer_store_dwordx4 v[232:235], v22, s[44:47], s80 offen offset:2048 sc1
    v_pk_fma_f32 v[204:205], v[176:177], v[216:217], v[204:205] op_sel_hi:[1,0,1] neg_lo:[0,1,0] neg_hi:[0,1,0]
    v_pk_fma_f32 v[206:207], v[178:179], v[216:217], v[206:207] op_sel_hi:[1,0,1] neg_lo:[0,1,0] neg_hi:[0,1,0]
    v_pk_fma_f32 v[208:209], v[180:181], v[216:217], v[208:209] op_sel_hi:[1,0,1] neg_lo:[0,1,0] neg_hi:[0,1,0]
    v_pk_fma_f32 v[210:211], v[182:183], v[216:217], v[210:211] op_sel_hi:[1,0,1] neg_lo:[0,1,0] neg_hi:[0,1,0]
    v_pk_mul_f32 v[176:177], v[204:205], v[218:219] op_sel_hi:[1,0]
    v_pk_mul_f32 v[178:179], v[206:207], v[218:219] op_sel_hi:[1,0]
    v_pk_mul_f32 v[180:181], v[208:209], v[218:219] op_sel_hi:[1,0]
    v_pk_mul_f32 v[182:183], v[210:211], v[218:219] op_sel_hi:[1,0]
    v_exp_f32 v176, v176
    v_exp_f32 v177, v177
    v_exp_f32 v178, v178
    v_exp_f32 v179, v179
    v_exp_f32 v180, v180
    v_exp_f32 v181, v181
    v_exp_f32 v182, v182
    v_exp_f32 v183, v183
    v_pk_fma_f32 v[176:177], v[176:177], v[216:217], v[216:217] op_sel:[0,1,1] op_sel_hi:[1,1,1]
    v_pk_fma_f32 v[178:179], v[178:179], v[216:217], v[216:217] op_sel:[0,1,1] op_sel_hi:[1,1,1]
    v_pk_fma_f32 v[180:181], v[180:181], v[216:217], v[216:217] op_sel:[0,1,1] op_sel_hi:[1,1,1]
    v_pk_fma_f32 v[182:183], v[182:183], v[216:217], v[216:217] op_sel:[0,1,1] op_sel_hi:[1,1,1]
    v_rcp_f32 v176, v176
    v_rcp_f32 v177, v177
    v_rcp_f32 v178, v178
    v_rcp_f32 v179, v179
    v_rcp_f32 v180, v180
    v_rcp_f32 v181, v181
    v_rcp_f32 v182, v182
    v_rcp_f32 v183, v183
    v_pk_mul_f32 v[176:177], v[176:177], v[204:205]
    v_pk_mul_f32 v[178:179], v[178:179], v[206:207]
    v_pk_mul_f32 v[180:181], v[180:181], v[208:209]
    v_pk_mul_f32 v[182:183], v[182:183], v[210:211]
    v_cvt_pk_bf16_f32 v240, v176, v177
    v_cvt_pk_bf16_f32 v241, v178, v179
    v_cvt_pk_bf16_f32 v242, v180, v181
    v_cvt_pk_bf16_f32 v243, v182, v183
    s_nop 0
    v_permlane16_swap_b32 v240, v242
    v_permlane16_swap_b32 v241, v243
    buffer_store_dwordx4 v[240:243], v22, s[44:47], s5 offen offset:0 sc1
    v_pk_fma_f32 v[212:213], v[184:185], v[216:217], v[212:213] op_sel_hi:[1,0,1] neg_lo:[0,1,0] neg_hi:[0,1,0]
    v_pk_fma_f32 v[214:215], v[186:187], v[216:217], v[214:215] op_sel_hi:[1,0,1] neg_lo:[0,1,0] neg_hi:[0,1,0]
    v_pk_mul_f32 v[184:185], v[212:213], v[218:219] op_sel_hi:[1,0]
    v_pk_mul_f32 v[186:187], v[214:215], v[218:219] op_sel_hi:[1,0]
    v_exp_f32 v184, v184
    v_exp_f32 v185, v185
    v_exp_f32 v186, v186
    v_exp_f32 v187, v187
    v_pk_fma_f32 v[184:185], v[184:185], v[216:217], v[216:217] op_sel:[0,1,1] op_sel_hi:[1,1,1]
    v_pk_fma_f32 v[186:187], v[186:187], v[216:217], v[216:217] op_sel:[0,1,1] op_sel_hi:[1,1,1]
    v_rcp_f32 v184, v184
    v_rcp_f32 v185, v185
    v_rcp_f32 v186, v186
    v_rcp_f32 v187, v187
    v_pk_mul_f32 v[184:185], v[184:185], v[212:213]
    v_pk_mul_f32 v[186:187], v[186:187], v[214:215]
    v_cvt_pk_bf16_f32 v248, v184, v185
    v_cvt_pk_bf16_f32 v249, v186, v187
    v_xor_b32 v252, 32, v16
    v_and_b32 v253, 32, v16
    v_mul_u32_u24 v253, 6, v253
    v_sub_u32 v253, v16, v253
    v_add_u32 v253, 384, v253
    ds_read_b64_tr_b16 v[160:161], v16 offset:0
    ds_read_b64_tr_b16 v[162:163], v16 offset:3584
    ds_read_b64_tr_b16 v[164:165], v252 offset:0
    ds_read_b64_tr_b16 v[166:167], v252 offset:3584
    ds_read_b64_tr_b16 v[168:169], v16 offset:64
    ds_read_b64_tr_b16 v[170:171], v16 offset:3648
    ds_read_b64_tr_b16 v[172:173], v252 offset:64
    ds_read_b64_tr_b16 v[174:175], v252 offset:3648
    ds_read_b64_tr_b16 v[176:177], v16 offset:128
    ds_read_b64_tr_b16 v[178:179], v16 offset:3712
    ds_read_b64_tr_b16 v[180:181], v252 offset:128
    ds_read_b64_tr_b16 v[182:183], v252 offset:3712
    ds_read_b64_tr_b16 v[184:185], v253 offset:0
    ds_read_b64_tr_b16 v[186:187], v253 offset:3584
    buffer_store_dwordx2 v[248:249], v23, s[44:47], s5 offen offset:2048 sc1
    s_waitcnt vmcnt(16)
    v_swap_b32 v97, v100
    v_swap_b32 v99, v102
    s_waitcnt lgkmcnt(6)
    s_nop 0
    v_mfma_f32_16x16x32_bf16 a[224:227], v[160:163], v[100:103], 0
    ds_read_b64_tr_b16 v[188:189], v16 offset:7168
    v_mfma_f32_16x16x32_bf16 v[224:227], v[160:163], v[96:99], 0
    ds_read_b64_tr_b16 v[190:191], v16 offset:10752
    v_mfma_f32_16x16x32_bf16 a[228:231], v[164:167], v[100:103], 0
    ds_read_b64_tr_b16 v[192:193], v252 offset:7168
    v_mfma_f32_16x16x32_bf16 v[228:231], v[164:167], v[96:99], 0
    ds_read_b64_tr_b16 v[194:195], v252 offset:10752
    v_mfma_f32_16x16x32_bf16 a[232:235], v[168:171], v[100:103], 0
    ds_read_b64_tr_b16 v[196:197], v16 offset:7232
    v_mfma_f32_16x16x32_bf16 v[232:235], v[168:171], v[96:99], 0
    ds_read_b64_tr_b16 v[198:199], v16 offset:10816
    v_mfma_f32_16x16x32_bf16 a[236:239], v[172:175], v[100:103], 0
    ds_read_b64_tr_b16 v[200:201], v252 offset:7232
    v_mfma_f32_16x16x32_bf16 v[236:239], v[172:175], v[96:99], 0
    ds_read_b64_tr_b16 v[202:203], v252 offset:10816
    s_waitcnt lgkmcnt(8)
    v_mfma_f32_16x16x32_bf16 a[240:243], v[176:179], v[100:103], 0
    ds_read_b64_tr_b16 v[204:205], v16 offset:7296
    s_mov_b32 s78, 8404992
    buffer_load_dwordx2 v[128:129], v15, s[44:47], s78 offen offset:0 sc1
    v_mfma_f32_16x16x32_bf16 v[240:243], v[176:179], v[96:99], 0
    ds_read_b64_tr_b16 v[206:207], v16 offset:10880
    v_mfma_f32_16x16x32_bf16 a[244:247], v[180:183], v[100:103], 0
    ds_read_b64_tr_b16 v[208:209], v252 offset:7296
    v_mfma_f32_16x16x32_bf16 v[244:247], v[180:183], v[96:99], 0
    ds_read_b64_tr_b16 v[210:211], v252 offset:10880
    s_waitcnt vmcnt(13)
    v_swap_b32 v105, v108
    v_swap_b32 v107, v110
    v_mfma_f32_16x16x32_bf16 a[248:251], v[184:187], v[100:103], 0
    ds_read_b64_tr_b16 v[212:213], v253 offset:7168
    buffer_load_dwordx2 v[132:133], v15, s[44:47], s78 offen offset:256 sc1
    v_mfma_f32_16x16x32_bf16 v[248:251], v[184:187], v[96:99], 0
    ds_read_b64_tr_b16 v[214:215], v253 offset:10752
    s_waitcnt lgkmcnt(6)
    v_mfma_f32_16x16x32_bf16 a[224:227], v[188:191], v[108:111], a[224:227]
    ds_read_b64_tr_b16 v[160:161], v16 offset:14336
    buffer_load_dwordx2 v[130:131], v15, s[44:47], s78 offen offset:2048 sc1
    v_mfma_f32_16x16x32_bf16 v[224:227], v[188:191], v[104:107], v[224:227]
    ds_read_b64_tr_b16 v[162:163], v16 offset:17920
    v_mfma_f32_16x16x32_bf16 a[228:231], v[192:195], v[108:111], a[228:231]
    ds_read_b64_tr_b16 v[164:165], v252 offset:14336
    v_mfma_f32_16x16x32_bf16 v[228:231], v[192:195], v[104:107], v[228:231]
    ds_read_b64_tr_b16 v[166:167], v252 offset:17920
    v_mfma_f32_16x16x32_bf16 a[232:235], v[196:199], v[108:111], a[232:235]
    ds_read_b64_tr_b16 v[168:169], v16 offset:14400
    buffer_load_dwordx2 v[134:135], v15, s[44:47], s78 offen offset:2304 sc1
    v_mfma_f32_16x16x32_bf16 v[232:235], v[196:199], v[104:107], v[232:235]
    ds_read_b64_tr_b16 v[170:171], v16 offset:17984
    v_mfma_f32_16x16x32_bf16 a[236:239], v[200:203], v[108:111], a[236:239]
    ds_read_b64_tr_b16 v[172:173], v252 offset:14400
    v_mfma_f32_16x16x32_bf16 v[236:239], v[200:203], v[104:107], v[236:239]
    ds_read_b64_tr_b16 v[174:175], v252 offset:17984
    s_waitcnt lgkmcnt(8)
    v_mfma_f32_16x16x32_bf16 a[240:243], v[204:207], v[108:111], a[240:243]
    ds_read_b64_tr_b16 v[176:177], v16 offset:14464
    s_mov_b32 s78, 8409088
    buffer_load_dwordx2 v[136:137], v15, s[44:47], s78 offen offset:0 sc1
    v_mfma_f32_16x16x32_bf16 v[240:243], v[204:207], v[104:107], v[240:243]
    ds_read_b64_tr_b16 v[178:179], v16 offset:18048
    v_mfma_f32_16x16x32_bf16 a[244:247], v[208:211], v[108:111], a[244:247]
    ds_read_b64_tr_b16 v[180:181], v252 offset:14464
    v_mfma_f32_16x16x32_bf16 v[244:247], v[208:211], v[104:107], v[244:247]
    ds_read_b64_tr_b16 v[182:183], v252 offset:18048
    s_waitcnt vmcnt(13)
    v_swap_b32 v113, v116
    v_swap_b32 v115, v118
    v_mfma_f32_16x16x32_bf16 a[248:251], v[212:215], v[108:111], a[248:251]
    ds_read_b64_tr_b16 v[184:185], v253 offset:14336
    buffer_load_dwordx2 v[140:141], v15, s[44:47], s78 offen offset:256 sc1
    v_mfma_f32_16x16x32_bf16 v[248:251], v[212:215], v[104:107], v[248:251]
    ds_read_b64_tr_b16 v[186:187], v253 offset:17920
    s_waitcnt lgkmcnt(6)
    v_mfma_f32_16x16x32_bf16 a[224:227], v[160:163], v[116:119], a[224:227]
    ds_read_b64_tr_b16 v[188:189], v16 offset:21504
    buffer_load_dwordx2 v[138:139], v15, s[44:47], s78 offen offset:2048 sc1
    v_mfma_f32_16x16x32_bf16 v[224:227], v[160:163], v[112:115], v[224:227]
    ds_read_b64_tr_b16 v[190:191], v16 offset:25088
    v_mfma_f32_16x16x32_bf16 a[228:231], v[164:167], v[116:119], a[228:231]
    ds_read_b64_tr_b16 v[192:193], v252 offset:21504
    v_mfma_f32_16x16x32_bf16 v[228:231], v[164:167], v[112:115], v[228:231]
    ds_read_b64_tr_b16 v[194:195], v252 offset:25088
    v_mfma_f32_16x16x32_bf16 a[232:235], v[168:171], v[116:119], a[232:235]
    ds_read_b64_tr_b16 v[196:197], v16 offset:21568
    buffer_load_dwordx2 v[142:143], v15, s[44:47], s78 offen offset:2304 sc1
    v_mfma_f32_16x16x32_bf16 v[232:235], v[168:171], v[112:115], v[232:235]
    ds_read_b64_tr_b16 v[198:199], v16 offset:25152
    v_mfma_f32_16x16x32_bf16 a[236:239], v[172:175], v[116:119], a[236:239]
    ds_read_b64_tr_b16 v[200:201], v252 offset:21568
    v_mfma_f32_16x16x32_bf16 v[236:239], v[172:175], v[112:115], v[236:239]
    ds_read_b64_tr_b16 v[202:203], v252 offset:25152
    s_waitcnt lgkmcnt(8)
    v_mfma_f32_16x16x32_bf16 a[240:243], v[176:179], v[116:119], a[240:243]
    ds_read_b64_tr_b16 v[204:205], v16 offset:21632
    s_mov_b32 s78, 8413184
    buffer_load_dwordx2 v[144:145], v15, s[44:47], s78 offen offset:0 sc1
    v_mfma_f32_16x16x32_bf16 v[240:243], v[176:179], v[112:115], v[240:243]
    ds_read_b64_tr_b16 v[206:207], v16 offset:25216
    v_mfma_f32_16x16x32_bf16 a[244:247], v[180:183], v[116:119], a[244:247]
    ds_read_b64_tr_b16 v[208:209], v252 offset:21632
    v_mfma_f32_16x16x32_bf16 v[244:247], v[180:183], v[112:115], v[244:247]
    ds_read_b64_tr_b16 v[210:211], v252 offset:25216
    s_waitcnt vmcnt(13)
    v_swap_b32 v121, v124
    v_swap_b32 v123, v126
    v_mfma_f32_16x16x32_bf16 a[248:251], v[184:187], v[116:119], a[248:251]
    ds_read_b64_tr_b16 v[212:213], v253 offset:21504
    buffer_load_dwordx2 v[148:149], v15, s[44:47], s78 offen offset:256 sc1
    v_mfma_f32_16x16x32_bf16 v[248:251], v[184:187], v[112:115], v[248:251]
    ds_read_b64_tr_b16 v[214:215], v253 offset:25088
    s_waitcnt vmcnt(10)
    s_add_u32 s80, s82, 32768
    s_mov_b64 exec, 1
    v_mov_b32 v5, 1
    buffer_atomic_add v5, off, s[44:47], s80 sc1
    s_mov_b64 exec, -1
    s_barrier
    s_waitcnt lgkmcnt(6)
    v_mfma_f32_16x16x32_bf16 a[224:227], v[188:191], v[124:127], a[224:227]
    ds_read_b64_tr_b16 v[160:161], v16 offset:28672
    buffer_load_dwordx2 v[146:147], v15, s[44:47], s78 offen offset:2048 sc1
    v_mfma_f32_16x16x32_bf16 v[224:227], v[188:191], v[120:123], v[224:227]
    ds_read_b64_tr_b16 v[162:163], v16 offset:32256
    v_mfma_f32_16x16x32_bf16 a[228:231], v[192:195], v[124:127], a[228:231]
    ds_read_b64_tr_b16 v[164:165], v252 offset:28672
    v_mfma_f32_16x16x32_bf16 v[228:231], v[192:195], v[120:123], v[228:231]
    ds_read_b64_tr_b16 v[166:167], v252 offset:32256
    v_mfma_f32_16x16x32_bf16 a[232:235], v[196:199], v[124:127], a[232:235]
    ds_read_b64_tr_b16 v[168:169], v16 offset:28736
    buffer_load_dwordx2 v[150:151], v15, s[44:47], s78 offen offset:2304 sc1
    v_mfma_f32_16x16x32_bf16 v[232:235], v[196:199], v[120:123], v[232:235]
    ds_read_b64_tr_b16 v[170:171], v16 offset:32320
    v_mfma_f32_16x16x32_bf16 a[236:239], v[200:203], v[124:127], a[236:239]
    ds_read_b64_tr_b16 v[172:173], v252 offset:28736
    v_mfma_f32_16x16x32_bf16 v[236:239], v[200:203], v[120:123], v[236:239]
    ds_read_b64_tr_b16 v[174:175], v252 offset:32320
    s_waitcnt lgkmcnt(8)
    v_mfma_f32_16x16x32_bf16 a[240:243], v[204:207], v[124:127], a[240:243]
    ds_read_b64_tr_b16 v[176:177], v16 offset:28800
    s_mov_b32 s78, 8417280
    buffer_load_dwordx2 v[152:153], v15, s[44:47], s78 offen offset:0 sc1
    v_mfma_f32_16x16x32_bf16 v[240:243], v[204:207], v[120:123], v[240:243]
    ds_read_b64_tr_b16 v[178:179], v16 offset:32384
    v_mfma_f32_16x16x32_bf16 a[244:247], v[208:211], v[124:127], a[244:247]
    ds_read_b64_tr_b16 v[180:181], v252 offset:28800
    v_mfma_f32_16x16x32_bf16 v[244:247], v[208:211], v[120:123], v[244:247]
    ds_read_b64_tr_b16 v[182:183], v252 offset:32384
    s_waitcnt vmcnt(10)
    v_swap_b32 v129, v132
    v_swap_b32 v131, v134
    v_mfma_f32_16x16x32_bf16 a[248:251], v[212:215], v[124:127], a[248:251]
    ds_read_b64_tr_b16 v[184:185], v253 offset:28672
    buffer_load_dwordx2 v[156:157], v15, s[44:47], s78 offen offset:256 sc1
    v_mfma_f32_16x16x32_bf16 v[248:251], v[212:215], v[120:123], v[248:251]
    ds_read_b64_tr_b16 v[186:187], v253 offset:32256
    s_waitcnt lgkmcnt(6)
    v_mfma_f32_16x16x32_bf16 a[224:227], v[160:163], v[132:135], a[224:227]
    ds_read_b64_tr_b16 v[188:189], v16 offset:35840
    buffer_load_dwordx2 v[154:155], v15, s[44:47], s78 offen offset:2048 sc1
    v_mfma_f32_16x16x32_bf16 v[224:227], v[160:163], v[128:131], v[224:227]
    ds_read_b64_tr_b16 v[190:191], v16 offset:39424
    v_mfma_f32_16x16x32_bf16 a[228:231], v[164:167], v[132:135], a[228:231]
    ds_read_b64_tr_b16 v[192:193], v252 offset:35840
    v_mfma_f32_16x16x32_bf16 v[228:231], v[164:167], v[128:131], v[228:231]
    ds_read_b64_tr_b16 v[194:195], v252 offset:39424
    v_mfma_f32_16x16x32_bf16 a[232:235], v[168:171], v[132:135], a[232:235]
    ds_read_b64_tr_b16 v[196:197], v16 offset:35904
    buffer_load_dwordx2 v[158:159], v15, s[44:47], s78 offen offset:2304 sc1
    v_mfma_f32_16x16x32_bf16 v[232:235], v[168:171], v[128:131], v[232:235]
    ds_read_b64_tr_b16 v[198:199], v16 offset:39488
    v_mfma_f32_16x16x32_bf16 a[236:239], v[172:175], v[132:135], a[236:239]
    ds_read_b64_tr_b16 v[200:201], v252 offset:35904
    v_mfma_f32_16x16x32_bf16 v[236:239], v[172:175], v[128:131], v[236:239]
    ds_read_b64_tr_b16 v[202:203], v252 offset:39488
    s_waitcnt lgkmcnt(8)
    v_mfma_f32_16x16x32_bf16 a[240:243], v[176:179], v[132:135], a[240:243]
    ds_read_b64_tr_b16 v[204:205], v16 offset:35968
    v_mfma_f32_16x16x32_bf16 v[240:243], v[176:179], v[128:131], v[240:243]
    ds_read_b64_tr_b16 v[206:207], v16 offset:39552
    v_mfma_f32_16x16x32_bf16 a[244:247], v[180:183], v[132:135], a[244:247]
    ds_read_b64_tr_b16 v[208:209], v252 offset:35968
    v_mfma_f32_16x16x32_bf16 v[244:247], v[180:183], v[128:131], v[244:247]
    ds_read_b64_tr_b16 v[210:211], v252 offset:39552
    s_waitcnt vmcnt(9)
    v_swap_b32 v137, v140
    v_swap_b32 v139, v142
    v_mfma_f32_16x16x32_bf16 a[248:251], v[184:187], v[132:135], a[248:251]
    ds_read_b64_tr_b16 v[212:213], v253 offset:35840
    v_mfma_f32_16x16x32_bf16 v[248:251], v[184:187], v[128:131], v[248:251]
    ds_read_b64_tr_b16 v[214:215], v253 offset:39424
    s_waitcnt lgkmcnt(6)
    v_mfma_f32_16x16x32_bf16 a[224:227], v[188:191], v[140:143], a[224:227]
    ds_read_b64_tr_b16 v[160:161], v16 offset:43008
    v_mfma_f32_16x16x32_bf16 v[224:227], v[188:191], v[136:139], v[224:227]
    ds_read_b64_tr_b16 v[162:163], v16 offset:46592
    v_mfma_f32_16x16x32_bf16 a[228:231], v[192:195], v[140:143], a[228:231]
    ds_read_b64_tr_b16 v[164:165], v252 offset:43008
    v_mfma_f32_16x16x32_bf16 v[228:231], v[192:195], v[136:139], v[228:231]
    ds_read_b64_tr_b16 v[166:167], v252 offset:46592
    v_mfma_f32_16x16x32_bf16 a[232:235], v[196:199], v[140:143], a[232:235]
    ds_read_b64_tr_b16 v[168:169], v16 offset:43072
    v_mfma_f32_16x16x32_bf16 v[232:235], v[196:199], v[136:139], v[232:235]
    ds_read_b64_tr_b16 v[170:171], v16 offset:46656
    v_mfma_f32_16x16x32_bf16 a[236:239], v[200:203], v[140:143], a[236:239]
    ds_read_b64_tr_b16 v[172:173], v252 offset:43072
    v_mfma_f32_16x16x32_bf16 v[236:239], v[200:203], v[136:139], v[236:239]
    ds_read_b64_tr_b16 v[174:175], v252 offset:46656
    s_waitcnt lgkmcnt(8)
    v_mfma_f32_16x16x32_bf16 a[240:243], v[204:207], v[140:143], a[240:243]
    ds_read_b64_tr_b16 v[176:177], v16 offset:43136
    v_mfma_f32_16x16x32_bf16 v[240:243], v[204:207], v[136:139], v[240:243]
    ds_read_b64_tr_b16 v[178:179], v16 offset:46720
    v_mfma_f32_16x16x32_bf16 a[244:247], v[208:211], v[140:143], a[244:247]
    ds_read_b64_tr_b16 v[180:181], v252 offset:43136
    v_mfma_f32_16x16x32_bf16 v[244:247], v[208:211], v[136:139], v[244:247]
    ds_read_b64_tr_b16 v[182:183], v252 offset:46720
    s_waitcnt vmcnt(4)
    v_swap_b32 v145, v148
    v_swap_b32 v147, v150
    v_mfma_f32_16x16x32_bf16 a[248:251], v[212:215], v[140:143], a[248:251]
    ds_read_b64_tr_b16 v[184:185], v253 offset:43008
    v_mfma_f32_16x16x32_bf16 v[248:251], v[212:215], v[136:139], v[248:251]
    ds_read_b64_tr_b16 v[186:187], v253 offset:46592
    s_waitcnt lgkmcnt(6)
    v_mfma_f32_16x16x32_bf16 a[224:227], v[160:163], v[148:151], a[224:227]
    ds_read_b64_tr_b16 v[188:189], v16 offset:50176
    v_mfma_f32_16x16x32_bf16 v[224:227], v[160:163], v[144:147], v[224:227]
    ds_read_b64_tr_b16 v[190:191], v16 offset:53760
    v_mfma_f32_16x16x32_bf16 a[228:231], v[164:167], v[148:151], a[228:231]
    ds_read_b64_tr_b16 v[192:193], v252 offset:50176
    v_mfma_f32_16x16x32_bf16 v[228:231], v[164:167], v[144:147], v[228:231]
    ds_read_b64_tr_b16 v[194:195], v252 offset:53760
    v_mfma_f32_16x16x32_bf16 a[232:235], v[168:171], v[148:151], a[232:235]
    ds_read_b64_tr_b16 v[196:197], v16 offset:50240
    v_mfma_f32_16x16x32_bf16 v[232:235], v[168:171], v[144:147], v[232:235]
    ds_read_b64_tr_b16 v[198:199], v16 offset:53824
    v_mfma_f32_16x16x32_bf16 a[236:239], v[172:175], v[148:151], a[236:239]
    ds_read_b64_tr_b16 v[200:201], v252 offset:50240
    v_mfma_f32_16x16x32_bf16 v[236:239], v[172:175], v[144:147], v[236:239]
    ds_read_b64_tr_b16 v[202:203], v252 offset:53824
    s_waitcnt lgkmcnt(8)
    v_mfma_f32_16x16x32_bf16 a[240:243], v[176:179], v[148:151], a[240:243]
    ds_read_b64_tr_b16 v[204:205], v16 offset:50304
    v_mfma_f32_16x16x32_bf16 v[240:243], v[176:179], v[144:147], v[240:243]
    ds_read_b64_tr_b16 v[206:207], v16 offset:53888
    v_mfma_f32_16x16x32_bf16 a[244:247], v[180:183], v[148:151], a[244:247]
    ds_read_b64_tr_b16 v[208:209], v252 offset:50304
    v_mfma_f32_16x16x32_bf16 v[244:247], v[180:183], v[144:147], v[244:247]
    ds_read_b64_tr_b16 v[210:211], v252 offset:53888
    s_waitcnt vmcnt(0)
    v_swap_b32 v153, v156
    v_swap_b32 v155, v158
    v_mfma_f32_16x16x32_bf16 a[248:251], v[184:187], v[148:151], a[248:251]
    ds_read_b64_tr_b16 v[212:213], v253 offset:50176
    v_mfma_f32_16x16x32_bf16 v[248:251], v[184:187], v[144:147], v[248:251]
    ds_read_b64_tr_b16 v[214:215], v253 offset:53760
    s_waitcnt lgkmcnt(6)
    v_mfma_f32_16x16x32_bf16 a[224:227], v[188:191], v[156:159], a[224:227]
    ds_read_b128 v[160:163], v21 offset:0
    v_mov_b32 v220, 0x3e803e80
    v_mfma_f32_16x16x32_bf16 a[228:231], v[192:195], v[156:159], a[228:231]
    ds_read_b128 v[164:167], v21 offset:64
    v_mov_b32 v221, 0x3e803e80
    v_mfma_f32_16x16x32_bf16 a[232:235], v[196:199], v[156:159], a[232:235]
    ds_read_b128 v[168:171], v21 offset:128
    v_mov_b32 v222, 0x3e803e80
    v_mfma_f32_16x16x32_bf16 a[236:239], v[200:203], v[156:159], a[236:239]
    ds_read_b128 v[172:175], v21 offset:192
    v_mov_b32 v223, 0x3e803e80
    s_waitcnt lgkmcnt(4)
    v_mfma_f32_16x16x32_bf16 a[240:243], v[204:207], v[156:159], a[240:243]
    ds_read_b128 v[176:179], v21 offset:256
    v_mfma_f32_16x16x32_bf16 a[244:247], v[208:211], v[156:159], a[244:247]
    ds_read_b128 v[180:183], v21 offset:320
    v_mfma_f32_16x16x32_bf16 a[248:251], v[212:215], v[156:159], a[248:251]
    ds_read_b128 v[184:187], v21 offset:384
    v_mfma_f32_16x16x32_bf16 v[224:227], v[188:191], v[152:155], v[224:227]
    ds_write_b128 v17, a[224:227] offset:0
    v_mfma_f32_16x16x32_bf16 v[228:231], v[192:195], v[152:155], v[228:231]
    v_mfma_f32_16x16x32_bf16 v[232:235], v[196:199], v[152:155], v[232:235]
    ds_write_b128 v17, a[228:231] offset:1024
    v_mfma_f32_16x16x32_bf16 v[236:239], v[200:203], v[152:155], v[236:239]
    v_mfma_f32_16x16x32_bf16 v[240:243], v[204:207], v[152:155], v[240:243]
    v_mfma_f32_16x16x32_bf16 v[244:247], v[208:211], v[152:155], v[244:247]
    v_mfma_f32_16x16x32_bf16 v[248:251], v[212:215], v[152:155], v[248:251]
    s_add_u32 s80, s91, 32768
    v_mov_b32 v5, 0
    buffer_load_dword v3, v5, s[44:47], s80 offen sc1
    v_mfma_f32_16x16x32_bf16 v[188:191], v[220:223], v[96:99], 0
    ds_write_b128 v17, a[232:235] offset:2048
    v_mfma_f32_16x16x32_bf16 v[192:195], v[220:223], v[100:103], 0
    v_mfma_f32_16x16x32_bf16 v[188:191], v[220:223], v[104:107], v[188:191]
    v_mfma_f32_16x16x32_bf16 v[192:195], v[220:223], v[108:111], v[192:195]
    ds_write_b128 v17, a[236:239] offset:3072
    v_mfma_f32_16x16x32_bf16 v[188:191], v[220:223], v[112:115], v[188:191]
    v_mfma_f32_16x16x32_bf16 v[192:195], v[220:223], v[116:119], v[192:195]
    v_mfma_f32_16x16x32_bf16 v[188:191], v[220:223], v[120:123], v[188:191]
    ds_write_b128 v17, a[240:243] offset:4096
    v_mfma_f32_16x16x32_bf16 v[192:195], v[220:223], v[124:127], v[192:195]
    v_mfma_f32_16x16x32_bf16 v[188:191], v[220:223], v[128:131], v[188:191]
    v_mfma_f32_16x16x32_bf16 v[192:195], v[220:223], v[132:135], v[192:195]
    ds_write_b128 v17, a[244:247] offset:5120
    v_mfma_f32_16x16x32_bf16 v[188:191], v[220:223], v[136:139], v[188:191]
    v_mfma_f32_16x16x32_bf16 v[192:195], v[220:223], v[140:143], v[192:195]
    v_mfma_f32_16x16x32_bf16 v[188:191], v[220:223], v[144:147], v[188:191]
    ds_write_b128 v17, a[248:251] offset:6144
    v_mfma_f32_16x16x32_bf16 v[192:195], v[220:223], v[148:151], v[192:195]
    v_mfma_f32_16x16x32_bf16 v[188:191], v[220:223], v[152:155], v[188:191]
    v_mfma_f32_16x16x32_bf16 v[192:195], v[220:223], v[156:159], v[192:195]
    v_dot2_f32_bf16 v217, v96, v96, 0
    v_dot2_f32_bf16 v219, v100, v100, 0
    v_dot2_f32_bf16 v221, v97, v97, 0
    v_dot2_f32_bf16 v223, v101, v101, 0
    v_dot2c_f32_bf16 v217, v98, v98
    v_dot2c_f32_bf16 v219, v102, v102
    v_dot2c_f32_bf16 v221, v99, v99
    v_dot2c_f32_bf16 v223, v103, v103
    v_dot2c_f32_bf16 v217, v104, v104
    v_dot2c_f32_bf16 v219, v108, v108
    v_dot2c_f32_bf16 v221, v105, v105
    v_dot2c_f32_bf16 v223, v109, v109
    v_dot2c_f32_bf16 v217, v106, v106
    v_dot2c_f32_bf16 v219, v110, v110
    v_dot2c_f32_bf16 v221, v107, v107
    v_dot2c_f32_bf16 v223, v111, v111
    v_dot2c_f32_bf16 v217, v112, v112
    v_dot2c_f32_bf16 v219, v116, v116
    v_dot2c_f32_bf16 v221, v113, v113
    v_dot2c_f32_bf16 v223, v117, v117
    v_dot2c_f32_bf16 v217, v114, v114
    v_dot2c_f32_bf16 v219, v118, v118
    v_dot2c_f32_bf16 v221, v115, v115
    v_dot2c_f32_bf16 v223, v119, v119
    v_dot2c_f32_bf16 v217, v120, v120
    v_dot2c_f32_bf16 v219, v124, v124
    v_dot2c_f32_bf16 v221, v121, v121
    v_dot2c_f32_bf16 v223, v125, v125
    v_dot2c_f32_bf16 v217, v122, v122
    v_dot2c_f32_bf16 v219, v126, v126
    v_dot2c_f32_bf16 v221, v123, v123
    v_dot2c_f32_bf16 v223, v127, v127
    v_dot2c_f32_bf16 v217, v128, v128
    v_dot2c_f32_bf16 v219, v132, v132
    v_dot2c_f32_bf16 v221, v129, v129
    v_dot2c_f32_bf16 v223, v133, v133
    v_dot2c_f32_bf16 v217, v130, v130
    v_dot2c_f32_bf16 v219, v134, v134
    v_dot2c_f32_bf16 v221, v131, v131
    v_dot2c_f32_bf16 v223, v135, v135
    v_dot2c_f32_bf16 v217, v136, v136
    v_dot2c_f32_bf16 v219, v140, v140
    v_dot2c_f32_bf16 v221, v137, v137
    v_dot2c_f32_bf16 v223, v141, v141
    v_dot2c_f32_bf16 v217, v138, v138
    v_dot2c_f32_bf16 v219, v142, v142
    v_dot2c_f32_bf16 v221, v139, v139
    v_dot2c_f32_bf16 v223, v143, v143
    v_dot2c_f32_bf16 v217, v144, v144
    v_dot2c_f32_bf16 v219, v148, v148
    v_dot2c_f32_bf16 v221, v145, v145
    v_dot2c_f32_bf16 v223, v149, v149
    v_dot2c_f32_bf16 v217, v146, v146
    v_dot2c_f32_bf16 v219, v150, v150
    v_dot2c_f32_bf16 v221, v147, v147
    v_dot2c_f32_bf16 v223, v151, v151
    v_dot2c_f32_bf16 v217, v152, v152
    v_dot2c_f32_bf16 v219, v156, v156
    v_dot2c_f32_bf16 v221, v153, v153
    v_dot2c_f32_bf16 v223, v157, v157
    v_dot2c_f32_bf16 v217, v154, v154
    v_dot2c_f32_bf16 v219, v158, v158
    v_dot2c_f32_bf16 v221, v155, v155
    v_dot2c_f32_bf16 v223, v159, v159
    v_permlane32_swap_b32 v188, v192
    s_nop 0
    v_add_f32 v217, v217, v221
    v_add_f32 v219, v219, v223
    v_add_f32 v216, v188, v192
    s_nop 0
    v_permlane32_swap_b32 v217, v219
    v_add_f32 v217, v217, v219
    s_nop 1
    v_permlane16_swap_b32 v216, v217
    v_add_f32 v216, v216, v217
    ds_write_b32 v19, v216
    s_waitcnt lgkmcnt(0)
    s_barrier
    ds_read2_b32 v[216:217], v20 offset0:0 offset1:16
    ds_read2_b32 v[218:219], v20 offset0:32 offset1:48
    ds_read_b128 v[188:191], v18 offset:0
    ds_read_b128 v[192:195], v18 offset:1024
    ds_read_b128 v[196:199], v18 offset:2048
    ds_read_b128 v[200:203], v18 offset:3072
    ds_read_b128 v[204:207], v18 offset:4096
    ds_read_b128 v[208:211], v18 offset:5120
    ds_read_b128 v[212:215], v18 offset:6144
    s_waitcnt vmcnt(0)
    v_cmp_gt_u32 vcc, 8, v3
    s_cbranch_vccnz .slow_34
.back_35:
    s_mov_b32 s80, 7340032
    buffer_load_dwordx2 v[144:145], v26, s[44:47], s80 offen offset:0 sc1
    buffer_load_dwordx2 v[146:147], v26, s[44:47], s80 offen offset:256 sc1
    s_waitcnt lgkmcnt(7)
    v_pk_add_f32 v[216:217], v[216:217], v[218:219]
    v_pk_mul_f32 v[216:217], v[216:217], s[72:73]
    s_waitcnt lgkmcnt(6)
    v_pk_add_f32 v[188:189], v[188:189], v[224:225]
    v_pk_add_f32 v[190:191], v[190:191], v[226:227]
    v_fma_f32 v217, -v216, v216, v217
    s_mov_b32 s78, 16777216
    buffer_load_dwordx4 v[32:35], v24, s[44:47], s78 offen offset:0 sc1
    s_waitcnt lgkmcnt(5)
    v_pk_add_f32 v[192:193], v[192:193], v[228:229]
    v_pk_add_f32 v[194:195], v[194:195], v[230:231]
    v_cvt_pk_bf16_f32 v217, 0, v217
    s_waitcnt lgkmcnt(4)
    v_pk_add_f32 v[196:197], v[196:197], v[232:233]
    v_pk_add_f32 v[198:199], v[198:199], v[234:235]
    buffer_load_dwordx4 v[36:39], v24, s[44:47], s78 offen offset:256 sc1
    v_cvt_pk_bf16_f32 v216, 0, v216
    s_waitcnt lgkmcnt(3)
    v_pk_add_f32 v[200:201], v[200:201], v[236:237]
    v_pk_add_f32 v[202:203], v[202:203], v[238:239]
    v_add_f32 v217, s74, v217
    s_waitcnt lgkmcnt(2)
    v_pk_add_f32 v[204:205], v[204:205], v[240:241]
    v_pk_add_f32 v[206:207], v[206:207], v[242:243]
    buffer_load_dwordx4 v[40:43], v24, s[44:47], s78 offen offset:2048 sc1
    v_cvt_pk_bf16_f32 v217, 0, v217
    s_waitcnt lgkmcnt(1)
    v_pk_add_f32 v[208:209], v[208:209], v[244:245]
    v_pk_add_f32 v[210:211], v[210:211], v[246:247]
    v_sqrt_f32 v217, abs(v217)
    s_waitcnt lgkmcnt(0)
    v_pk_add_f32 v[212:213], v[212:213], v[248:249]
    buffer_load_dwordx4 v[44:47], v24, s[44:47], s78 offen offset:2304 sc1
    v_pk_add_f32 v[214:215], v[214:215], v[250:251]
    v_cvt_pk_bf16_f32 v217, 0, v217
    v_rcp_f32 v218, v217
    s_nop 0
    v_mul_f32 v218, s75, v218
    v_pk_fma_f32 v[188:189], v[160:161], v[216:217], v[188:189] op_sel_hi:[1,0,1] neg_lo:[0,1,0] neg_hi:[0,1,0]
    v_pk_fma_f32 v[190:191], v[162:163], v[216:217], v[190:191] op_sel_hi:[1,0,1] neg_lo:[0,1,0] neg_hi:[0,1,0]
    v_pk_fma_f32 v[192:193], v[164:165], v[216:217], v[192:193] op_sel_hi:[1,0,1] neg_lo:[0,1,0] neg_hi:[0,1,0]
    s_mov_b32 s78, 16781312
    buffer_load_dwordx4 v[48:51], v24, s[44:47], s78 offen offset:0 sc1
    v_pk_fma_f32 v[194:195], v[166:167], v[216:217], v[194:195] op_sel_hi:[1,0,1] neg_lo:[0,1,0] neg_hi:[0,1,0]
    v_pk_fma_f32 v[196:197], v[168:169], v[216:217], v[196:197] op_sel_hi:[1,0,1] neg_lo:[0,1,0] neg_hi:[0,1,0]
    v_pk_fma_f32 v[198:199], v[170:171], v[216:217], v[198:199] op_sel_hi:[1,0,1] neg_lo:[0,1,0] neg_hi:[0,1,0]
    v_pk_fma_f32 v[200:201], v[172:173], v[216:217], v[200:201] op_sel_hi:[1,0,1] neg_lo:[0,1,0] neg_hi:[0,1,0]
    v_pk_fma_f32 v[202:203], v[174:175], v[216:217], v[202:203] op_sel_hi:[1,0,1] neg_lo:[0,1,0] neg_hi:[0,1,0]
    v_pk_mul_f32 v[160:161], v[188:189], v[218:219] op_sel_hi:[1,0]
    v_pk_mul_f32 v[162:163], v[190:191], v[218:219] op_sel_hi:[1,0]
    v_pk_mul_f32 v[164:165], v[192:193], v[218:219] op_sel_hi:[1,0]
    buffer_load_dwordx4 v[52:55], v24, s[44:47], s78 offen offset:256 sc1
    v_pk_mul_f32 v[166:167], v[194:195], v[218:219] op_sel_hi:[1,0]
    v_pk_mul_f32 v[168:169], v[196:197], v[218:219] op_sel_hi:[1,0]
    v_pk_mul_f32 v[170:171], v[198:199], v[218:219] op_sel_hi:[1,0]
    v_pk_mul_f32 v[172:173], v[200:201], v[218:219] op_sel_hi:[1,0]
    v_pk_mul_f32 v[174:175], v[202:203], v[218:219] op_sel_hi:[1,0]
    v_exp_f32 v160, v160
    v_exp_f32 v161, v161
    buffer_load_dwordx4 v[56:59], v24, s[44:47], s78 offen offset:2048 sc1
    v_exp_f32 v162, v162
    v_exp_f32 v163, v163
    v_exp_f32 v164, v164
    v_exp_f32 v165, v165
    v_exp_f32 v166, v166
    v_exp_f32 v167, v167
    v_exp_f32 v168, v168
    buffer_load_dwordx4 v[60:63], v24, s[44:47], s78 offen offset:2304 sc1
    v_exp_f32 v169, v169
    v_exp_f32 v170, v170
    v_exp_f32 v171, v171
    v_exp_f32 v172, v172
    v_exp_f32 v173, v173
    v_exp_f32 v174, v174
    v_exp_f32 v175, v175
    v_pk_fma_f32 v[160:161], v[160:161], v[216:217], v[216:217] op_sel:[0,1,1] op_sel_hi:[1,1,1]
    s_mov_b32 s78, 16785408
    buffer_load_dwordx4 v[64:67], v24, s[44:47], s78 offen offset:0 sc1
    v_pk_fma_f32 v[162:163], v[162:163], v[216:217], v[216:217] op_sel:[0,1,1] op_sel_hi:[1,1,1]
    v_pk_fma_f32 v[164:165], v[164:165], v[216:217], v[216:217] op_sel:[0,1,1] op_sel_hi:[1,1,1]
    v_pk_fma_f32 v[166:167], v[166:167], v[216:217], v[216:217] op_sel:[0,1,1] op_sel_hi:[1,1,1]
    v_pk_fma_f32 v[168:169], v[168:169], v[216:217], v[216:217] op_sel:[0,1,1] op_sel_hi:[1,1,1]
    v_pk_fma_f32 v[170:171], v[170:171], v[216:217], v[216:217] op_sel:[0,1,1] op_sel_hi:[1,1,1]
    v_pk_fma_f32 v[172:173], v[172:173], v[216:217], v[216:217] op_sel:[0,1,1] op_sel_hi:[1,1,1]
    v_pk_fma_f32 v[174:175], v[174:175], v[216:217], v[216:217] op_sel:[0,1,1] op_sel_hi:[1,1,1]
    buffer_load_dwordx4 v[68:71], v24, s[44:47], s78 offen offset:256 sc1
    v_rcp_f32 v160, v160
    v_rcp_f32 v161, v161
    v_rcp_f32 v162, v162
    v_rcp_f32 v163, v163
    v_rcp_f32 v164, v164
    v_rcp_f32 v165, v165
    v_rcp_f32 v166, v166
    buffer_load_dwordx4 v[72:75], v24, s[44:47], s78 offen offset:2048 sc1
    v_rcp_f32 v167, v167
    v_rcp_f32 v168, v168
    v_rcp_f32 v169, v169
    v_rcp_f32 v170, v170
    v_rcp_f32 v171, v171
    v_rcp_f32 v172, v172
    v_rcp_f32 v173, v173
    v_rcp_f32 v174, v174
    buffer_load_dwordx4 v[76:79], v24, s[44:47], s78 offen offset:2304 sc1
    v_rcp_f32 v175, v175
    v_pk_mul_f32 v[160:161], v[160:161], v[188:189]
    v_pk_mul_f32 v[162:163], v[162:163], v[190:191]
    v_pk_mul_f32 v[164:165], v[164:165], v[192:193]
    v_pk_mul_f32 v[166:167], v[166:167], v[194:195]
    v_pk_mul_f32 v[168:169], v[168:169], v[196:197]
    v_pk_mul_f32 v[170:171], v[170:171], v[198:199]
    s_mov_b32 s78, 16789504
    buffer_load_dwordx4 v[80:83], v24, s[44:47], s78 offen offset:0 sc1
    v_pk_mul_f32 v[172:173], v[172:173], v[200:201]
    v_pk_mul_f32 v[174:175], v[174:175], v[202:203]
    v_cvt_pk_bf16_f32 v224, v160, v161
    v_cvt_pk_bf16_f32 v225, v162, v163
    v_cvt_pk_bf16_f32 v226, v164, v165
    v_cvt_pk_bf16_f32 v227, v166, v167
    v_cvt_pk_bf16_f32 v232, v168, v169
    buffer_load_dwordx4 v[84:87], v24, s[44:47], s78 offen offset:256 sc1
    v_cvt_pk_bf16_f32 v233, v170, v171
    v_cvt_pk_bf16_f32 v234, v172, v173
    v_cvt_pk_bf16_f32 v235, v174, v175
    v_permlane16_swap_b32 v224, v226
    v_permlane16_swap_b32 v225, v227
    v_permlane16_swap_b32 v232, v234
    v_permlane16_swap_b32 v233, v235
    s_mov_b32 s80, 20447232
    s_mov_b32 s5, 20451328
    buffer_store_dwordx4 v[224:227], v22, s[44:47], s80 offen offset:0 sc1
    buffer_store_dwordx4 v[232:235], v22, s[44:47], s80 offen offset:2048 sc1
    v_pk_fma_f32 v[204:205], v[176:177], v[216:217], v[204:205] op_sel_hi:[1,0,1] neg_lo:[0,1,0] neg_hi:[0,1,0]
    v_pk_fma_f32 v[206:207], v[178:179], v[216:217], v[206:207] op_sel_hi:[1,0,1] neg_lo:[0,1,0] neg_hi:[0,1,0]
    v_pk_fma_f32 v[208:209], v[180:181], v[216:217], v[208:209] op_sel_hi:[1,0,1] neg_lo:[0,1,0] neg_hi:[0,1,0]
    v_pk_fma_f32 v[210:211], v[182:183], v[216:217], v[210:211] op_sel_hi:[1,0,1] neg_lo:[0,1,0] neg_hi:[0,1,0]
    v_pk_mul_f32 v[176:177], v[204:205], v[218:219] op_sel_hi:[1,0]
    v_pk_mul_f32 v[178:179], v[206:207], v[218:219] op_sel_hi:[1,0]
    v_pk_mul_f32 v[180:181], v[208:209], v[218:219] op_sel_hi:[1,0]
    v_pk_mul_f32 v[182:183], v[210:211], v[218:219] op_sel_hi:[1,0]
    v_exp_f32 v176, v176
    v_exp_f32 v177, v177
    v_exp_f32 v178, v178
    v_exp_f32 v179, v179
    v_exp_f32 v180, v180
    v_exp_f32 v181, v181
    v_exp_f32 v182, v182
    v_exp_f32 v183, v183
    v_pk_fma_f32 v[176:177], v[176:177], v[216:217], v[216:217] op_sel:[0,1,1] op_sel_hi:[1,1,1]
    v_pk_fma_f32 v[178:179], v[178:179], v[216:217], v[216:217] op_sel:[0,1,1] op_sel_hi:[1,1,1]
    v_pk_fma_f32 v[180:181], v[180:181], v[216:217], v[216:217] op_sel:[0,1,1] op_sel_hi:[1,1,1]
    v_pk_fma_f32 v[182:183], v[182:183], v[216:217], v[216:217] op_sel:[0,1,1] op_sel_hi:[1,1,1]
    v_rcp_f32 v176, v176
    v_rcp_f32 v177, v177
    v_rcp_f32 v178, v178
    v_rcp_f32 v179, v179
    v_rcp_f32 v180, v180
    v_rcp_f32 v181, v181
    v_rcp_f32 v182, v182
    v_rcp_f32 v183, v183
    v_pk_mul_f32 v[176:177], v[176:177], v[204:205]
    v_pk_mul_f32 v[178:179], v[178:179], v[206:207]
    v_pk_mul_f32 v[180:181], v[180:181], v[208:209]
    v_pk_mul_f32 v[182:183], v[182:183], v[210:211]
    v_cvt_pk_bf16_f32 v240, v176, v177
    v_cvt_pk_bf16_f32 v241, v178, v179
    v_cvt_pk_bf16_f32 v242, v180, v181
    v_cvt_pk_bf16_f32 v243, v182, v183
    s_nop 0
    v_permlane16_swap_b32 v240, v242
    v_permlane16_swap_b32 v241, v243
    buffer_store_dwordx4 v[240:243], v22, s[44:47], s5 offen offset:0 sc1
    v_pk_fma_f32 v[212:213], v[184:185], v[216:217], v[212:213] op_sel_hi:[1,0,1] neg_lo:[0,1,0] neg_hi:[0,1,0]
    v_pk_fma_f32 v[214:215], v[186:187], v[216:217], v[214:215] op_sel_hi:[1,0,1] neg_lo:[0,1,0] neg_hi:[0,1,0]
    v_pk_mul_f32 v[184:185], v[212:213], v[218:219] op_sel_hi:[1,0]
    v_pk_mul_f32 v[186:187], v[214:215], v[218:219] op_sel_hi:[1,0]
    v_exp_f32 v184, v184
    v_exp_f32 v185, v185
    v_exp_f32 v186, v186
    v_exp_f32 v187, v187
    v_pk_fma_f32 v[184:185], v[184:185], v[216:217], v[216:217] op_sel:[0,1,1] op_sel_hi:[1,1,1]
    v_pk_fma_f32 v[186:187], v[186:187], v[216:217], v[216:217] op_sel:[0,1,1] op_sel_hi:[1,1,1]
    v_rcp_f32 v184, v184
    v_rcp_f32 v185, v185
    v_rcp_f32 v186, v186
    v_rcp_f32 v187, v187
    v_pk_mul_f32 v[184:185], v[184:185], v[212:213]
    v_pk_mul_f32 v[186:187], v[186:187], v[214:215]
    v_cvt_pk_bf16_f32 v248, v184, v185
    v_cvt_pk_bf16_f32 v249, v186, v187
    buffer_store_dwordx2 v[248:249], v23, s[44:47], s5 offen offset:2048 sc1
    s_waitcnt vmcnt(16)
    v_mfma_f32_16x16x32_bf16 v[216:219], a[12:15], v[32:35], 0
    v_mfma_f32_16x16x32_bf16 v[220:223], a[12:15], v[36:39], 0
    v_mfma_f32_16x16x32_bf16 v[208:211], a[8:11], v[32:35], 0
    v_mfma_f32_16x16x32_bf16 v[212:215], a[8:11], v[36:39], 0
    v_mfma_f32_16x16x32_bf16 v[200:203], a[4:7], v[32:35], 0
    v_mfma_f32_16x16x32_bf16 v[204:207], a[4:7], v[36:39], 0
    v_mfma_f32_16x16x32_bf16 v[192:195], a[0:3], v[32:35], 0
    v_mfma_f32_16x16x32_bf16 v[196:199], a[0:3], v[36:39], 0
    s_waitcnt vmcnt(14)
    v_mfma_f32_16x16x32_bf16 v[216:219], a[28:31], v[40:43], v[216:219]
    buffer_load_dwordx4 v[88:91], v24, s[44:47], s78 offen offset:2048 sc1
    v_mfma_f32_16x16x32_bf16 v[220:223], a[28:31], v[44:47], v[220:223]
    v_mfma_f32_16x16x32_bf16 v[208:211], a[24:27], v[40:43], v[208:211]
    v_mfma_f32_16x16x32_bf16 v[212:215], a[24:27], v[44:47], v[212:215]
    v_mfma_f32_16x16x32_bf16 v[200:203], a[20:23], v[40:43], v[200:203]
    buffer_load_dwordx4 v[92:95], v24, s[44:47], s78 offen offset:2304 sc1
    v_mfma_f32_16x16x32_bf16 v[204:207], a[20:23], v[44:47], v[204:207]
    v_mfma_f32_16x16x32_bf16 v[192:195], a[16:19], v[40:43], v[192:195]
    v_mfma_f32_16x16x32_bf16 v[196:199], a[16:19], v[44:47], v[196:199]
    s_waitcnt vmcnt(14)
    v_mfma_f32_16x16x32_bf16 v[216:219], a[44:47], v[48:51], v[216:219]
    s_mov_b32 s78, 16793600
    buffer_load_dwordx4 v[96:99], v24, s[44:47], s78 offen offset:0 sc1
    v_mfma_f32_16x16x32_bf16 v[220:223], a[44:47], v[52:55], v[220:223]
    v_mfma_f32_16x16x32_bf16 v[208:211], a[40:43], v[48:51], v[208:211]
    v_mfma_f32_16x16x32_bf16 v[212:215], a[40:43], v[52:55], v[212:215]
    v_mfma_f32_16x16x32_bf16 v[200:203], a[36:39], v[48:51], v[200:203]
    buffer_load_dwordx4 v[100:103], v24, s[44:47], s78 offen offset:256 sc1
    v_mfma_f32_16x16x32_bf16 v[204:207], a[36:39], v[52:55], v[204:207]
    v_mfma_f32_16x16x32_bf16 v[192:195], a[32:35], v[48:51], v[192:195]
    v_mfma_f32_16x16x32_bf16 v[196:199], a[32:35], v[52:55], v[196:199]
    s_waitcnt vmcnt(14)
    v_mfma_f32_16x16x32_bf16 v[216:219], a[60:63], v[56:59], v[216:219]
    buffer_load_dwordx4 v[104:107], v24, s[44:47], s78 offen offset:2048 sc1
    v_mfma_f32_16x16x32_bf16 v[220:223], a[60:63], v[60:63], v[220:223]
    v_mfma_f32_16x16x32_bf16 v[208:211], a[56:59], v[56:59], v[208:211]
    v_mfma_f32_16x16x32_bf16 v[212:215], a[56:59], v[60:63], v[212:215]
    v_mfma_f32_16x16x32_bf16 v[200:203], a[52:55], v[56:59], v[200:203]
    buffer_load_dwordx4 v[108:111], v24, s[44:47], s78 offen offset:2304 sc1
    v_mfma_f32_16x16x32_bf16 v[204:207], a[52:55], v[60:63], v[204:207]
    v_mfma_f32_16x16x32_bf16 v[192:195], a[48:51], v[56:59], v[192:195]
    v_mfma_f32_16x16x32_bf16 v[196:199], a[48:51], v[60:63], v[196:199]
    s_waitcnt vmcnt(6)
    s_add_u32 s80, s82, 49152
    s_mov_b64 exec, 1
    v_mov_b32 v5, 1
    buffer_atomic_add v5, off, s[44:47], s80 sc1
    s_mov_b64 exec, -1
    s_barrier
    v_mfma_f32_16x16x32_bf16 v[216:219], a[76:79], v[64:67], v[216:219]
    s_mov_b32 s78, 16797696
    buffer_load_dwordx4 v[112:115], v24, s[44:47], s78 offen offset:0 sc1
    v_mfma_f32_16x16x32_bf16 v[220:223], a[76:79], v[68:71], v[220:223]
    v_mfma_f32_16x16x32_bf16 v[208:211], a[72:75], v[64:67], v[208:211]
    v_mfma_f32_16x16x32_bf16 v[212:215], a[72:75], v[68:71], v[212:215]
    v_mfma_f32_16x16x32_bf16 v[200:203], a[68:71], v[64:67], v[200:203]
    buffer_load_dwordx4 v[116:119], v24, s[44:47], s78 offen offset:256 sc1
    v_mfma_f32_16x16x32_bf16 v[204:207], a[68:71], v[68:71], v[204:207]
    v_mfma_f32_16x16x32_bf16 v[192:195], a[64:67], v[64:67], v[192:195]
    v_mfma_f32_16x16x32_bf16 v[196:199], a[64:67], v[68:71], v[196:199]
    v_mfma_f32_16x16x32_bf16 v[216:219], a[92:95], v[72:75], v[216:219]
    buffer_load_dwordx4 v[120:123], v24, s[44:47], s78 offen offset:2048 sc1
    v_mfma_f32_16x16x32_bf16 v[220:223], a[92:95], v[76:79], v[220:223]
    v_mfma_f32_16x16x32_bf16 v[208:211], a[88:91], v[72:75], v[208:211]
    v_mfma_f32_16x16x32_bf16 v[212:215], a[88:91], v[76:79], v[212:215]
    v_mfma_f32_16x16x32_bf16 v[200:203], a[84:87], v[72:75], v[200:203]
    buffer_load_dwordx4 v[124:127], v24, s[44:47], s78 offen offset:2304 sc1
    v_mfma_f32_16x16x32_bf16 v[204:207], a[84:87], v[76:79], v[204:207]
    v_mfma_f32_16x16x32_bf16 v[192:195], a[80:83], v[72:75], v[192:195]
    v_mfma_f32_16x16x32_bf16 v[196:199], a[80:83], v[76:79], v[196:199]
    v_mfma_f32_16x16x32_bf16 v[216:219], a[108:111], v[80:83], v[216:219]
    s_mov_b32 s78, 16801792
    buffer_load_dwordx4 v[128:131], v24, s[44:47], s78 offen offset:0 sc1
    v_mfma_f32_16x16x32_bf16 v[220:223], a[108:111], v[84:87], v[220:223]
    v_mfma_f32_16x16x32_bf16 v[208:211], a[104:107], v[80:83], v[208:211]
    v_mfma_f32_16x16x32_bf16 v[212:215], a[104:107], v[84:87], v[212:215]
    v_mfma_f32_16x16x32_bf16 v[200:203], a[100:103], v[80:83], v[200:203]
    buffer_load_dwordx4 v[132:135], v24, s[44:47], s78 offen offset:256 sc1
    v_mfma_f32_16x16x32_bf16 v[204:207], a[100:103], v[84:87], v[204:207]
    v_mfma_f32_16x16x32_bf16 v[192:195], a[96:99], v[80:83], v[192:195]
    v_mfma_f32_16x16x32_bf16 v[196:199], a[96:99], v[84:87], v[196:199]
    s_waitcnt vmcnt(11)
    v_mfma_f32_16x16x32_bf16 v[216:219], a[124:127], v[88:91], v[216:219]
    buffer_load_dwordx4 v[136:139], v24, s[44:47], s78 offen offset:2048 sc1
    v_mfma_f32_16x16x32_bf16 v[220:223], a[124:127], v[92:95], v[220:223]
    v_mfma_f32_16x16x32_bf16 v[208:211], a[120:123], v[88:91], v[208:211]
    v_mfma_f32_16x16x32_bf16 v[212:215], a[120:123], v[92:95], v[212:215]
    v_mfma_f32_16x16x32_bf16 v[200:203], a[116:119], v[88:91], v[200:203]
    buffer_load_dwordx4 v[140:143], v24, s[44:47], s78 offen offset:2304 sc1
    v_mfma_f32_16x16x32_bf16 v[204:207], a[116:119], v[92:95], v[204:207]
    v_mfma_f32_16x16x32_bf16 v[192:195], a[112:115], v[88:91], v[192:195]
    v_mfma_f32_16x16x32_bf16 v[196:199], a[112:115], v[92:95], v[196:199]
    s_waitcnt vmcnt(11)
    v_mfma_f32_16x16x32_bf16 v[216:219], a[140:143], v[96:99], v[216:219]
    v_mfma_f32_16x16x32_bf16 v[220:223], a[140:143], v[100:103], v[220:223]
    v_mfma_f32_16x16x32_bf16 v[208:211], a[136:139], v[96:99], v[208:211]
    v_mfma_f32_16x16x32_bf16 v[212:215], a[136:139], v[100:103], v[212:215]
    v_mfma_f32_16x16x32_bf16 v[200:203], a[132:135], v[96:99], v[200:203]
    v_mfma_f32_16x16x32_bf16 v[204:207], a[132:135], v[100:103], v[204:207]
    v_mfma_f32_16x16x32_bf16 v[192:195], a[128:131], v[96:99], v[192:195]
    v_mfma_f32_16x16x32_bf16 v[196:199], a[128:131], v[100:103], v[196:199]
    s_waitcnt vmcnt(9)
    v_mfma_f32_16x16x32_bf16 v[216:219], a[156:159], v[104:107], v[216:219]
    v_mfma_f32_16x16x32_bf16 v[220:223], a[156:159], v[108:111], v[220:223]
    v_mfma_f32_16x16x32_bf16 v[208:211], a[152:155], v[104:107], v[208:211]
    v_mfma_f32_16x16x32_bf16 v[212:215], a[152:155], v[108:111], v[212:215]
    v_mfma_f32_16x16x32_bf16 v[200:203], a[148:151], v[104:107], v[200:203]
    v_mfma_f32_16x16x32_bf16 v[204:207], a[148:151], v[108:111], v[204:207]
    v_mfma_f32_16x16x32_bf16 v[192:195], a[144:147], v[104:107], v[192:195]
    v_mfma_f32_16x16x32_bf16 v[196:199], a[144:147], v[108:111], v[196:199]
    s_add_u32 s80, s91, 49152
    v_mov_b32 v5, 0
    buffer_load_dword v3, v5, s[44:47], s80 offen sc1
    s_waitcnt vmcnt(7)
    v_mfma_f32_16x16x32_bf16 v[216:219], a[172:175], v[112:115], v[216:219]
    v_mfma_f32_16x16x32_bf16 v[220:223], a[172:175], v[116:119], v[220:223]
    v_mfma_f32_16x16x32_bf16 v[208:211], a[168:171], v[112:115], v[208:211]
    v_mfma_f32_16x16x32_bf16 v[212:215], a[168:171], v[116:119], v[212:215]
    s_waitcnt vmcnt(5)
    v_mfma_f32_16x16x32_bf16 v[216:219], a[188:191], v[120:123], v[216:219]
    v_mfma_f32_16x16x32_bf16 v[220:223], a[188:191], v[124:127], v[220:223]
    v_mfma_f32_16x16x32_bf16 v[208:211], a[184:187], v[120:123], v[208:211]
    v_mfma_f32_16x16x32_bf16 v[212:215], a[184:187], v[124:127], v[212:215]
    s_waitcnt vmcnt(3)
    v_mfma_f32_16x16x32_bf16 v[216:219], a[204:207], v[128:131], v[216:219]
    v_mfma_f32_16x16x32_bf16 v[220:223], a[204:207], v[132:135], v[220:223]
    v_mfma_f32_16x16x32_bf16 v[208:211], a[200:203], v[128:131], v[208:211]
    v_mfma_f32_16x16x32_bf16 v[212:215], a[200:203], v[132:135], v[212:215]
    s_waitcnt vmcnt(1)
    v_mfma_f32_16x16x32_bf16 v[216:219], a[220:223], v[136:139], v[216:219]
    v_mfma_f32_16x16x32_bf16 v[220:223], a[220:223], v[140:143], v[220:223]
    v_mfma_f32_16x16x32_bf16 v[208:211], a[216:219], v[136:139], v[208:211]
    v_mfma_f32_16x16x32_bf16 v[212:215], a[216:219], v[140:143], v[212:215]
    s_waitcnt vmcnt(0)
    v_cmp_gt_u32 vcc, 8, v3
    s_cbranch_vccnz .slow_37
.back_38:
    v_mfma_f32_16x16x32_bf16 v[200:203], a[164:167], v[112:115], v[200:203]
    v_mfma_f32_16x16x32_bf16 v[204:207], a[164:167], v[116:119], v[204:207]
    s_mov_b32 s78, 20447232
    buffer_load_dwordx4 v[32:35], v24, s[44:47], s78 offen offset:0 sc1
    v_mfma_f32_16x16x32_bf16 v[200:203], a[180:183], v[120:123], v[200:203]
    ds_write_b128 v29, v[216:219] offset:0
    v_mfma_f32_16x16x32_bf16 v[204:207], a[180:183], v[124:127], v[204:207]
    buffer_load_dwordx4 v[36:39], v24, s[44:47], s78 offen offset:256 sc1
    v_mfma_f32_16x16x32_bf16 v[200:203], a[196:199], v[128:131], v[200:203]
    ds_write_b128 v29, v[220:223] offset:1024
    v_mfma_f32_16x16x32_bf16 v[204:207], a[196:199], v[132:135], v[204:207]
    buffer_load_dwordx4 v[40:43], v24, s[44:47], s78 offen offset:2048 sc1
    v_mfma_f32_16x16x32_bf16 v[200:203], a[212:215], v[136:139], v[200:203]
    ds_write_b128 v28, v[208:211] offset:0
    v_mfma_f32_16x16x32_bf16 v[204:207], a[212:215], v[140:143], v[204:207]
    buffer_load_dwordx4 v[44:47], v24, s[44:47], s78 offen offset:2304 sc1
    v_mfma_f32_16x16x32_bf16 v[192:195], a[160:163], v[112:115], v[192:195]
    ds_write_b128 v28, v[212:215] offset:1024
    v_mfma_f32_16x16x32_bf16 v[196:199], a[160:163], v[116:119], v[196:199]
    s_mov_b32 s78, 20451328
    buffer_load_dwordx4 v[48:51], v24, s[44:47], s78 offen offset:0 sc1
    v_mfma_f32_16x16x32_bf16 v[192:195], a[176:179], v[120:123], v[192:195]
    v_mfma_f32_16x16x32_bf16 v[196:199], a[176:179], v[124:127], v[196:199]
    buffer_load_dwordx4 v[52:55], v24, s[44:47], s78 offen offset:256 sc1
    v_mfma_f32_16x16x32_bf16 v[192:195], a[192:195], v[128:131], v[192:195]
    ds_write_b128 v27, v[200:203] offset:0
    v_mfma_f32_16x16x32_bf16 v[196:199], a[192:195], v[132:135], v[196:199]
    buffer_load_dwordx4 v[56:59], v24, s[44:47], s78 offen offset:2048 sc1
    v_mfma_f32_16x16x32_bf16 v[192:195], a[208:211], v[136:139], v[192:195]
    ds_write_b128 v27, v[204:207] offset:1024
    v_mfma_f32_16x16x32_bf16 v[196:199], a[208:211], v[140:143], v[196:199]
    buffer_load_dwordx4 v[60:63], v24, s[44:47], s78 offen offset:2304 sc1
    s_mov_b32 s78, 20455424
    buffer_load_dwordx4 v[64:67], v24, s[44:47], s78 offen offset:0 sc1
    s_mov_b64 exec, s[86:87]
    v_swap_b32 v144, v145
    v_swap_b32 v146, v147
    s_mov_b64 exec, -1
    v_lshlrev_b32 v224, 16, v144
    v_and_b32 v225, s71, v144
    v_lshlrev_b32 v228, 16, v145
    v_and_b32 v229, s71, v145
    buffer_load_dwordx4 v[68:71], v24, s[44:47], s78 offen offset:256 sc1
    v_lshlrev_b32 v226, 16, v146
    v_and_b32 v227, s71, v146
    v_lshlrev_b32 v230, 16, v147
    v_and_b32 v231, s71, v147
    s_waitcnt lgkmcnt(0)
    s_barrier
    buffer_load_dwordx4 v[72:75], v24, s[44:47], s78 offen offset:2048 sc1
    ds_read_b128 v[160:163], v30 offset:0
    ds_read_b128 v[164:167], v30 offset:1024
    ds_read_b128 v[168:171], v30 offset:2048
    ds_read_b128 v[172:175], v30 offset:3072
    ds_read_b128 v[176:179], v30 offset:4096
    ds_read_b128 v[180:183], v30 offset:5120
    buffer_load_dwordx4 v[76:79], v24, s[44:47], s78 offen offset:2304 sc1
    s_waitcnt lgkmcnt(4)
    v_pk_add_f32 v[192:193], v[192:193], v[160:161]
    v_pk_add_f32 v[194:195], v[194:195], v[162:163]
    v_pk_add_f32 v[196:197], v[196:197], v[164:165]
    v_pk_add_f32 v[198:199], v[198:199], v[166:167]
    s_waitcnt lgkmcnt(2)
    s_mov_b32 s78, 20459520
    buffer_load_dwordx4 v[80:83], v24, s[44:47], s78 offen offset:0 sc1
    v_pk_add_f32 v[192:193], v[192:193], v[168:169]
    v_pk_add_f32 v[194:195], v[194:195], v[170:171]
    v_pk_add_f32 v[196:197], v[196:197], v[172:173]
    v_pk_add_f32 v[198:199], v[198:199], v[174:175]
    s_waitcnt lgkmcnt(0)
    v_pk_add_f32 v[192:193], v[192:193], v[176:177]
    buffer_load_dwordx4 v[84:87], v24, s[44:47], s78 offen offset:256 sc1
    v_pk_add_f32 v[194:195], v[194:195], v[178:179]
    v_pk_add_f32 v[196:197], v[196:197], v[180:181]
    v_pk_add_f32 v[198:199], v[198:199], v[182:183]
    v_cvt_pk_bf16_f32 v192, 0, v192
    v_cvt_pk_bf16_f32 v193, 0, v193
    v_cvt_pk_bf16_f32 v194, 0, v194
    v_cvt_pk_bf16_f32 v195, 0, v195
    v_cvt_pk_bf16_f32 v196, 0, v196
    v_cvt_pk_bf16_f32 v197, 0, v197
    v_cvt_pk_bf16_f32 v198, 0, v198
    v_cvt_pk_bf16_f32 v199, 0, v199
    v_pk_add_f32 v[192:193], v[192:193], v[224:225]
    v_pk_add_f32 v[194:195], v[194:195], v[226:227]
    v_pk_add_f32 v[196:197], v[196:197], v[228:229]
    v_pk_add_f32 v[198:199], v[198:199], v[230:231]
    v_cvt_pk_bf16_f32 v240, v192, v193
    v_cvt_pk_bf16_f32 v241, v194, v195
    v_cvt_pk_bf16_f32 v242, v196, v197
    v_cvt_pk_bf16_f32 v243, v198, v199
    s_nop 0
    v_permlane16_swap_b32 v240, v242
    v_permlane16_swap_b32 v241, v243
    s_mov_b32 s80, 0
    buffer_store_dwordx4 v[240:243], v0, s[56:59], s80 offen
    s_barrier
    s_waitcnt vmcnt(13)
    v_mfma_f32_16x16x32_bf16 v[216:219], a[12:15], v[32:35], 0
    buffer_load_dwordx4 v[88:91], v24, s[44:47], s78 offen offset:2048 sc1
    v_mfma_f32_16x16x32_bf16 v[220:223], a[12:15], v[36:39], 0
    v_mfma_f32_16x16x32_bf16 v[208:211], a[8:11], v[32:35], 0
    v_mfma_f32_16x16x32_bf16 v[212:215], a[8:11], v[36:39], 0
    v_mfma_f32_16x16x32_bf16 v[200:203], a[4:7], v[32:35], 0
    buffer_load_dwordx4 v[92:95], v24, s[44:47], s78 offen offset:2304 sc1
    v_mfma_f32_16x16x32_bf16 v[204:207], a[4:7], v[36:39], 0
    v_mfma_f32_16x16x32_bf16 v[192:195], a[0:3], v[32:35], 0
    v_mfma_f32_16x16x32_bf16 v[196:199], a[0:3], v[36:39], 0
    s_waitcnt vmcnt(13)
    v_mfma_f32_16x16x32_bf16 v[216:219], a[28:31], v[40:43], v[216:219]
    s_mov_b32 s78, 20463616
    buffer_load_dwordx4 v[96:99], v24, s[44:47], s78 offen offset:0 sc1
    v_mfma_f32_16x16x32_bf16 v[220:223], a[28:31], v[44:47], v[220:223]
    v_mfma_f32_16x16x32_bf16 v[208:211], a[24:27], v[40:43], v[208:211]
    v_mfma_f32_16x16x32_bf16 v[212:215], a[24:27], v[44:47], v[212:215]
    v_mfma_f32_16x16x32_bf16 v[200:203], a[20:23], v[40:43], v[200:203]
    buffer_load_dwordx4 v[100:103], v24, s[44:47], s78 offen offset:256 sc1
    v_mfma_f32_16x16x32_bf16 v[204:207], a[20:23], v[44:47], v[204:207]
    v_mfma_f32_16x16x32_bf16 v[192:195], a[16:19], v[40:43], v[192:195]
    v_mfma_f32_16x16x32_bf16 v[196:199], a[16:19], v[44:47], v[196:199]
    s_waitcnt vmcnt(13)
    v_mfma_f32_16x16x32_bf16 v[216:219], a[44:47], v[48:51], v[216:219]
    buffer_load_dwordx4 v[104:107], v24, s[44:47], s78 offen offset:2048 sc1
    v_mfma_f32_16x16x32_bf16 v[220:223], a[44:47], v[52:55], v[220:223]
    v_mfma_f32_16x16x32_bf16 v[208:211], a[40:43], v[48:51], v[208:211]
    v_mfma_f32_16x16x32_bf16 v[212:215], a[40:43], v[52:55], v[212:215]
    v_mfma_f32_16x16x32_bf16 v[200:203], a[36:39], v[48:51], v[200:203]
    buffer_load_dwordx4 v[108:111], v24, s[44:47], s78 offen offset:2304 sc1
    v_mfma_f32_16x16x32_bf16 v[204:207], a[36:39], v[52:55], v[204:207]
    v_mfma_f32_16x16x32_bf16 v[192:195], a[32:35], v[48:51], v[192:195]
    v_mfma_f32_16x16x32_bf16 v[196:199], a[32:35], v[52:55], v[196:199]
    s_waitcnt vmcnt(13)
    v_mfma_f32_16x16x32_bf16 v[216:219], a[60:63], v[56:59], v[216:219]
    s_mov_b32 s78, 20467712
    buffer_load_dwordx4 v[112:115], v24, s[44:47], s78 offen offset:0 sc1
    v_mfma_f32_16x16x32_bf16 v[220:223], a[60:63], v[60:63], v[220:223]
    v_mfma_f32_16x16x32_bf16 v[208:211], a[56:59], v[56:59], v[208:211]
    v_mfma_f32_16x16x32_bf16 v[212:215], a[56:59], v[60:63], v[212:215]
    v_mfma_f32_16x16x32_bf16 v[200:203], a[52:55], v[56:59], v[200:203]
    buffer_load_dwordx4 v[116:119], v24, s[44:47], s78 offen offset:256 sc1
    v_mfma_f32_16x16x32_bf16 v[204:207], a[52:55], v[60:63], v[204:207]
    v_mfma_f32_16x16x32_bf16 v[192:195], a[48:51], v[56:59], v[192:195]
    v_mfma_f32_16x16x32_bf16 v[196:199], a[48:51], v[60:63], v[196:199]
    s_waitcnt vmcnt(13)
    v_mfma_f32_16x16x32_bf16 v[216:219], a[76:79], v[64:67], v[216:219]
    buffer_load_dwordx4 v[120:123], v24, s[44:47], s78 offen offset:2048 sc1
    v_mfma_f32_16x16x32_bf16 v[220:223], a[76:79], v[68:71], v[220:223]
    v_mfma_f32_16x16x32_bf16 v[208:211], a[72:75], v[64:67], v[208:211]
    v_mfma_f32_16x16x32_bf16 v[212:215], a[72:75], v[68:71], v[212:215]
    v_mfma_f32_16x16x32_bf16 v[200:203], a[68:71], v[64:67], v[200:203]
    buffer_load_dwordx4 v[124:127], v24, s[44:47], s78 offen offset:2304 sc1
    v_mfma_f32_16x16x32_bf16 v[204:207], a[68:71], v[68:71], v[204:207]
    v_mfma_f32_16x16x32_bf16 v[192:195], a[64:67], v[64:67], v[192:195]
    v_mfma_f32_16x16x32_bf16 v[196:199], a[64:67], v[68:71], v[196:199]
    s_waitcnt vmcnt(13)
    v_mfma_f32_16x16x32_bf16 v[216:219], a[92:95], v[72:75], v[216:219]
    s_mov_b32 s78, 20471808
    buffer_load_dwordx4 v[128:131], v24, s[44:47], s78 offen offset:0 sc1
    v_mfma_f32_16x16x32_bf16 v[220:223], a[92:95], v[76:79], v[220:223]
    v_mfma_f32_16x16x32_bf16 v[208:211], a[88:91], v[72:75], v[208:211]
    v_mfma_f32_16x16x32_bf16 v[212:215], a[88:91], v[76:79], v[212:215]
    v_mfma_f32_16x16x32_bf16 v[200:203], a[84:87], v[72:75], v[200:203]
    buffer_load_dwordx4 v[132:135], v24, s[44:47], s78 offen offset:256 sc1
    v_mfma_f32_16x16x32_bf16 v[204:207], a[84:87], v[76:79], v[204:207]
    v_mfma_f32_16x16x32_bf16 v[192:195], a[80:83], v[72:75], v[192:195]
    v_mfma_f32_16x16x32_bf16 v[196:199], a[80:83], v[76:79], v[196:199]
    s_waitcnt vmcnt(13)
    v_mfma_f32_16x16x32_bf16 v[216:219], a[108:111], v[80:83], v[216:219]
    buffer_load_dwordx4 v[136:139], v24, s[44:47], s78 offen offset:2048 sc1
    v_mfma_f32_16x16x32_bf16 v[220:223], a[108:111], v[84:87], v[220:223]
    v_mfma_f32_16x16x32_bf16 v[208:211], a[104:107], v[80:83], v[208:211]
    v_mfma_f32_16x16x32_bf16 v[212:215], a[104:107], v[84:87], v[212:215]
    v_mfma_f32_16x16x32_bf16 v[200:203], a[100:103], v[80:83], v[200:203]
    buffer_load_dwordx4 v[140:143], v24, s[44:47], s78 offen offset:2304 sc1
    v_mfma_f32_16x16x32_bf16 v[204:207], a[100:103], v[84:87], v[204:207]
    v_mfma_f32_16x16x32_bf16 v[192:195], a[96:99], v[80:83], v[192:195]
    v_mfma_f32_16x16x32_bf16 v[196:199], a[96:99], v[84:87], v[196:199]
    s_waitcnt vmcnt(12)
    v_mfma_f32_16x16x32_bf16 v[216:219], a[124:127], v[88:91], v[216:219]
    s_mov_b32 s80, 8388608
    buffer_load_dwordx2 v[184:185], v26, s[44:47], s80 offen offset:0 sc1
    buffer_load_dwordx2 v[186:187], v26, s[44:47], s80 offen offset:256 sc1
    v_mfma_f32_16x16x32_bf16 v[220:223], a[124:127], v[92:95], v[220:223]
    v_mfma_f32_16x16x32_bf16 v[208:211], a[120:123], v[88:91], v[208:211]
    v_mfma_f32_16x16x32_bf16 v[212:215], a[120:123], v[92:95], v[212:215]
    v_mfma_f32_16x16x32_bf16 v[200:203], a[116:119], v[88:91], v[200:203]
    v_mfma_f32_16x16x32_bf16 v[204:207], a[116:119], v[92:95], v[204:207]
    v_mfma_f32_16x16x32_bf16 v[192:195], a[112:115], v[88:91], v[192:195]
    v_mfma_f32_16x16x32_bf16 v[196:199], a[112:115], v[92:95], v[196:199]
    s_waitcnt vmcnt(12)
    v_mfma_f32_16x16x32_bf16 v[216:219], a[140:143], v[96:99], v[216:219]
    v_mfma_f32_16x16x32_bf16 v[220:223], a[140:143], v[100:103], v[220:223]
    v_mfma_f32_16x16x32_bf16 v[208:211], a[136:139], v[96:99], v[208:211]
    v_mfma_f32_16x16x32_bf16 v[212:215], a[136:139], v[100:103], v[212:215]
    v_mfma_f32_16x16x32_bf16 v[200:203], a[132:135], v[96:99], v[200:203]
    v_mfma_f32_16x16x32_bf16 v[204:207], a[132:135], v[100:103], v[204:207]
    v_mfma_f32_16x16x32_bf16 v[192:195], a[128:131], v[96:99], v[192:195]
    v_mfma_f32_16x16x32_bf16 v[196:199], a[128:131], v[100:103], v[196:199]
    s_waitcnt vmcnt(10)
    v_mfma_f32_16x16x32_bf16 v[216:219], a[156:159], v[104:107], v[216:219]
    v_mfma_f32_16x16x32_bf16 v[220:223], a[156:159], v[108:111], v[220:223]
    v_mfma_f32_16x16x32_bf16 v[208:211], a[152:155], v[104:107], v[208:211]
    v_mfma_f32_16x16x32_bf16 v[212:215], a[152:155], v[108:111], v[212:215]
    v_mfma_f32_16x16x32_bf16 v[200:203], a[148:151], v[104:107], v[200:203]
    v_mfma_f32_16x16x32_bf16 v[204:207], a[148:151], v[108:111], v[204:207]
    v_mfma_f32_16x16x32_bf16 v[192:195], a[144:147], v[104:107], v[192:195]
    v_mfma_f32_16x16x32_bf16 v[196:199], a[144:147], v[108:111], v[196:199]
    s_waitcnt vmcnt(8)
    v_mfma_f32_16x16x32_bf16 v[216:219], a[172:175], v[112:115], v[216:219]
    v_mfma_f32_16x16x32_bf16 v[220:223], a[172:175], v[116:119], v[220:223]
    v_mfma_f32_16x16x32_bf16 v[208:211], a[168:171], v[112:115], v[208:211]
    v_mfma_f32_16x16x32_bf16 v[212:215], a[168:171], v[116:119], v[212:215]
    s_waitcnt vmcnt(6)
    v_mfma_f32_16x16x32_bf16 v[216:219], a[188:191], v[120:123], v[216:219]
    v_mfma_f32_16x16x32_bf16 v[220:223], a[188:191], v[124:127], v[220:223]
    v_mfma_f32_16x16x32_bf16 v[208:211], a[184:187], v[120:123], v[208:211]
    v_mfma_f32_16x16x32_bf16 v[212:215], a[184:187], v[124:127], v[212:215]
    s_waitcnt vmcnt(4)
    v_mfma_f32_16x16x32_bf16 v[216:219], a[204:207], v[128:131], v[216:219]
    v_mfma_f32_16x16x32_bf16 v[220:223], a[204:207], v[132:135], v[220:223]
    v_mfma_f32_16x16x32_bf16 v[208:211], a[200:203], v[128:131], v[208:211]
    v_mfma_f32_16x16x32_bf16 v[212:215], a[200:203], v[132:135], v[212:215]
    s_waitcnt vmcnt(2)
    v_mfma_f32_16x16x32_bf16 v[216:219], a[220:223], v[136:139], v[216:219]
    v_mfma_f32_16x16x32_bf16 v[220:223], a[220:223], v[140:143], v[220:223]
    v_mfma_f32_16x16x32_bf16 v[208:211], a[216:219], v[136:139], v[208:211]
    v_mfma_f32_16x16x32_bf16 v[212:215], a[216:219], v[140:143], v[212:215]
    v_mfma_f32_16x16x32_bf16 v[200:203], a[164:167], v[112:115], v[200:203]
    v_mfma_f32_16x16x32_bf16 v[204:207], a[164:167], v[116:119], v[204:207]
    v_mfma_f32_16x16x32_bf16 v[200:203], a[180:183], v[120:123], v[200:203]
    s_nop 1
    ds_write_b128 v29, v[216:219] offset:0
    v_mfma_f32_16x16x32_bf16 v[204:207], a[180:183], v[124:127], v[204:207]
    v_mfma_f32_16x16x32_bf16 v[200:203], a[196:199], v[128:131], v[200:203]
    ds_write_b128 v29, v[220:223] offset:1024
    v_mfma_f32_16x16x32_bf16 v[204:207], a[196:199], v[132:135], v[204:207]
    v_mfma_f32_16x16x32_bf16 v[200:203], a[212:215], v[136:139], v[200:203]
    ds_write_b128 v28, v[208:211] offset:0
    v_mfma_f32_16x16x32_bf16 v[204:207], a[212:215], v[140:143], v[204:207]
    v_mfma_f32_16x16x32_bf16 v[192:195], a[160:163], v[112:115], v[192:195]
    ds_write_b128 v28, v[212:215] offset:1024
    v_mfma_f32_16x16x32_bf16 v[196:199], a[160:163], v[116:119], v[196:199]
    v_mfma_f32_16x16x32_bf16 v[192:195], a[176:179], v[120:123], v[192:195]
    v_mfma_f32_16x16x32_bf16 v[196:199], a[176:179], v[124:127], v[196:199]
    v_mfma_f32_16x16x32_bf16 v[192:195], a[192:195], v[128:131], v[192:195]
    ds_write_b128 v27, v[200:203] offset:0
    v_mfma_f32_16x16x32_bf16 v[196:199], a[192:195], v[132:135], v[196:199]
    v_mfma_f32_16x16x32_bf16 v[192:195], a[208:211], v[136:139], v[192:195]
    ds_write_b128 v27, v[204:207] offset:1024
    v_mfma_f32_16x16x32_bf16 v[196:199], a[208:211], v[140:143], v[196:199]
    s_waitcnt vmcnt(0)
    s_mov_b64 exec, s[86:87]
    v_swap_b32 v184, v185
    v_swap_b32 v186, v187
    s_mov_b64 exec, -1
    v_lshlrev_b32 v224, 16, v184
    v_and_b32 v225, s71, v184
    v_lshlrev_b32 v228, 16, v185
    v_and_b32 v229, s71, v185
    v_lshlrev_b32 v226, 16, v186
    v_and_b32 v227, s71, v186
    v_lshlrev_b32 v230, 16, v187
    v_and_b32 v231, s71, v187
    s_waitcnt lgkmcnt(0)
    s_barrier
    ds_read_b128 v[160:163], v30 offset:0
    ds_read_b128 v[164:167], v30 offset:1024
    ds_read_b128 v[168:171], v30 offset:2048
    ds_read_b128 v[172:175], v30 offset:3072
    ds_read_b128 v[176:179], v30 offset:4096
    ds_read_b128 v[180:183], v30 offset:5120
    s_waitcnt lgkmcnt(4)
    v_pk_add_f32 v[192:193], v[192:193], v[160:161]
    v_pk_add_f32 v[194:195], v[194:195], v[162:163]
    v_pk_add_f32 v[196:197], v[196:197], v[164:165]
    v_pk_add_f32 v[198:199], v[198:199], v[166:167]
    s_waitcnt lgkmcnt(2)
    v_pk_add_f32 v[192:193], v[192:193], v[168:169]
    v_pk_add_f32 v[194:195], v[194:195], v[170:171]
    v_pk_add_f32 v[196:197], v[196:197], v[172:173]
    v_pk_add_f32 v[198:199], v[198:199], v[174:175]
    s_waitcnt lgkmcnt(0)
    v_pk_add_f32 v[192:193], v[192:193], v[176:177]
    v_pk_add_f32 v[194:195], v[194:195], v[178:179]
    v_pk_add_f32 v[196:197], v[196:197], v[180:181]
    v_pk_add_f32 v[198:199], v[198:199], v[182:183]
    v_cvt_pk_bf16_f32 v192, 0, v192
    v_cvt_pk_bf16_f32 v193, 0, v193
    v_cvt_pk_bf16_f32 v194, 0, v194
    v_cvt_pk_bf16_f32 v195, 0, v195
    v_cvt_pk_bf16_f32 v196, 0, v196
    v_cvt_pk_bf16_f32 v197, 0, v197
    v_cvt_pk_bf16_f32 v198, 0, v198
    v_cvt_pk_bf16_f32 v199, 0, v199
    v_pk_add_f32 v[192:193], v[192:193], v[224:225]
    v_pk_add_f32 v[194:195], v[194:195], v[226:227]
    v_pk_add_f32 v[196:197], v[196:197], v[228:229]
    v_pk_add_f32 v[198:199], v[198:199], v[230:231]
    v_cvt_pk_bf16_f32 v240, v192, v193
    v_cvt_pk_bf16_f32 v241, v194, v195
    v_cvt_pk_bf16_f32 v242, v196, v197
    v_cvt_pk_bf16_f32 v243, v198, v199
    s_nop 0
    v_permlane16_swap_b32 v240, v242
    v_permlane16_swap_b32 v241, v243
    s_mov_b32 s80, 1048576
    buffer_store_dwordx4 v[240:243], v0, s[56:59], s80 offen
.Ldone:
    s_endpgm
.nn_3:
    s_mov_b32 s10, 60000
    v_mov_b32 v213, 0
.nl_4:
    global_load_dword v215, v213, s[38:39] sc1
    s_waitcnt vmcnt(0)
    v_readfirstlane_b32 s66, v215
    s_nop 0
    s_cmp_lg_u32 s66, 0
    s_cbranch_scc1 .nb_5
    s_sub_u32 s10, s10, 1
    s_cmp_lg_u32 s10, 0
    s_cbranch_scc1 .nl_4
    s_branch .nb_5
.gs_7:
    s_mov_b32 s10, 60000
    s_mov_b32 s11, 524288
    s_mov_b32 s5, 532480
.gl_9:
    buffer_load_dwordx4 v[232:235], v9, s[44:47], s11 offen offset:0 sc1
    buffer_load_dwordx4 v[236:239], v9, s[44:47], s11 offen offset:16 sc1
    buffer_load_dwordx4 v[240:243], v9, s[44:47], s5 offen offset:0 sc1
    buffer_load_dwordx4 v[244:247], v9, s[44:47], s5 offen offset:16 sc1
    s_waitcnt vmcnt(0)
    v_xor_b32 v160, s66, v233
    v_xor_b32 v161, s66, v235
    v_xor_b32 v162, s66, v237
    v_xor_b32 v163, s66, v239
    v_xor_b32 v164, s66, v241
    v_xor_b32 v165, s66, v243
    v_xor_b32 v166, s66, v245
    v_xor_b32 v167, s66, v247
    v_or3_b32 v160, v160, v161, v162
    v_or3_b32 v163, v163, v164, v165
    v_or3_b32 v160, v160, v166, v167
    v_or_b32 v160, v160, v163
    v_cmp_ne_u32 vcc, 0, v160
    s_cbranch_vccz .gb_8
    s_sub_u32 s10, s10, 1
    s_cmp_lg_u32 s10, 0
    s_cbranch_scc1 .gl_9
    s_branch .gb_8
.slow_10:
    s_mov_b32 s10, 60000
    s_mov_b32 s11, 0
    v_mov_b32 v5, v1
.lp_12:
    buffer_load_dword v3, v5, s[44:47], s11 offen sc1
    s_waitcnt vmcnt(0)
    v_cmp_gt_u32 vcc, 32, v3
    s_cbranch_vccz .back_11
    s_sub_u32 s10, s10, 1
    s_cmp_lg_u32 s10, 0
    s_cbranch_scc1 .lp_12
    s_branch .back_11
.slow_13:
    s_mov_b32 s10, 60000
    s_mov_b32 s11, 32768
    v_mov_b32 v5, v1
.lp_15:
    buffer_load_dword v3, v5, s[44:47], s11 offen sc1
    s_waitcnt vmcnt(0)
    v_cmp_gt_u32 vcc, 32, v3
    s_cbranch_vccz .back_14
    s_sub_u32 s10, s10, 1
    s_cmp_lg_u32 s10, 0
    s_cbranch_scc1 .lp_15
    s_branch .back_14
.slow_16:
    s_mov_b32 s10, 60000
    s_add_u32 s11, s91, 0
    v_mov_b32 v5, 0
.lp_18:
    buffer_load_dword v3, v5, s[44:47], s11 offen sc1
    s_waitcnt vmcnt(0)
    v_cmp_gt_u32 vcc, 8, v3
    s_cbranch_vccz .back_17
    s_sub_u32 s10, s10, 1
    s_cmp_lg_u32 s10, 0
    s_cbranch_scc1 .lp_18
    s_branch .back_17
.slow_19:
    s_mov_b32 s10, 60000
    s_add_u32 s11, s91, 16384
    v_mov_b32 v5, 0
.lp_21:
    buffer_load_dword v3, v5, s[44:47], s11 offen sc1
    s_waitcnt vmcnt(0)
    v_cmp_gt_u32 vcc, 8, v3
    s_cbranch_vccz .back_20
    s_sub_u32 s10, s10, 1
    s_cmp_lg_u32 s10, 0
    s_cbranch_scc1 .lp_21
    s_branch .back_20
.slow_22:
    s_mov_b32 s10, 60000
    s_mov_b32 s11, 65536
    v_mov_b32 v5, v1
.lp_24:
    buffer_load_dword v3, v5, s[44:47], s11 offen sc1
    s_waitcnt vmcnt(0)
    v_cmp_gt_u32 vcc, 32, v3
    s_cbranch_vccz .back_23
    s_sub_u32 s10, s10, 1
    s_cmp_lg_u32 s10, 0
    s_cbranch_scc1 .lp_24
    s_branch .back_23
.slow_25:
    s_mov_b32 s10, 60000
    s_mov_b32 s11, 98304
    v_mov_b32 v5, v1
.lp_27:
    buffer_load_dword v3, v5, s[44:47], s11 offen sc1
    s_waitcnt vmcnt(0)
    v_cmp_gt_u32 vcc, 32, v3
    s_cbranch_vccz .back_26
    s_sub_u32 s10, s10, 1
    s_cmp_lg_u32 s10, 0
    s_cbranch_scc1 .lp_27
    s_branch .back_26
.slow_28:
    s_mov_b32 s10, 60000
    s_mov_b32 s11, 131072
    v_mov_b32 v5, v1
.lp_30:
    buffer_load_dword v3, v5, s[44:47], s11 offen sc1
    s_waitcnt vmcnt(0)
    v_cmp_gt_u32 vcc, 32, v3
    s_cbranch_vccz .back_29
    s_sub_u32 s10, s10, 1
    s_cmp_lg_u32 s10, 0
    s_cbranch_scc1 .lp_30
    s_branch .back_29
.slow_31:
    s_mov_b32 s10, 60000
    s_mov_b32 s11, 163840
    v_mov_b32 v5, v1
.lp_33:
    buffer_load_dword v3, v5, s[44:47], s11 offen sc1
    s_waitcnt vmcnt(0)
    v_cmp_gt_u32 vcc, 32, v3
    s_cbranch_vccz .back_32
    s_sub_u32 s10, s10, 1
    s_cmp_lg_u32 s10, 0
    s_cbranch_scc1 .lp_33
    s_branch .back_32
.slow_34:
    s_mov_b32 s10, 60000
    s_add_u32 s11, s91, 32768
    v_mov_b32 v5, 0
.lp_36:
    buffer_load_dword v3, v5, s[44:47], s11 offen sc1
    s_waitcnt vmcnt(0)
    v_cmp_gt_u32 vcc, 8, v3
    s_cbranch_vccz .back_35
    s_sub_u32 s10, s10, 1
    s_cmp_lg_u32 s10, 0
    s_cbranch_scc1 .lp_36
    s_branch .back_35
.slow_37:
    s_mov_b32 s10, 60000
    s_add_u32 s11, s91, 49152
    v_mov_b32 v5, 0
.lp_39:
    buffer_load_dword v3, v5, s[44:47], s11 offen sc1
    s_waitcnt vmcnt(0)
    v_cmp_gt_u32 vcc, 8, v3
    s_cbranch_vccz .back_38
    s_sub_u32 s10, s10, 1
    s_cmp_lg_u32 s10, 0
    s_cbranch_scc1 .lp_39
    s_branch .back_38
.Lkend:
.section .rodata,"a"
.p2align 6
.amdhsa_kernel interleave_layers__ssm_conv_s4d__dense_activation_silu__prompt_kernel
  .amdhsa_next_free_vgpr 512
  .amdhsa_next_free_sgpr 102
  .amdhsa_accum_offset 256
  .amdhsa_group_segment_fixed_size 0
  .amdhsa_kernarg_size 104
  .amdhsa_user_sgpr_count 2
  .amdhsa_user_sgpr_kernarg_segment_ptr 1
  .amdhsa_system_sgpr_workgroup_id_x 1
  .amdhsa_float_denorm_mode_32 3
.end_amdhsa_kernel
```
